```python
import torch

def _softmax(x, axis=-1):
    return torch.softmax(x, dim=axis)
def _gelu(x):
    return torch.nn.functional.gelu(x, approximate="tanh")
def _silu(x):
    return torch.nn.functional.silu(x)
def _sigmoid(x):
    return torch.sigmoid(x)
def _layernorm(x, axis=-1, eps=1e-5):
    m = x.mean(dim=axis, keepdim=True)
    v = x.var(dim=axis, keepdim=True, unbiased=False)
    return (x - m) / torch.sqrt(v + eps)
def _scatter_add(tgt, idx, src, axis=0):
    return tgt.clone().index_add_(axis, idx, src)
def _segment_sum(src, seg, n):
    out = torch.zeros((n,) + src.shape[1:], dtype=src.dtype)
    return out.index_add_(0, seg, src)
def _pad(x, pw):
    flat = tuple(v for pair in reversed(pw) for v in pair)
    return torch.nn.functional.pad(x, flat)

kernel_name = 'standalone__gqa_block_cached__sampling'

def setup_inputs():

    _w = (lambda a: (lambda t: t.to(torch.bfloat16) if t.is_floating_point() else t)(torch.as_tensor(a)))
    B, Sq, D = 16, 32, 512
    Hq, Hkv, Sk, Dh = 32, 8, 4096, 128
    assert Hq % Hkv == 0, (Hq, Hkv)
    return {
        "x": _w((lambda *s: torch.randn(*s, dtype=torch.bfloat16) * 0.8)(B, Sq, D)),
        "k_cache": _w((lambda *s: torch.randn(*s, dtype=torch.bfloat16) * 0.8)(B, Hkv, Sk, Dh)),
        "v_cache": _w((lambda *s: torch.randn(*s, dtype=torch.bfloat16) * 0.05)(B, Hkv, Sk, Dh)),
        "wq": _w((lambda *s: torch.randn(*s, dtype=torch.bfloat16) * 0.8)(D, Hq * Dh) * (D ** -0.5)),
        "wo": _w((lambda *s: torch.randn(*s, dtype=torch.bfloat16) * 0.05)(Hq * Dh, D) * ((Hq * Dh) ** -0.5)),
    }

def reference(x, k_cache, v_cache, wq, wo):
    B, Sq, D = x.shape
    Hq, Dh = 32, 128
    Hkv = k_cache.shape[1]
    rep = Hq // Hkv
    q = (lambda x, *d: x.permute(*d))((x @ wq).reshape(B, Sq, Hq, Dh), 0, 2, 1, 3)
    k = (lambda x, n, axis: torch.repeat_interleave(x, n, dim=axis))(k_cache, rep, axis=1)
    v = (lambda x, n, axis: torch.repeat_interleave(x, n, dim=axis))(v_cache, rep, axis=1)
    scores = torch.einsum("bhqd,bhkd->bhqk", q, k) * (Dh ** -0.5)
    p = _softmax(scores, axis=-1)
    o = torch.einsum("bhqk,bhkd->bhqd", p, v)
    return (lambda x, *d: x.permute(*d))(o, 0, 2, 1, 3).reshape(B, Sq, Hq * Dh) @ wo
```

```asm
; @launch grid=(256,1,1) block=(256,1,1) lds=163840
.amdgcn_target "amdgcn-amd-amdhsa--gfx950"
.text
.globl standalone__gqa_block_cached__sampling_kernel
.p2align 8
.type standalone__gqa_block_cached__sampling_kernel,@function
standalone__gqa_block_cached__sampling_kernel:
L_codestart:
    s_cmp_ge_u32 s2, 256
    s_cbranch_scc1 L_end
    s_load_dwordx16 s[76:91], s[0:1], 0
    v_lshrrev_b32 v2, 6, v0
    v_and_b32 v1, 63, v0
    v_readfirstlane_b32 s36, v2
    s_and_b32 s37, s2, 7
    s_lshr_b32 s39, s2, 4
    s_bfe_u32 s38, s2, 0x10003
    v_lshrrev_b32 v2, 4, v1
    v_and_b32 v3, 15, v1
    s_lshl_b32 s42, s36, 12
    s_add_u32 s43, s42, 65536
    s_cmp_eq_u32 s38, 0
    s_cbranch_scc1 L_prod
    v_lshlrev_b32 v4, 8, v2
    v_add_u32 v4, s42, v4
    v_xor_b32 v5, v3, v2
    v_xor_b32 v6, 0, v5
    v_lshl_add_u32 v22, v6, 4, v4
    v_xor_b32 v6, 4, v5
    v_lshl_add_u32 v23, v6, 4, v4
    v_xor_b32 v6, 8, v5
    v_lshl_add_u32 v24, v6, 4, v4
    v_xor_b32 v6, 12, v5
    v_lshl_add_u32 v25, v6, 4, v4
    v_lshlrev_b32 v6, 1, v2
    v_xor_b32 v6, v3, v6
    v_lshl_add_u32 v26, v6, 4, v4
    v_xor_b32 v27, 128, v26
    s_waitcnt lgkmcnt(0)
    s_mov_b32 s24, s82
    s_mov_b32 s25, s83
    s_mov_b32 s26, 4194304
    s_mov_b32 s27, 0x20000
    s_mov_b32 s20, s76
    s_mov_b32 s21, s77
    s_mov_b32 s22, 524288
    s_mov_b32 s23, 0x20000
    s_lshr_b32 s4, s39, 2
    s_and_b32 s5, s39, 3
    s_add_u32 s4, s4, s5
    s_lshl_b32 s4, s4, 1
    s_add_u32 s4, s4, 1
    s_and_b32 s4, s4, 7
    s_cmp_lt_u32 s36, 2
    s_cbranch_scc0 L_tx
    v_lshrrev_b32 v8, 1, v0
    v_lshlrev_b32 v8, 13, v8
    v_and_b32 v9, 1, v0
    v_lshl_add_u32 v8, v9, 7, v8
    s_lshl_b32 s6, s37, 2
    s_add_u32 s6, s6, s5
    s_lshl_b32 s6, s6, 8
    s_lshl_b32 s4, s4, 19
    s_add_u32 s6, s6, s4
    buffer_load_dword v9, v8, s[24:27], s6 offen
    s_branch L_td
L_tx:
    v_subrev_u32 v8, 128, v0
    v_lshlrev_b32 v8, 10, v8
    s_and_b32 s6, s39, 12
    s_lshl_b32 s6, s6, 15
    s_lshl_b32 s4, s4, 7
    s_add_u32 s6, s6, s4
    buffer_load_dword v9, v8, s[20:23], s6 offen
L_td:
    s_lshl_b32 s3, s39, 3
    s_add_u32 s3, s3, s37
    s_lshl_b32 s3, s3, 1
    s_add_u32 s3, s3, s38
    s_lshl_b32 s3, s3, 19
    s_add_u32 s8, s78, s3
    s_addc_u32 s9, s79, 0
    s_add_u32 s12, s80, s3
    s_addc_u32 s13, s81, 0
    s_mov_b32 s10, 524288
    s_mov_b32 s11, 0x20000
    s_mov_b32 s14, 524288
    s_mov_b32 s15, 0x20000
    s_mov_b32 s40, 0
    s_mov_b32 s41, 0
    s_add_u32 m0, s42, 0
    s_nop 0
    buffer_load_dwordx4 v22, s[8:11], s40 offen offset:0 nt lds
    buffer_load_dwordx4 v23, s[8:11], s40 offen offset:1024 nt lds
    buffer_load_dwordx4 v24, s[8:11], s40 offen offset:2048 nt lds
    buffer_load_dwordx4 v25, s[8:11], s40 offen offset:3072 nt lds
    s_add_u32 s40, s40, 16384
    s_add_u32 m0, s42, 16384
    s_nop 0
    buffer_load_dwordx4 v22, s[8:11], s40 offen offset:0 nt lds
    buffer_load_dwordx4 v23, s[8:11], s40 offen offset:1024 nt lds
    buffer_load_dwordx4 v24, s[8:11], s40 offen offset:2048 nt lds
    buffer_load_dwordx4 v25, s[8:11], s40 offen offset:3072 nt lds
    s_add_u32 s40, s40, 16384
    s_branch L_cons
L_prod:
    v_and_b32 v5, 7, v1
    v_xor_b32 v5, v5, v2
    v_lshrrev_b32 v4, 3, v1
    v_lshlrev_b32 v4, 10, v4
    v_lshl_add_u32 v96, v5, 4, v4
    v_xor_b32 v4, 64, v96
    v_add_u32 v97, 7168, v4
    v_add_u32 v98, 14336, v96
    v_add_u32 v99, 21504, v4
    v_lshlrev_b32 v4, 2, v2
    v_xor_b32 v5, v3, v4
    s_lshl_b32 s4, s36, 4
    v_add_u32 v4, s4, v2
    v_lshlrev_b32 v4, 13, v4
    v_lshl_add_u32 v100, v5, 4, v4
    v_add_u32 v101, 31744, v100
    v_add_u32 v102, 63488, v100
    v_add_u32 v103, 95232, v100
    s_lshr_b32 s4, s39, 2
    s_and_b32 s5, s39, 3
    s_add_u32 s4, s4, s5
    s_lshl_b32 s4, s4, 8
    s_and_b32 s99, s4, 1023
    s_and_b32 s4, s39, 12
    s_add_u32 s4, s4, s36
    s_lshl_b32 s6, s4, 15
    s_lshl_b32 s4, s37, 2
    s_add_u32 s4, s4, s5
    s_lshl_b32 s7, s4, 8
    s_mov_b32 s22, 32768
    s_mov_b32 s23, 0x20000
    s_sub_u32 s26, 4194304, s7
    s_mov_b32 s27, 0x20000
    s_waitcnt lgkmcnt(0)
    s_add_u32 s24, s82, s7
    s_addc_u32 s25, s83, 0
    s_add_u32 s20, s76, s6
    s_addc_u32 s21, s77, 0
    s_add_u32 m0, s43, 0
    s_lshl_b32 s100, s99, 12
    buffer_load_dwordx4 v100, s[24:27], s100 offen offset:0 lds
    buffer_load_dwordx4 v101, s[24:27], s100 offen offset:1024 lds
    buffer_load_dwordx4 v102, s[24:27], s100 offen offset:2048 lds
    buffer_load_dwordx4 v103, s[24:27], s100 offen offset:3072 lds
    s_add_u32 m0, s42, 0
    s_nop 0
    buffer_load_dwordx4 v96, s[20:23], s99 offen offset:0 lds
    buffer_load_dwordx4 v97, s[20:23], s99 offen offset:1024 lds
    buffer_load_dwordx4 v98, s[20:23], s99 offen offset:2048 lds
    buffer_load_dwordx4 v99, s[20:23], s99 offen offset:3072 lds
    s_add_u32 s99, s99, 128
    s_and_b32 s99, s99, 1023
    s_lshl_b32 s4, s39, 7
    s_and_b32 s5, s39, 12
    s_add_u32 s5, s5, s36
    s_lshl_b32 s5, s5, 7
    s_load_dword s46, s[90:91], s4
    s_load_dword s47, s[90:91], s5
    s_add_u32 m0, s43, 16384
    s_lshl_b32 s100, s99, 12
    buffer_load_dwordx4 v100, s[24:27], s100 offen offset:0 lds
    buffer_load_dwordx4 v101, s[24:27], s100 offen offset:1024 lds
    buffer_load_dwordx4 v102, s[24:27], s100 offen offset:2048 lds
    buffer_load_dwordx4 v103, s[24:27], s100 offen offset:3072 lds
    s_add_u32 m0, s42, 16384
    s_nop 0
    buffer_load_dwordx4 v96, s[20:23], s99 offen offset:0 lds
    buffer_load_dwordx4 v97, s[20:23], s99 offen offset:1024 lds
    buffer_load_dwordx4 v98, s[20:23], s99 offen offset:2048 lds
    buffer_load_dwordx4 v99, s[20:23], s99 offen offset:3072 lds
    s_add_u32 s99, s99, 128
    s_and_b32 s99, s99, 1023
    v_and_b32 v4, 31, v1
    v_lshrrev_b32 v5, 5, v1
    v_bfe_u32 v6, v1, 1, 3
    v_xor_b32 v6, v6, v5
    v_lshlrev_b32 v6, 4, v6
    v_lshl_add_u32 v6, v4, 7, v6
    v_add_u32 v6, s42, v6
    v_xor_b32 v104, 0, v6
    v_xor_b32 v105, 32, v6
    v_xor_b32 v106, 64, v6
    v_xor_b32 v107, 96, v6
    v_bfe_u32 v6, v1, 4, 1
    v_lshlrev_b32 v9, 12, v6
    v_lshl_add_u32 v9, v5, 8, v9
    v_lshl_add_u32 v9, v3, 4, v9
    v_bfe_u32 v4, v1, 2, 2
    v_lshl_add_u32 v5, v5, 3, v4
    v_lshlrev_b32 v5, 8, v5
    v_lshl_add_u32 v5, v4, 6, v5
    v_lshl_add_u32 v5, v6, 5, v5
    v_and_b32 v6, 1, v1
    v_lshl_add_u32 v5, v6, 4, v5
    v_bfe_u32 v6, v1, 1, 1
    v_lshl_add_u32 v5, v6, 3, v5
    v_add_u32 v5, 65536, v5
    v_xor_b32 v108, 0, v5
    v_xor_b32 v109, 64, v5
    v_xor_b32 v110, 128, v5
    v_xor_b32 v111, 192, v5
    s_waitcnt vmcnt(8) lgkmcnt(0)
    s_barrier
    ds_read_b128 v[128:131], v104 offset:0
    ds_read_b128 v[132:135], v105 offset:0
    ds_read_b128 v[136:139], v106 offset:0
    ds_read_b128 v[140:143], v107 offset:0
    ds_read_b64_tr_b16 v[52:53], v108 offset:0
    ds_read_b64_tr_b16 v[54:55], v108 offset:1024
    ds_read_b64_tr_b16 v[56:57], v109 offset:0
    ds_read_b64_tr_b16 v[58:59], v109 offset:1024
    ds_read_b64_tr_b16 v[60:61], v110 offset:0
    ds_read_b64_tr_b16 v[62:63], v110 offset:1024
    ds_read_b64_tr_b16 v[64:65], v111 offset:0
    ds_read_b64_tr_b16 v[66:67], v111 offset:1024
    s_waitcnt lgkmcnt(4)
    v_mfma_f32_32x32x16_bf16 v[192:207], v[52:55], v[128:131], 0
    ds_read_b64_tr_b16 v[68:69], v108 offset:4096
    ds_read_b64_tr_b16 v[70:71], v108 offset:5120
    s_add_u32 m0, s43, 32768
    s_lshl_b32 s100, s99, 12
    buffer_load_dwordx4 v100, s[24:27], s100 offen offset:0 lds
    v_mfma_f32_32x32x16_bf16 v[208:223], v[56:59], v[128:131], 0
    ds_read_b64_tr_b16 v[72:73], v109 offset:4096
    ds_read_b64_tr_b16 v[74:75], v109 offset:5120
    buffer_load_dwordx4 v101, s[24:27], s100 offen offset:1024 lds
    buffer_load_dwordx4 v102, s[24:27], s100 offen offset:2048 lds
    s_waitcnt lgkmcnt(4)
    v_mfma_f32_32x32x16_bf16 v[224:239], v[60:63], v[128:131], 0
    ds_read_b64_tr_b16 v[76:77], v110 offset:4096
    ds_read_b64_tr_b16 v[78:79], v110 offset:5120
    buffer_load_dwordx4 v103, s[24:27], s100 offen offset:3072 lds
    s_add_u32 m0, s42, 32768
    v_mfma_f32_32x32x16_bf16 v[240:255], v[64:67], v[128:131], 0
    ds_read_b64_tr_b16 v[80:81], v111 offset:4096
    ds_read_b64_tr_b16 v[82:83], v111 offset:5120
    s_nop 0
    buffer_load_dwordx4 v96, s[20:23], s99 offen offset:0 lds
    buffer_load_dwordx4 v97, s[20:23], s99 offen offset:1024 lds
    s_waitcnt lgkmcnt(4)
    v_mfma_f32_32x32x16_bf16 v[192:207], v[68:71], v[132:135], v[192:207]
    ds_read_b64_tr_b16 v[52:53], v108 offset:8192
    ds_read_b64_tr_b16 v[54:55], v108 offset:9216
    buffer_load_dwordx4 v98, s[20:23], s99 offen offset:2048 lds
    buffer_load_dwordx4 v99, s[20:23], s99 offen offset:3072 lds
    v_mfma_f32_32x32x16_bf16 v[208:223], v[72:75], v[132:135], v[208:223]
    ds_read_b64_tr_b16 v[56:57], v109 offset:8192
    ds_read_b64_tr_b16 v[58:59], v109 offset:9216
    s_add_u32 s99, s99, 128
    s_and_b32 s99, s99, 1023
    s_waitcnt lgkmcnt(4)
    v_mfma_f32_32x32x16_bf16 v[224:239], v[76:79], v[132:135], v[224:239]
    ds_read_b64_tr_b16 v[60:61], v110 offset:8192
    ds_read_b64_tr_b16 v[62:63], v110 offset:9216
    s_add_u32 m0, s43, 49152
    s_lshl_b32 s100, s99, 12
    buffer_load_dwordx4 v100, s[24:27], s100 offen offset:0 lds
    v_mfma_f32_32x32x16_bf16 v[240:255], v[80:83], v[132:135], v[240:255]
    ds_read_b64_tr_b16 v[64:65], v111 offset:8192
    ds_read_b64_tr_b16 v[66:67], v111 offset:9216
    buffer_load_dwordx4 v101, s[24:27], s100 offen offset:1024 lds
    buffer_load_dwordx4 v102, s[24:27], s100 offen offset:2048 lds
    s_waitcnt lgkmcnt(4)
    v_mfma_f32_32x32x16_bf16 v[192:207], v[52:55], v[136:139], v[192:207]
    ds_read_b64_tr_b16 v[68:69], v108 offset:12288
    ds_read_b64_tr_b16 v[70:71], v108 offset:13312
    buffer_load_dwordx4 v103, s[24:27], s100 offen offset:3072 lds
    s_add_u32 m0, s42, 49152
    v_mfma_f32_32x32x16_bf16 v[208:223], v[56:59], v[136:139], v[208:223]
    ds_read_b64_tr_b16 v[72:73], v109 offset:12288
    ds_read_b64_tr_b16 v[74:75], v109 offset:13312
    s_nop 0
    buffer_load_dwordx4 v96, s[20:23], s99 offen offset:0 lds
    buffer_load_dwordx4 v97, s[20:23], s99 offen offset:1024 lds
    s_waitcnt lgkmcnt(4)
    v_mfma_f32_32x32x16_bf16 v[224:239], v[60:63], v[136:139], v[224:239]
    ds_read_b64_tr_b16 v[76:77], v110 offset:12288
    ds_read_b64_tr_b16 v[78:79], v110 offset:13312
    buffer_load_dwordx4 v98, s[20:23], s99 offen offset:2048 lds
    buffer_load_dwordx4 v99, s[20:23], s99 offen offset:3072 lds
    v_mfma_f32_32x32x16_bf16 v[240:255], v[64:67], v[136:139], v[240:255]
    ds_read_b64_tr_b16 v[80:81], v111 offset:12288
    ds_read_b64_tr_b16 v[82:83], v111 offset:13312
    s_add_u32 s99, s99, 128
    s_and_b32 s99, s99, 1023
    s_waitcnt lgkmcnt(4)
    v_mfma_f32_32x32x16_bf16 v[192:207], v[68:71], v[140:143], v[192:207]
    s_waitcnt vmcnt(16) lgkmcnt(0)
    s_barrier
    ds_read_b128 v[144:147], v104 offset:16384
    ds_read_b128 v[148:151], v105 offset:16384
    ds_read_b64_tr_b16 v[52:53], v108 offset:16384
    ds_read_b64_tr_b16 v[54:55], v108 offset:17408
    v_mfma_f32_32x32x16_bf16 v[208:223], v[72:75], v[140:143], v[208:223]
    ds_read_b64_tr_b16 v[56:57], v109 offset:16384
    ds_read_b64_tr_b16 v[58:59], v109 offset:17408
    ds_read_b128 v[152:155], v106 offset:16384
    ds_read_b128 v[156:159], v107 offset:16384
    v_mfma_f32_32x32x16_bf16 v[224:239], v[76:79], v[140:143], v[224:239]
    ds_read_b64_tr_b16 v[60:61], v110 offset:16384
    ds_read_b64_tr_b16 v[62:63], v110 offset:17408
    v_mfma_f32_32x32x16_bf16 v[240:255], v[80:83], v[140:143], v[240:255]
    ds_read_b64_tr_b16 v[64:65], v111 offset:16384
    ds_read_b64_tr_b16 v[66:67], v111 offset:17408
    s_waitcnt lgkmcnt(6)
    v_mfma_f32_32x32x16_bf16 v[192:207], v[52:55], v[144:147], v[192:207]
    ds_read_b64_tr_b16 v[68:69], v108 offset:20480
    ds_read_b64_tr_b16 v[70:71], v108 offset:21504
    s_add_u32 m0, s43, 0
    s_lshl_b32 s100, s99, 12
    s_mov_b32 s16, s90
    s_mov_b32 s17, s91
    s_mov_b32 s18, 536870912
    v_mfma_f32_32x32x16_bf16 v[208:223], v[56:59], v[144:147], v[208:223]
    ds_read_b64_tr_b16 v[72:73], v109 offset:20480
    ds_read_b64_tr_b16 v[74:75], v109 offset:21504
    buffer_load_dwordx4 v100, s[24:27], s100 offen offset:0 lds
    s_mov_b32 s19, 0x20000
    s_mov_b32 s28, s84
    s_mov_b32 s29, s85
    s_waitcnt lgkmcnt(4)
    v_mfma_f32_32x32x16_bf16 v[224:239], v[60:63], v[144:147], v[224:239]
    ds_read_b64_tr_b16 v[76:77], v110 offset:20480
    ds_read_b64_tr_b16 v[78:79], v110 offset:21504
    buffer_load_dwordx4 v101, s[24:27], s100 offen offset:1024 lds
    s_mov_b32 s30, 4194304
    s_mov_b32 s31, 0x20000
    v_mfma_f32_32x32x16_bf16 v[240:255], v[64:67], v[144:147], v[240:255]
    ds_read_b64_tr_b16 v[80:81], v111 offset:20480
    ds_read_b64_tr_b16 v[82:83], v111 offset:21504
    buffer_load_dwordx4 v102, s[24:27], s100 offen offset:2048 lds
    s_mov_b32 s32, s86
    s_mov_b32 s33, s87
    s_mov_b32 s34, 524288
    s_waitcnt lgkmcnt(4)
    v_mfma_f32_32x32x16_bf16 v[192:207], v[68:71], v[148:151], v[192:207]
    ds_read_b64_tr_b16 v[52:53], v108 offset:24576
    ds_read_b64_tr_b16 v[54:55], v108 offset:25600
    buffer_load_dwordx4 v103, s[24:27], s100 offen offset:3072 lds
    s_mov_b32 s35, 0x20000
    s_lshl_b32 s3, s39, 3
    s_add_u32 s3, s3, s37
    v_mfma_f32_32x32x16_bf16 v[208:223], v[72:75], v[148:151], v[208:223]
    ds_read_b64_tr_b16 v[56:57], v109 offset:24576
    ds_read_b64_tr_b16 v[58:59], v109 offset:25600
    s_add_u32 m0, s42, 0
    s_lshl_b32 s3, s3, 1
    s_add_u32 s3, s3, s38
    s_waitcnt lgkmcnt(4)
    v_mfma_f32_32x32x16_bf16 v[224:239], v[76:79], v[148:151], v[224:239]
    ds_read_b64_tr_b16 v[60:61], v110 offset:24576
    ds_read_b64_tr_b16 v[62:63], v110 offset:25600
    s_nop 0
    buffer_load_dwordx4 v96, s[20:23], s99 offen offset:0 lds
    s_lshl_b32 s3, s3, 19
    s_add_u32 s8, s78, s3
    s_addc_u32 s9, s79, 0
    s_add_u32 s12, s80, s3
    s_addc_u32 s13, s81, 0
    v_mfma_f32_32x32x16_bf16 v[240:255], v[80:83], v[148:151], v[240:255]
    ds_read_b64_tr_b16 v[64:65], v111 offset:24576
    ds_read_b64_tr_b16 v[66:67], v111 offset:25600
    buffer_load_dwordx4 v97, s[20:23], s99 offen offset:1024 lds
    s_mov_b32 s10, 524288
    s_mov_b32 s11, 0x20000
    s_waitcnt lgkmcnt(4)
    v_mfma_f32_32x32x16_bf16 v[192:207], v[52:55], v[152:155], v[192:207]
    ds_read_b64_tr_b16 v[68:69], v108 offset:28672
    ds_read_b64_tr_b16 v[70:71], v108 offset:29696
    buffer_load_dwordx4 v98, s[20:23], s99 offen offset:2048 lds
    s_mov_b32 s14, 524288
    s_mov_b32 s15, 0x20000
    s_mov_b32 s40, 0
    v_mfma_f32_32x32x16_bf16 v[208:223], v[56:59], v[152:155], v[208:223]
    ds_read_b64_tr_b16 v[72:73], v109 offset:28672
    ds_read_b64_tr_b16 v[74:75], v109 offset:29696
    buffer_load_dwordx4 v99, s[20:23], s99 offen offset:3072 lds
    s_mov_b32 s41, 0
    v_lshlrev_b32 v4, 8, v2
    v_add_u32 v4, s42, v4
    s_waitcnt lgkmcnt(4)
    v_mfma_f32_32x32x16_bf16 v[224:239], v[60:63], v[152:155], v[224:239]
    ds_read_b64_tr_b16 v[76:77], v110 offset:28672
    ds_read_b64_tr_b16 v[78:79], v110 offset:29696
    s_add_u32 s99, s99, 128
    v_xor_b32 v5, v3, v2
    v_xor_b32 v6, 0, v5
    v_mfma_f32_32x32x16_bf16 v[240:255], v[64:67], v[152:155], v[240:255]
    ds_read_b64_tr_b16 v[80:81], v111 offset:28672
    ds_read_b64_tr_b16 v[82:83], v111 offset:29696
    s_and_b32 s99, s99, 1023
    v_lshl_add_u32 v22, v6, 4, v4
    v_xor_b32 v6, 4, v5
    v_lshl_add_u32 v23, v6, 4, v4
    s_waitcnt lgkmcnt(4)
    v_mfma_f32_32x32x16_bf16 v[192:207], v[68:71], v[156:159], v[192:207]
    v_xor_b32 v6, 8, v5
    v_lshl_add_u32 v24, v6, 4, v4
    v_xor_b32 v6, 12, v5
    s_waitcnt vmcnt(16) lgkmcnt(0)
    s_barrier
    ds_read_b128 v[128:131], v104 offset:32768
    ds_read_b128 v[132:135], v105 offset:32768
    ds_read_b64_tr_b16 v[52:53], v108 offset:32768
    ds_read_b64_tr_b16 v[54:55], v108 offset:33792
    v_mfma_f32_32x32x16_bf16 v[208:223], v[72:75], v[156:159], v[208:223]
    v_lshl_add_u32 v25, v6, 4, v4
    v_lshlrev_b32 v6, 1, v2
    ds_read_b64_tr_b16 v[56:57], v109 offset:32768
    ds_read_b64_tr_b16 v[58:59], v109 offset:33792
    ds_read_b128 v[136:139], v106 offset:32768
    ds_read_b128 v[140:143], v107 offset:32768
    v_mfma_f32_32x32x16_bf16 v[224:239], v[76:79], v[156:159], v[224:239]
    v_xor_b32 v6, v3, v6
    v_lshl_add_u32 v26, v6, 4, v4
    v_xor_b32 v27, 128, v26
    ds_read_b64_tr_b16 v[60:61], v110 offset:32768
    ds_read_b64_tr_b16 v[62:63], v110 offset:33792
    v_mfma_f32_32x32x16_bf16 v[240:255], v[80:83], v[156:159], v[240:255]
    v_xor_b32 v4, v3, v2
    v_lshlrev_b32 v4, 4, v4
    ds_read_b64_tr_b16 v[64:65], v111 offset:32768
    ds_read_b64_tr_b16 v[66:67], v111 offset:33792
    s_waitcnt lgkmcnt(6)
    v_mfma_f32_32x32x16_bf16 v[192:207], v[52:55], v[128:131], v[192:207]
    ds_read_b64_tr_b16 v[68:69], v108 offset:36864
    ds_read_b64_tr_b16 v[70:71], v108 offset:37888
    s_add_u32 m0, s43, 16384
    s_lshl_b32 s100, s99, 12
    v_lshl_add_u32 v4, v3, 8, v4
    v_xor_b32 v10, 0, v4
    v_xor_b32 v11, 64, v4
    v_mfma_f32_32x32x16_bf16 v[208:223], v[56:59], v[128:131], v[208:223]
    ds_read_b64_tr_b16 v[72:73], v109 offset:36864
    ds_read_b64_tr_b16 v[74:75], v109 offset:37888
    buffer_load_dwordx4 v100, s[24:27], s100 offen offset:0 lds
    v_xor_b32 v12, 128, v4
    v_xor_b32 v13, 192, v4
    v_lshrrev_b32 v4, 2, v1
    s_waitcnt lgkmcnt(4)
    v_mfma_f32_32x32x16_bf16 v[224:239], v[60:63], v[128:131], v[224:239]
    ds_read_b64_tr_b16 v[76:77], v110 offset:36864
    ds_read_b64_tr_b16 v[78:79], v110 offset:37888
    buffer_load_dwordx4 v101, s[24:27], s100 offen offset:1024 lds
    v_and_b32 v5, 7, v4
    v_lshlrev_b32 v5, 5, v5
    v_mfma_f32_32x32x16_bf16 v[240:255], v[64:67], v[128:131], v[240:255]
    ds_read_b64_tr_b16 v[80:81], v111 offset:36864
    ds_read_b64_tr_b16 v[82:83], v111 offset:37888
    buffer_load_dwordx4 v102, s[24:27], s100 offen offset:2048 lds
    v_lshl_add_u32 v5, v4, 8, v5
    v_and_b32 v6, 3, v1
    v_lshl_add_u32 v5, v6, 3, v5
    s_waitcnt lgkmcnt(4)
    v_mfma_f32_32x32x16_bf16 v[192:207], v[68:71], v[132:135], v[192:207]
    ds_read_b64_tr_b16 v[52:53], v108 offset:40960
    ds_read_b64_tr_b16 v[54:55], v108 offset:41984
    buffer_load_dwordx4 v103, s[24:27], s100 offen offset:3072 lds
    v_add_u32 v5, 65536, v5
    s_lshl_b32 s4, s38, 7
    v_xor_b32 v5, s4, v5
    v_mfma_f32_32x32x16_bf16 v[208:223], v[72:75], v[132:135], v[208:223]
    ds_read_b64_tr_b16 v[56:57], v109 offset:40960
    ds_read_b64_tr_b16 v[58:59], v109 offset:41984
    s_add_u32 m0, s42, 16384
    v_xor_b32 v14, 0, v5
    v_xor_b32 v15, 32, v5
    s_waitcnt lgkmcnt(4)
    v_mfma_f32_32x32x16_bf16 v[224:239], v[76:79], v[132:135], v[224:239]
    ds_read_b64_tr_b16 v[60:61], v110 offset:40960
    ds_read_b64_tr_b16 v[62:63], v110 offset:41984
    s_nop 0
    buffer_load_dwordx4 v96, s[20:23], s99 offen offset:0 lds
    v_xor_b32 v16, 64, v5
    v_xor_b32 v17, 96, v5
    v_xor_b32 v18, 128, v5
    v_mfma_f32_32x32x16_bf16 v[240:255], v[80:83], v[132:135], v[240:255]
    ds_read_b64_tr_b16 v[64:65], v111 offset:40960
    ds_read_b64_tr_b16 v[66:67], v111 offset:41984
    buffer_load_dwordx4 v97, s[20:23], s99 offen offset:1024 lds
    v_xor_b32 v19, 160, v5
    v_xor_b32 v20, 192, v5
    s_waitcnt lgkmcnt(4)
    v_mfma_f32_32x32x16_bf16 v[192:207], v[52:55], v[136:139], v[192:207]
    ds_read_b64_tr_b16 v[68:69], v108 offset:45056
    ds_read_b64_tr_b16 v[70:71], v108 offset:46080
    buffer_load_dwordx4 v98, s[20:23], s99 offen offset:2048 lds
    v_xor_b32 v21, 224, v5
    v_lshlrev_b32 v6, 1, v2
    v_xor_b32 v6, v3, v6
    v_mfma_f32_32x32x16_bf16 v[208:223], v[56:59], v[136:139], v[208:223]
    ds_read_b64_tr_b16 v[72:73], v109 offset:45056
    ds_read_b64_tr_b16 v[74:75], v109 offset:46080
    buffer_load_dwordx4 v99, s[20:23], s99 offen offset:3072 lds
    v_lshlrev_b32 v6, 4, v6
    v_lshl_add_u32 v6, v2, 10, v6
    s_lshl_b32 s4, s36, 8
    s_waitcnt lgkmcnt(4)
    v_mfma_f32_32x32x16_bf16 v[224:239], v[60:63], v[136:139], v[224:239]
    ds_read_b64_tr_b16 v[76:77], v110 offset:45056
    ds_read_b64_tr_b16 v[78:79], v110 offset:46080
    s_add_u32 s99, s99, 128
    v_add_u32 v30, s4, v6
    v_xor_b32 v6, 128, v30
    v_mfma_f32_32x32x16_bf16 v[240:255], v[64:67], v[136:139], v[240:255]
    ds_read_b64_tr_b16 v[80:81], v111 offset:45056
    ds_read_b64_tr_b16 v[82:83], v111 offset:46080
    s_and_b32 s99, s99, 1023
    v_add_u32 v31, 3072, v6
    s_lshl_b32 s94, s37, 19
    s_lshl_b32 s4, s38, 16
    s_waitcnt lgkmcnt(4)
    v_mfma_f32_32x32x16_bf16 v[192:207], v[68:71], v[140:143], v[192:207]
    s_add_u32 s94, s94, s4
    s_lshl_b32 s84, s36, 13
    s_add_u32 s86, s84, 65536
    s_waitcnt vmcnt(16) lgkmcnt(0)
    s_barrier
    ds_read_b128 v[144:147], v104 offset:49152
    ds_read_b128 v[148:151], v105 offset:49152
    ds_read_b64_tr_b16 v[52:53], v108 offset:49152
    ds_read_b64_tr_b16 v[54:55], v108 offset:50176
    v_mfma_f32_32x32x16_bf16 v[208:223], v[72:75], v[140:143], v[208:223]
    s_add_u32 s84, s84, 131072
    v_mov_b32 v84, 0x3f803f80
    ds_read_b64_tr_b16 v[56:57], v109 offset:49152
    ds_read_b64_tr_b16 v[58:59], v109 offset:50176
    ds_read_b128 v[152:155], v106 offset:49152
    ds_read_b128 v[156:159], v107 offset:49152
    v_mfma_f32_32x32x16_bf16 v[224:239], v[76:79], v[140:143], v[224:239]
    v_mov_b32 v85, v84
    v_mov_b32 v86, v84
    v_mov_b32 v87, v84
    ds_read_b64_tr_b16 v[60:61], v110 offset:49152
    ds_read_b64_tr_b16 v[62:63], v110 offset:50176
    v_mfma_f32_32x32x16_bf16 v[240:255], v[80:83], v[140:143], v[240:255]
    s_lshr_b32 s4, s2, 3
    s_mul_i32 s4, s4, 7
    ds_read_b64_tr_b16 v[64:65], v111 offset:49152
    ds_read_b64_tr_b16 v[66:67], v111 offset:50176
    s_waitcnt lgkmcnt(6)
    v_mfma_f32_32x32x16_bf16 v[192:207], v[52:55], v[144:147], v[192:207]
    ds_read_b64_tr_b16 v[68:69], v108 offset:53248
    ds_read_b64_tr_b16 v[70:71], v108 offset:54272
    s_add_u32 m0, s43, 32768
    s_lshl_b32 s100, s99, 12
    s_lshr_b32 s4, s4, 5
    s_add_u32 s45, s4, 6
    s_mov_b32 s82, 16384
    v_mfma_f32_32x32x16_bf16 v[208:223], v[56:59], v[144:147], v[208:223]
    ds_read_b64_tr_b16 v[72:73], v109 offset:53248
    ds_read_b64_tr_b16 v[74:75], v109 offset:54272
    buffer_load_dwordx4 v100, s[24:27], s100 offen offset:0 lds
    s_add_u32 s46, s46, 0x9e3779b9
    s_add_u32 s47, s47, 0x9e3779b9
    s_and_b32 s4, s39, 12
    s_waitcnt lgkmcnt(4)
    v_mfma_f32_32x32x16_bf16 v[224:239], v[60:63], v[144:147], v[224:239]
    ds_read_b64_tr_b16 v[76:77], v110 offset:53248
    ds_read_b64_tr_b16 v[78:79], v110 offset:54272
    buffer_load_dwordx4 v101, s[24:27], s100 offen offset:1024 lds
    s_add_u32 s4, s4, s36
    s_and_b32 s5, s39, 3
    v_mfma_f32_32x32x16_bf16 v[240:255], v[64:67], v[144:147], v[240:255]
    ds_read_b64_tr_b16 v[80:81], v111 offset:53248
    ds_read_b64_tr_b16 v[82:83], v111 offset:54272
    buffer_load_dwordx4 v102, s[24:27], s100 offen offset:2048 lds
    s_lshl_b32 s4, s2, 2
    s_add_u32 s4, s4, s36
    s_xor_b32 s5, s4, 32
    s_waitcnt lgkmcnt(4)
    v_mfma_f32_32x32x16_bf16 v[192:207], v[68:71], v[148:151], v[192:207]
    ds_read_b64_tr_b16 v[52:53], v108 offset:57344
    ds_read_b64_tr_b16 v[54:55], v108 offset:58368
    buffer_load_dwordx4 v103, s[24:27], s100 offen offset:3072 lds
    s_lshl_b32 s48, s4, 13
    s_add_u32 s48, s48, 8388608
    s_lshl_b32 s49, s5, 13
    v_mfma_f32_32x32x16_bf16 v[208:223], v[72:75], v[148:151], v[208:223]
    ds_read_b64_tr_b16 v[56:57], v109 offset:57344
    ds_read_b64_tr_b16 v[58:59], v109 offset:58368
    s_add_u32 m0, s42, 32768
    s_add_u32 s49, s49, 8388608
    s_lshl_b32 s50, s4, 7
    s_waitcnt lgkmcnt(4)
    v_mfma_f32_32x32x16_bf16 v[224:239], v[76:79], v[148:151], v[224:239]
    ds_read_b64_tr_b16 v[60:61], v110 offset:57344
    ds_read_b64_tr_b16 v[62:63], v110 offset:58368
    s_nop 0
    buffer_load_dwordx4 v96, s[20:23], s99 offen offset:0 lds
    s_add_u32 s59, s50, 131072
    s_add_u32 s50, s50, 262144
    s_lshl_b32 s83, s5, 7
    v_mfma_f32_32x32x16_bf16 v[240:255], v[80:83], v[148:151], v[240:255]
    ds_read_b64_tr_b16 v[64:65], v111 offset:57344
    ds_read_b64_tr_b16 v[66:67], v111 offset:58368
    buffer_load_dwordx4 v97, s[20:23], s99 offen offset:1024 lds
    s_add_u32 s83, s83, 131072
    s_and_b32 s4, s2, 0xf0
    s_waitcnt lgkmcnt(4)
    v_mfma_f32_32x32x16_bf16 v[192:207], v[52:55], v[152:155], v[192:207]
    ds_read_b64_tr_b16 v[68:69], v108 offset:61440
    ds_read_b64_tr_b16 v[70:71], v108 offset:62464
    buffer_load_dwordx4 v98, s[20:23], s99 offen offset:2048 lds
    s_lshl_b32 s4, s4, 2
    s_bfe_u32 s5, s2, 0x20002
    s_add_u32 s4, s4, s5
    v_mfma_f32_32x32x16_bf16 v[208:223], v[56:59], v[152:155], v[208:223]
    ds_read_b64_tr_b16 v[72:73], v109 offset:61440
    ds_read_b64_tr_b16 v[74:75], v109 offset:62464
    buffer_load_dwordx4 v99, s[20:23], s99 offen offset:3072 lds
    s_lshl_b32 s4, s4, 7
    s_add_u32 s51, s4, 262144
    s_and_b32 s4, s2, 0xf0
    s_waitcnt lgkmcnt(4)
    v_mfma_f32_32x32x16_bf16 v[224:239], v[60:63], v[152:155], v[224:239]
    ds_read_b64_tr_b16 v[76:77], v110 offset:61440
    ds_read_b64_tr_b16 v[78:79], v110 offset:62464
    s_add_u32 s99, s99, 128
    s_lshl_b32 s5, s36, 2
    s_add_u32 s4, s4, s5
    v_mfma_f32_32x32x16_bf16 v[240:255], v[64:67], v[152:155], v[240:255]
    ds_read_b64_tr_b16 v[80:81], v111 offset:61440
    ds_read_b64_tr_b16 v[82:83], v111 offset:62464
    s_and_b32 s99, s99, 1023
    s_lshl_b32 s5, s38, 1
    s_and_b32 s7, s2, 15
    s_xor_b32 s6, s5, 0
    s_waitcnt lgkmcnt(4)
    v_mfma_f32_32x32x16_bf16 v[192:207], v[68:71], v[156:159], v[192:207]
    s_add_u32 s6, s6, s4
    s_lshl_b32 s6, s6, 4
    s_add_u32 s6, s6, s7
    s_waitcnt vmcnt(16) lgkmcnt(0)
    s_barrier
    ds_read_b128 v[128:131], v104 offset:0
    ds_read_b128 v[132:135], v105 offset:0
    ds_read_b64_tr_b16 v[52:53], v108 offset:0
    ds_read_b64_tr_b16 v[54:55], v108 offset:1024
    v_mfma_f32_32x32x16_bf16 v[208:223], v[72:75], v[156:159], v[208:223]
    s_lshl_b32 s6, s6, 11
    s_add_u32 s52, s6, 16777216
    ds_read_b64_tr_b16 v[56:57], v109 offset:0
    ds_read_b64_tr_b16 v[58:59], v109 offset:1024
    ds_read_b128 v[136:139], v106 offset:0
    ds_read_b128 v[140:143], v107 offset:0
    v_mfma_f32_32x32x16_bf16 v[224:239], v[76:79], v[156:159], v[224:239]
    s_xor_b32 s6, s5, 1
    s_add_u32 s6, s6, s4
    s_lshl_b32 s6, s6, 4
    ds_read_b64_tr_b16 v[60:61], v110 offset:0
    ds_read_b64_tr_b16 v[62:63], v110 offset:1024
    v_mfma_f32_32x32x16_bf16 v[240:255], v[80:83], v[156:159], v[240:255]
    s_add_u32 s6, s6, s7
    s_lshl_b32 s6, s6, 11
    ds_read_b64_tr_b16 v[64:65], v111 offset:0
    ds_read_b64_tr_b16 v[66:67], v111 offset:1024
    s_waitcnt lgkmcnt(6)
    v_mfma_f32_32x32x16_bf16 v[192:207], v[52:55], v[128:131], v[192:207]
    ds_read_b64_tr_b16 v[68:69], v108 offset:4096
    ds_read_b64_tr_b16 v[70:71], v108 offset:5120
    s_add_u32 m0, s43, 49152
    s_lshl_b32 s100, s99, 12
    s_add_u32 s53, s6, 16777216
    s_xor_b32 s6, s5, 2
    s_add_u32 s6, s6, s4
    v_mfma_f32_32x32x16_bf16 v[208:223], v[56:59], v[128:131], v[208:223]
    ds_read_b64_tr_b16 v[72:73], v109 offset:4096
    ds_read_b64_tr_b16 v[74:75], v109 offset:5120
    buffer_load_dwordx4 v100, s[24:27], s100 offen offset:0 lds
    s_lshl_b32 s6, s6, 4
    s_add_u32 s6, s6, s7
    s_waitcnt lgkmcnt(4)
    v_mfma_f32_32x32x16_bf16 v[224:239], v[60:63], v[128:131], v[224:239]
    ds_read_b64_tr_b16 v[76:77], v110 offset:4096
    ds_read_b64_tr_b16 v[78:79], v110 offset:5120
    buffer_load_dwordx4 v101, s[24:27], s100 offen offset:1024 lds
    s_lshl_b32 s6, s6, 11
    s_add_u32 s54, s6, 16777216
    s_xor_b32 s6, s5, 3
    v_mfma_f32_32x32x16_bf16 v[240:255], v[64:67], v[128:131], v[240:255]
    ds_read_b64_tr_b16 v[80:81], v111 offset:4096
    ds_read_b64_tr_b16 v[82:83], v111 offset:5120
    buffer_load_dwordx4 v102, s[24:27], s100 offen offset:2048 lds
    s_add_u32 s6, s6, s4
    s_lshl_b32 s6, s6, 4
    s_waitcnt lgkmcnt(4)
    v_mfma_f32_32x32x16_bf16 v[192:207], v[68:71], v[132:135], v[192:207]
    ds_read_b64_tr_b16 v[52:53], v108 offset:8192
    ds_read_b64_tr_b16 v[54:55], v108 offset:9216
    buffer_load_dwordx4 v103, s[24:27], s100 offen offset:3072 lds
    s_add_u32 s6, s6, s7
    s_lshl_b32 s6, s6, 11
    s_add_u32 s55, s6, 16777216
    v_mfma_f32_32x32x16_bf16 v[208:223], v[72:75], v[132:135], v[208:223]
    ds_read_b64_tr_b16 v[56:57], v109 offset:8192
    ds_read_b64_tr_b16 v[58:59], v109 offset:9216
    s_add_u32 m0, s42, 49152
    s_lshl_b32 s4, s2, 15
    s_lshl_b32 s5, s36, 9
    s_waitcnt lgkmcnt(4)
    v_mfma_f32_32x32x16_bf16 v[224:239], v[76:79], v[132:135], v[224:239]
    ds_read_b64_tr_b16 v[60:61], v110 offset:8192
    ds_read_b64_tr_b16 v[62:63], v110 offset:9216
    s_nop 0
    buffer_load_dwordx4 v96, s[20:23], s99 offen offset:0 lds
    s_add_u32 s4, s4, s5
    s_add_u32 s56, s4, 16777216
    s_lshr_b32 s4, s36, 1
    v_mfma_f32_32x32x16_bf16 v[240:255], v[80:83], v[132:135], v[240:255]
    ds_read_b64_tr_b16 v[64:65], v111 offset:8192
    ds_read_b64_tr_b16 v[66:67], v111 offset:9216
    buffer_load_dwordx4 v97, s[20:23], s99 offen offset:1024 lds
    s_lshl_b32 s4, s4, 14
    s_lshl_b32 s5, s39, 15
    s_waitcnt lgkmcnt(4)
    v_mfma_f32_32x32x16_bf16 v[192:207], v[52:55], v[136:139], v[192:207]
    ds_read_b64_tr_b16 v[68:69], v108 offset:12288
    ds_read_b64_tr_b16 v[70:71], v108 offset:13312
    buffer_load_dwordx4 v98, s[20:23], s99 offen offset:2048 lds
    s_add_u32 s4, s4, s5
    s_lshl_b32 s5, s7, 6
    v_mfma_f32_32x32x16_bf16 v[208:223], v[56:59], v[136:139], v[208:223]
    ds_read_b64_tr_b16 v[72:73], v109 offset:12288
    ds_read_b64_tr_b16 v[74:75], v109 offset:13312
    buffer_load_dwordx4 v99, s[20:23], s99 offen offset:3072 lds
    s_add_u32 s4, s4, s5
    s_and_b32 s5, s36, 1
    s_lshl_b32 s5, s5, 4
    s_waitcnt lgkmcnt(4)
    v_mfma_f32_32x32x16_bf16 v[224:239], v[60:63], v[136:139], v[224:239]
    ds_read_b64_tr_b16 v[76:77], v110 offset:12288
    ds_read_b64_tr_b16 v[78:79], v110 offset:13312
    s_add_u32 s99, s99, 128
    s_add_u32 s57, s4, s5
    s_lshl_b32 s58, s39, 7
    v_mfma_f32_32x32x16_bf16 v[240:255], v[64:67], v[136:139], v[240:255]
    ds_read_b64_tr_b16 v[80:81], v111 offset:12288
    ds_read_b64_tr_b16 v[82:83], v111 offset:13312
    s_and_b32 s99, s99, 1023
    s_and_b32 s4, s39, 12
    s_add_u32 s4, s4, s36
    s_and_b32 s5, s39, 3
    s_waitcnt lgkmcnt(4)
    v_mfma_f32_32x32x16_bf16 v[192:207], v[68:71], v[140:143], v[192:207]
    s_lshl_b32 s96, s4, 3
    s_add_u32 s96, s96, s37
    s_waitcnt vmcnt(16) lgkmcnt(0)
    s_barrier
    ds_read_b128 v[144:147], v104 offset:16384
    ds_read_b128 v[148:151], v105 offset:16384
    ds_read_b64_tr_b16 v[52:53], v108 offset:16384
    ds_read_b64_tr_b16 v[54:55], v108 offset:17408
    v_mfma_f32_32x32x16_bf16 v[208:223], v[72:75], v[140:143], v[208:223]
    s_lshl_b32 s96, s96, 2
    s_add_u32 s96, s96, s5
    s_lshl_b32 s97, s96, 7
    ds_read_b64_tr_b16 v[56:57], v109 offset:16384
    ds_read_b64_tr_b16 v[58:59], v109 offset:17408
    ds_read_b128 v[152:155], v106 offset:16384
    ds_read_b128 v[156:159], v107 offset:16384
    v_mfma_f32_32x32x16_bf16 v[224:239], v[76:79], v[140:143], v[224:239]
    s_add_u32 s97, s97, 65536
    s_lshl_b32 s98, s96, 13
    ds_read_b64_tr_b16 v[60:61], v110 offset:16384
    ds_read_b64_tr_b16 v[62:63], v110 offset:17408
    v_mfma_f32_32x32x16_bf16 v[240:255], v[80:83], v[140:143], v[240:255]
    s_add_u32 s98, s98, 1048576
    s_mov_b32 s6, 0x3e0293ee
    ds_read_b64_tr_b16 v[64:65], v111 offset:16384
    ds_read_b64_tr_b16 v[66:67], v111 offset:17408
    s_waitcnt lgkmcnt(6)
    v_mfma_f32_32x32x16_bf16 v[192:207], v[52:55], v[144:147], v[192:207]
    ds_read_b64_tr_b16 v[68:69], v108 offset:20480
    ds_read_b64_tr_b16 v[70:71], v108 offset:21504
    s_add_u32 m0, s42, 0
    v_mfma_f32_32x32x16_bf16 v[208:223], v[56:59], v[144:147], v[208:223]
    ds_read_b64_tr_b16 v[72:73], v109 offset:20480
    ds_read_b64_tr_b16 v[74:75], v109 offset:21504
    s_nop 0
    s_waitcnt lgkmcnt(4)
    v_mfma_f32_32x32x16_bf16 v[224:239], v[60:63], v[144:147], v[224:239]
    ds_read_b64_tr_b16 v[76:77], v110 offset:20480
    ds_read_b64_tr_b16 v[78:79], v110 offset:21504
    v_mfma_f32_32x32x16_bf16 v[240:255], v[64:67], v[144:147], v[240:255]
    ds_read_b64_tr_b16 v[80:81], v111 offset:20480
    ds_read_b64_tr_b16 v[82:83], v111 offset:21504
    buffer_load_dwordx4 v22, s[8:11], s40 offen offset:0 nt lds
    s_waitcnt lgkmcnt(4)
    v_mfma_f32_32x32x16_bf16 v[192:207], v[68:71], v[148:151], v[192:207]
    ds_read_b64_tr_b16 v[52:53], v108 offset:24576
    ds_read_b64_tr_b16 v[54:55], v108 offset:25600
    v_mfma_f32_32x32x16_bf16 v[208:223], v[72:75], v[148:151], v[208:223]
    ds_read_b64_tr_b16 v[56:57], v109 offset:24576
    ds_read_b64_tr_b16 v[58:59], v109 offset:25600
    buffer_load_dwordx4 v23, s[8:11], s40 offen offset:1024 nt lds
    s_waitcnt lgkmcnt(4)
    v_mfma_f32_32x32x16_bf16 v[224:239], v[76:79], v[148:151], v[224:239]
    ds_read_b64_tr_b16 v[60:61], v110 offset:24576
    ds_read_b64_tr_b16 v[62:63], v110 offset:25600
    buffer_load_dwordx4 v24, s[8:11], s40 offen offset:2048 nt lds
    v_mfma_f32_32x32x16_bf16 v[240:255], v[80:83], v[148:151], v[240:255]
    ds_read_b64_tr_b16 v[64:65], v111 offset:24576
    ds_read_b64_tr_b16 v[66:67], v111 offset:25600
    s_waitcnt lgkmcnt(4)
    v_mfma_f32_32x32x16_bf16 v[192:207], v[52:55], v[152:155], v[192:207]
    ds_read_b64_tr_b16 v[68:69], v108 offset:28672
    ds_read_b64_tr_b16 v[70:71], v108 offset:29696
    buffer_load_dwordx4 v25, s[8:11], s40 offen offset:3072 nt lds
    v_mfma_f32_32x32x16_bf16 v[208:223], v[56:59], v[152:155], v[208:223]
    ds_read_b64_tr_b16 v[72:73], v109 offset:28672
    ds_read_b64_tr_b16 v[74:75], v109 offset:29696
    s_waitcnt lgkmcnt(4)
    v_mfma_f32_32x32x16_bf16 v[224:239], v[60:63], v[152:155], v[224:239]
    ds_read_b64_tr_b16 v[76:77], v110 offset:28672
    ds_read_b64_tr_b16 v[78:79], v110 offset:29696
    s_add_u32 s40, s40, 16384
    v_mfma_f32_32x32x16_bf16 v[240:255], v[64:67], v[152:155], v[240:255]
    ds_read_b64_tr_b16 v[80:81], v111 offset:28672
    ds_read_b64_tr_b16 v[82:83], v111 offset:29696
    s_waitcnt lgkmcnt(4)
    v_mfma_f32_32x32x16_bf16 v[192:207], v[68:71], v[156:159], v[192:207]
    s_waitcnt vmcnt(12) lgkmcnt(0)
    s_barrier
    ds_read_b128 v[128:131], v104 offset:32768
    ds_read_b128 v[132:135], v105 offset:32768
    ds_read_b64_tr_b16 v[52:53], v108 offset:32768
    ds_read_b64_tr_b16 v[54:55], v108 offset:33792
    v_mfma_f32_32x32x16_bf16 v[208:223], v[72:75], v[156:159], v[208:223]
    ds_read_b64_tr_b16 v[56:57], v109 offset:32768
    ds_read_b64_tr_b16 v[58:59], v109 offset:33792
    ds_read_b128 v[136:139], v106 offset:32768
    ds_read_b128 v[140:143], v107 offset:32768
    v_mfma_f32_32x32x16_bf16 v[224:239], v[76:79], v[156:159], v[224:239]
    ds_read_b64_tr_b16 v[60:61], v110 offset:32768
    ds_read_b64_tr_b16 v[62:63], v110 offset:33792
    v_mfma_f32_32x32x16_bf16 v[240:255], v[80:83], v[156:159], v[240:255]
    ds_read_b64_tr_b16 v[64:65], v111 offset:32768
    ds_read_b64_tr_b16 v[66:67], v111 offset:33792
    s_waitcnt lgkmcnt(6)
    v_mfma_f32_32x32x16_bf16 v[192:207], v[52:55], v[128:131], v[192:207]
    ds_read_b64_tr_b16 v[68:69], v108 offset:36864
    ds_read_b64_tr_b16 v[70:71], v108 offset:37888
    v_mfma_f32_32x32x16_bf16 v[208:223], v[56:59], v[128:131], v[208:223]
    ds_read_b64_tr_b16 v[72:73], v109 offset:36864
    ds_read_b64_tr_b16 v[74:75], v109 offset:37888
    s_waitcnt lgkmcnt(4)
    v_mfma_f32_32x32x16_bf16 v[224:239], v[60:63], v[128:131], v[224:239]
    ds_read_b64_tr_b16 v[76:77], v110 offset:36864
    ds_read_b64_tr_b16 v[78:79], v110 offset:37888
    v_mfma_f32_32x32x16_bf16 v[240:255], v[64:67], v[128:131], v[240:255]
    ds_read_b64_tr_b16 v[80:81], v111 offset:36864
    ds_read_b64_tr_b16 v[82:83], v111 offset:37888
    s_waitcnt lgkmcnt(4)
    v_mfma_f32_32x32x16_bf16 v[192:207], v[68:71], v[132:135], v[192:207]
    ds_read_b64_tr_b16 v[52:53], v108 offset:40960
    ds_read_b64_tr_b16 v[54:55], v108 offset:41984
    v_mfma_f32_32x32x16_bf16 v[208:223], v[72:75], v[132:135], v[208:223]
    ds_read_b64_tr_b16 v[56:57], v109 offset:40960
    ds_read_b64_tr_b16 v[58:59], v109 offset:41984
    s_waitcnt lgkmcnt(4)
    v_mfma_f32_32x32x16_bf16 v[224:239], v[76:79], v[132:135], v[224:239]
    ds_read_b64_tr_b16 v[60:61], v110 offset:40960
    ds_read_b64_tr_b16 v[62:63], v110 offset:41984
    v_mfma_f32_32x32x16_bf16 v[240:255], v[80:83], v[132:135], v[240:255]
    ds_read_b64_tr_b16 v[64:65], v111 offset:40960
    ds_read_b64_tr_b16 v[66:67], v111 offset:41984
    s_waitcnt lgkmcnt(4)
    v_mfma_f32_32x32x16_bf16 v[192:207], v[52:55], v[136:139], v[192:207]
    ds_read_b64_tr_b16 v[68:69], v108 offset:45056
    ds_read_b64_tr_b16 v[70:71], v108 offset:46080
    v_mfma_f32_32x32x16_bf16 v[208:223], v[56:59], v[136:139], v[208:223]
    ds_read_b64_tr_b16 v[72:73], v109 offset:45056
    ds_read_b64_tr_b16 v[74:75], v109 offset:46080
    s_waitcnt lgkmcnt(4)
    v_mfma_f32_32x32x16_bf16 v[224:239], v[60:63], v[136:139], v[224:239]
    ds_read_b64_tr_b16 v[76:77], v110 offset:45056
    ds_read_b64_tr_b16 v[78:79], v110 offset:46080
    v_mfma_f32_32x32x16_bf16 v[240:255], v[64:67], v[136:139], v[240:255]
    ds_read_b64_tr_b16 v[80:81], v111 offset:45056
    ds_read_b64_tr_b16 v[82:83], v111 offset:46080
    s_waitcnt lgkmcnt(4)
    v_mfma_f32_32x32x16_bf16 v[192:207], v[68:71], v[140:143], v[192:207]
    s_waitcnt vmcnt(4) lgkmcnt(0)
    s_barrier
    ds_read_b128 v[144:147], v104 offset:49152
    ds_read_b128 v[148:151], v105 offset:49152
    ds_read_b64_tr_b16 v[52:53], v108 offset:49152
    ds_read_b64_tr_b16 v[54:55], v108 offset:50176
    v_mfma_f32_32x32x16_bf16 v[208:223], v[72:75], v[140:143], v[208:223]
    ds_read_b64_tr_b16 v[56:57], v108 offset:53248
    ds_read_b64_tr_b16 v[58:59], v108 offset:54272
    ds_read_b128 v[152:155], v106 offset:49152
    ds_read_b128 v[156:159], v107 offset:49152
    v_mfma_f32_32x32x16_bf16 v[224:239], v[76:79], v[140:143], v[224:239]
    ds_read_b64_tr_b16 v[60:61], v108 offset:57344
    ds_read_b64_tr_b16 v[62:63], v108 offset:58368
    v_mfma_f32_32x32x16_bf16 v[240:255], v[80:83], v[140:143], v[240:255]
    ds_read_b64_tr_b16 v[64:65], v108 offset:61440
    ds_read_b64_tr_b16 v[66:67], v108 offset:62464
    s_waitcnt lgkmcnt(6)
    v_mfma_f32_32x32x16_bf16 v[192:207], v[52:55], v[144:147], v[192:207]
    ds_read_b64_tr_b16 v[68:69], v109 offset:49152
    ds_read_b64_tr_b16 v[70:71], v109 offset:50176
    v_mfma_f32_32x32x16_bf16 v[192:207], v[56:59], v[148:151], v[192:207]
    ds_read_b64_tr_b16 v[72:73], v109 offset:53248
    ds_read_b64_tr_b16 v[74:75], v109 offset:54272
    s_waitcnt lgkmcnt(4)
    v_mfma_f32_32x32x16_bf16 v[192:207], v[60:63], v[152:155], v[192:207]
    ds_read_b64_tr_b16 v[76:77], v109 offset:57344
    ds_read_b64_tr_b16 v[78:79], v109 offset:58368
    v_mfma_f32_32x32x16_bf16 v[192:207], v[64:67], v[156:159], v[192:207]
    ds_read_b64_tr_b16 v[80:81], v109 offset:61440
    ds_read_b64_tr_b16 v[82:83], v109 offset:62464
    s_waitcnt lgkmcnt(4)
    v_mfma_f32_32x32x16_bf16 v[208:223], v[68:71], v[144:147], v[208:223]
    ds_read_b64_tr_b16 v[52:53], v110 offset:49152
    ds_read_b64_tr_b16 v[54:55], v110 offset:50176
    v_mfma_f32_32x32x16_bf16 v[208:223], v[72:75], v[148:151], v[208:223]
    ds_read_b64_tr_b16 v[56:57], v110 offset:53248
    ds_read_b64_tr_b16 v[58:59], v110 offset:54272
    s_waitcnt lgkmcnt(4)
    v_mfma_f32_32x32x16_bf16 v[208:223], v[76:79], v[152:155], v[208:223]
    ds_read_b64_tr_b16 v[60:61], v110 offset:57344
    ds_read_b64_tr_b16 v[62:63], v110 offset:58368
    v_mul_f32 v192, s6, v192
    v_mul_f32 v193, s6, v193
    v_cvt_pk_bf16_f32 v160, v192, v193
    v_mul_f32 v194, s6, v194
    v_mul_f32 v195, s6, v195
    v_cvt_pk_bf16_f32 v161, v194, v195
    v_mul_f32 v196, s6, v196
    v_mfma_f32_32x32x16_bf16 v[208:223], v[80:83], v[156:159], v[208:223]
    ds_read_b64_tr_b16 v[64:65], v110 offset:61440
    ds_read_b64_tr_b16 v[66:67], v110 offset:62464
    v_mul_f32 v197, s6, v197
    v_cvt_pk_bf16_f32 v162, v196, v197
    v_mul_f32 v198, s6, v198
    v_mul_f32 v199, s6, v199
    v_cvt_pk_bf16_f32 v163, v198, v199
    buffer_store_dwordx4 v[160:163], v9, s[16:19], s98 offen offset:0 sc1
    s_waitcnt lgkmcnt(4)
    v_mfma_f32_32x32x16_bf16 v[224:239], v[52:55], v[144:147], v[224:239]
    ds_read_b64_tr_b16 v[68:69], v111 offset:49152
    ds_read_b64_tr_b16 v[70:71], v111 offset:50176
    v_mul_f32 v200, s6, v200
    v_mul_f32 v201, s6, v201
    v_cvt_pk_bf16_f32 v164, v200, v201
    v_mul_f32 v202, s6, v202
    v_mul_f32 v203, s6, v203
    v_cvt_pk_bf16_f32 v165, v202, v203
    v_mul_f32 v204, s6, v204
    v_mfma_f32_32x32x16_bf16 v[224:239], v[56:59], v[148:151], v[224:239]
    ds_read_b64_tr_b16 v[72:73], v111 offset:53248
    ds_read_b64_tr_b16 v[74:75], v111 offset:54272
    v_mul_f32 v205, s6, v205
    v_cvt_pk_bf16_f32 v166, v204, v205
    v_mul_f32 v206, s6, v206
    v_mul_f32 v207, s6, v207
    v_cvt_pk_bf16_f32 v167, v206, v207
    buffer_store_dwordx4 v[164:167], v9, s[16:19], s98 offen offset:512 sc1
    s_waitcnt lgkmcnt(4)
    v_mfma_f32_32x32x16_bf16 v[224:239], v[60:63], v[152:155], v[224:239]
    ds_read_b64_tr_b16 v[76:77], v111 offset:57344
    ds_read_b64_tr_b16 v[78:79], v111 offset:58368
    v_mul_f32 v208, s6, v208
    v_mul_f32 v209, s6, v209
    v_cvt_pk_bf16_f32 v168, v208, v209
    v_mul_f32 v210, s6, v210
    v_mul_f32 v211, s6, v211
    v_cvt_pk_bf16_f32 v169, v210, v211
    v_mul_f32 v212, s6, v212
    v_mfma_f32_32x32x16_bf16 v[224:239], v[64:67], v[156:159], v[224:239]
    ds_read_b64_tr_b16 v[80:81], v111 offset:61440
    ds_read_b64_tr_b16 v[82:83], v111 offset:62464
    v_mul_f32 v213, s6, v213
    v_cvt_pk_bf16_f32 v170, v212, v213
    v_mul_f32 v214, s6, v214
    v_mul_f32 v215, s6, v215
    v_cvt_pk_bf16_f32 v171, v214, v215
    buffer_store_dwordx4 v[168:171], v9, s[16:19], s98 offen offset:1024 sc1
    s_waitcnt lgkmcnt(4)
    v_mfma_f32_32x32x16_bf16 v[240:255], v[68:71], v[144:147], v[240:255]
    v_mul_f32 v216, s6, v216
    v_mul_f32 v217, s6, v217
    v_cvt_pk_bf16_f32 v172, v216, v217
    v_mul_f32 v218, s6, v218
    v_mul_f32 v219, s6, v219
    v_cvt_pk_bf16_f32 v173, v218, v219
    v_mul_f32 v220, s6, v220
    v_mfma_f32_32x32x16_bf16 v[240:255], v[72:75], v[148:151], v[240:255]
    v_mul_f32 v221, s6, v221
    v_cvt_pk_bf16_f32 v174, v220, v221
    v_mul_f32 v222, s6, v222
    v_mul_f32 v223, s6, v223
    v_cvt_pk_bf16_f32 v175, v222, v223
    buffer_store_dwordx4 v[172:175], v9, s[16:19], s98 offen offset:1536 sc1
    s_waitcnt lgkmcnt(0)
    v_mfma_f32_32x32x16_bf16 v[240:255], v[76:79], v[152:155], v[240:255]
    v_mul_f32 v224, s6, v224
    v_mul_f32 v225, s6, v225
    v_cvt_pk_bf16_f32 v160, v224, v225
    v_mul_f32 v226, s6, v226
    v_mul_f32 v227, s6, v227
    v_cvt_pk_bf16_f32 v161, v226, v227
    v_mul_f32 v228, s6, v228
    v_mfma_f32_32x32x16_bf16 v[240:255], v[80:83], v[156:159], v[240:255]
    v_mul_f32 v229, s6, v229
    v_cvt_pk_bf16_f32 v162, v228, v229
    v_mul_f32 v230, s6, v230
    v_mul_f32 v231, s6, v231
    v_cvt_pk_bf16_f32 v163, v230, v231
    buffer_store_dwordx4 v[160:163], v9, s[16:19], s98 offen offset:2048 sc1
    v_mul_f32 v232, s6, v232
    v_mul_f32 v233, s6, v233
    v_cvt_pk_bf16_f32 v164, v232, v233
    v_mul_f32 v234, s6, v234
    v_mul_f32 v235, s6, v235
    v_cvt_pk_bf16_f32 v165, v234, v235
    v_mul_f32 v236, s6, v236
    v_mul_f32 v237, s6, v237
    v_cvt_pk_bf16_f32 v166, v236, v237
    v_mul_f32 v238, s6, v238
    v_mul_f32 v239, s6, v239
    v_cvt_pk_bf16_f32 v167, v238, v239
    buffer_store_dwordx4 v[164:167], v9, s[16:19], s98 offen offset:2560 sc1
    v_mul_f32 v240, s6, v240
    v_mul_f32 v241, s6, v241
    v_cvt_pk_bf16_f32 v168, v240, v241
    v_mul_f32 v242, s6, v242
    v_mul_f32 v243, s6, v243
    v_cvt_pk_bf16_f32 v169, v242, v243
    v_mul_f32 v244, s6, v244
    v_mul_f32 v245, s6, v245
    v_cvt_pk_bf16_f32 v170, v244, v245
    v_mul_f32 v246, s6, v246
    v_mul_f32 v247, s6, v247
    v_cvt_pk_bf16_f32 v171, v246, v247
    buffer_store_dwordx4 v[168:171], v9, s[16:19], s98 offen offset:3072 sc1
    v_mul_f32 v248, s6, v248
    v_mul_f32 v249, s6, v249
    v_cvt_pk_bf16_f32 v172, v248, v249
    v_mul_f32 v250, s6, v250
    v_mul_f32 v251, s6, v251
    v_cvt_pk_bf16_f32 v173, v250, v251
    v_mul_f32 v252, s6, v252
    v_mul_f32 v253, s6, v253
    v_cvt_pk_bf16_f32 v174, v252, v253
    v_mul_f32 v254, s6, v254
    v_mul_f32 v255, s6, v255
    v_cvt_pk_bf16_f32 v175, v254, v255
    buffer_store_dwordx4 v[172:175], v9, s[16:19], s98 offen offset:3584 sc1
    s_barrier
    s_add_u32 m0, s42, 16384
    s_nop 0
    buffer_load_dwordx4 v22, s[8:11], s40 offen offset:0 nt lds
    buffer_load_dwordx4 v23, s[8:11], s40 offen offset:1024 nt lds
    buffer_load_dwordx4 v24, s[8:11], s40 offen offset:2048 nt lds
    buffer_load_dwordx4 v25, s[8:11], s40 offen offset:3072 nt lds
    s_add_u32 s40, s40, 16384
    v_mov_b32 v192, 0
    v_mov_b32 v193, 0
    v_mov_b32 v194, 0
    v_mov_b32 v195, 0
    v_mov_b32 v196, 0
    v_mov_b32 v197, 0
    v_mov_b32 v198, 0
    v_mov_b32 v199, 0
    v_mov_b32 v200, 0
    v_mov_b32 v201, 0
    v_mov_b32 v202, 0
    v_mov_b32 v203, 0
    v_mov_b32 v204, 0
    v_mov_b32 v205, 0
    v_mov_b32 v206, 0
    v_mov_b32 v207, 0
    v_mov_b32 v208, 0
    v_mov_b32 v209, 0
    v_mov_b32 v210, 0
    v_mov_b32 v211, 0
    v_mov_b32 v212, 0
    v_mov_b32 v213, 0
    v_mov_b32 v214, 0
    v_mov_b32 v215, 0
    v_mov_b32 v216, 0
    v_mov_b32 v217, 0
    v_mov_b32 v218, 0
    v_mov_b32 v219, 0
    v_mov_b32 v220, 0
    v_mov_b32 v221, 0
    v_mov_b32 v222, 0
    v_mov_b32 v223, 0
    v_mov_b32 v224, 0
    v_mov_b32 v225, 0
    v_mov_b32 v226, 0
    v_mov_b32 v227, 0
    v_mov_b32 v228, 0
    v_mov_b32 v229, 0
    v_mov_b32 v230, 0
    v_mov_b32 v231, 0
    v_mov_b32 v232, 0
    v_mov_b32 v233, 0
    v_mov_b32 v234, 0
    v_mov_b32 v235, 0
    v_mov_b32 v236, 0
    v_mov_b32 v237, 0
    v_mov_b32 v238, 0
    v_mov_b32 v239, 0
    v_mov_b32 v240, 0
    v_mov_b32 v241, 0
    v_mov_b32 v242, 0
    v_mov_b32 v243, 0
    v_mov_b32 v244, 0
    v_mov_b32 v245, 0
    v_mov_b32 v246, 0
    v_mov_b32 v247, 0
    v_mov_b32 v248, 0
    v_mov_b32 v249, 0
    v_mov_b32 v250, 0
    v_mov_b32 v251, 0
    v_mov_b32 v252, 0
    v_mov_b32 v253, 0
    v_mov_b32 v254, 0
    v_mov_b32 v255, 0
    s_waitcnt vmcnt(4)
    v_mov_b32 v8, 0
    v_mov_b32 v5, s47
    s_mov_b64 exec, 1
    buffer_store_dword v5, v8, s[16:19], s97 offen sc1
    s_mov_b64 exec, -1
    s_lshl_b32 s96, s39, 3
    s_add_u32 s96, s96, s37
    s_lshl_b32 s96, s96, 2
    s_add_u32 s96, s96, s36
    s_lshl_b32 s97, s96, 7
    s_add_u32 s97, s97, 65536
    s_lshl_b32 s98, s96, 13
    s_add_u32 s98, s98, 1048576
    s_add_u32 s99, s98, 4096
    v_mov_b32 v8, 0
    v_lshlrev_b32 v33, 4, v1
    v_mov_b32 v4, 0
    s_mov_b64 exec, 1
    buffer_atomic_add v4, off, s[16:19], s97 sc0 sc1
    s_mov_b64 exec, -1
    s_add_u32 m0, s42, 32768
    s_nop 0
    buffer_load_dwordx4 v22, s[8:11], s40 offen offset:0 nt lds
    buffer_load_dwordx4 v23, s[8:11], s40 offen offset:1024 nt lds
    buffer_load_dwordx4 v24, s[8:11], s40 offen offset:2048 nt lds
    buffer_load_dwordx4 v25, s[8:11], s40 offen offset:3072 nt lds
    s_add_u32 s40, s40, 16384
    s_mov_b64 exec, 1
    s_waitcnt vmcnt(4)
    v_cmp_ne_u32 vcc, s46, v4
    s_mov_b64 exec, -1
    s_cbranch_vccz L_qgot0
    v_mov_b32 v4, 0
    s_mov_b64 exec, 1
    buffer_atomic_add v4, off, s[16:19], s97 sc0 sc1
    s_mov_b64 exec, -1
    s_add_u32 m0, s43, 0
    s_nop 0
    buffer_load_dwordx4 v26, s[12:15], s41 offen offset:0 nt lds
    buffer_load_dwordx4 v27, s[12:15], s41 offen offset:1024 nt lds
    buffer_load_dwordx4 v26, s[12:15], s41 offen offset:2048 nt lds
    buffer_load_dwordx4 v27, s[12:15], s41 offen offset:3072 nt lds
    s_add_u32 s41, s41, 16384
    s_mov_b64 exec, 1
    s_waitcnt vmcnt(4)
    v_cmp_ne_u32 vcc, s46, v4
    s_mov_b64 exec, -1
    s_cbranch_vccz L_qgot1
    s_mov_b32 s4, 0
    s_mov_b64 exec, 0x1
L_pollA:
    v_mov_b32 v4, 0
    buffer_atomic_add v4, v8, s[16:19], s97 offen sc0 sc1
    s_waitcnt vmcnt(0)
    v_cmp_ne_u32 vcc, s46, v4
    s_cbranch_vccz L_gotA
    s_add_u32 s4, s4, 1
    s_cmp_lt_u32 s4, 400000
    s_cbranch_scc1 L_pollA
L_gotA:
    s_mov_b64 exec, -1
L_qgot1:
    buffer_load_dwordx4 a[0:3], v33, s[16:19], s98 offen offset:0 sc1
    buffer_load_dwordx4 a[4:7], v33, s[16:19], s98 offen offset:1024 sc1
    buffer_load_dwordx4 a[8:11], v33, s[16:19], s98 offen offset:2048 sc1
    buffer_load_dwordx4 a[12:15], v33, s[16:19], s98 offen offset:3072 sc1
    buffer_load_dwordx4 a[16:19], v33, s[16:19], s99 offen offset:0 sc1
    buffer_load_dwordx4 a[20:23], v33, s[16:19], s99 offen offset:1024 sc1
    buffer_load_dwordx4 a[24:27], v33, s[16:19], s99 offen offset:2048 sc1
    buffer_load_dwordx4 a[28:31], v33, s[16:19], s99 offen offset:3072 sc1
    s_waitcnt vmcnt(0)
L_qdone:
    s_barrier
    ds_read_b128 v[52:55], v10 offset:0
    ds_read_b128 v[56:59], v10 offset:4096
    ds_read_b128 v[60:63], v10 offset:8192
    ds_read_b128 v[64:67], v10 offset:12288
    s_waitcnt lgkmcnt(2)
    v_mfma_f32_16x16x32_bf16 v[128:131], v[52:55], a[0:3], 0
    ds_read_b128 v[68:71], v11 offset:0
    s_add_u32 m0, s42, 49152
    v_mfma_f32_16x16x32_bf16 v[132:135], v[52:55], a[16:19], 0
    ds_read_b128 v[72:75], v11 offset:4096
    v_mfma_f32_16x16x32_bf16 v[140:143], v[56:59], a[16:19], 0
    s_nop 0
    v_mfma_f32_16x16x32_bf16 v[136:139], v[56:59], a[0:3], 0
    s_waitcnt lgkmcnt(2)
    v_mfma_f32_16x16x32_bf16 v[144:147], v[60:63], a[0:3], 0
    ds_read_b128 v[76:79], v11 offset:8192
    buffer_load_dwordx4 v22, s[8:11], s40 offen offset:0 nt lds
    v_mfma_f32_16x16x32_bf16 v[148:151], v[60:63], a[16:19], 0
    ds_read_b128 v[80:83], v11 offset:12288
    v_mfma_f32_16x16x32_bf16 v[156:159], v[64:67], a[16:19], 0
    buffer_load_dwordx4 v23, s[8:11], s40 offen offset:1024 nt lds
    v_mfma_f32_16x16x32_bf16 v[152:155], v[64:67], a[0:3], 0
    s_waitcnt lgkmcnt(2)
    v_mfma_f32_16x16x32_bf16 v[128:131], v[68:71], a[4:7], v[128:131]
    ds_read_b128 v[52:55], v12 offset:0
    buffer_load_dwordx4 v24, s[8:11], s40 offen offset:2048 nt lds
    v_mfma_f32_16x16x32_bf16 v[132:135], v[68:71], a[20:23], v[132:135]
    ds_read_b128 v[56:59], v12 offset:4096
    v_mfma_f32_16x16x32_bf16 v[140:143], v[72:75], a[20:23], v[140:143]
    buffer_load_dwordx4 v25, s[8:11], s40 offen offset:3072 nt lds
    v_mfma_f32_16x16x32_bf16 v[136:139], v[72:75], a[4:7], v[136:139]
    s_waitcnt lgkmcnt(2)
    v_mfma_f32_16x16x32_bf16 v[144:147], v[76:79], a[4:7], v[144:147]
    ds_read_b128 v[60:63], v12 offset:8192
    s_add_u32 s40, s40, 16384
    v_mfma_f32_16x16x32_bf16 v[148:151], v[76:79], a[20:23], v[148:151]
    ds_read_b128 v[64:67], v12 offset:12288
    v_mfma_f32_16x16x32_bf16 v[156:159], v[80:83], a[20:23], v[156:159]
    v_mfma_f32_16x16x32_bf16 v[152:155], v[80:83], a[4:7], v[152:155]
    s_add_u32 m0, s43, 16384
    s_waitcnt lgkmcnt(2)
    v_mfma_f32_16x16x32_bf16 v[128:131], v[52:55], a[8:11], v[128:131]
    ds_read_b128 v[68:71], v13 offset:0
    v_mfma_f32_16x16x32_bf16 v[132:135], v[52:55], a[24:27], v[132:135]
    ds_read_b128 v[72:75], v13 offset:4096
    s_nop 0
    v_mfma_f32_16x16x32_bf16 v[140:143], v[56:59], a[24:27], v[140:143]
    v_mfma_f32_16x16x32_bf16 v[136:139], v[56:59], a[8:11], v[136:139]
    buffer_load_dwordx4 v26, s[12:15], s41 offen offset:0 nt lds
    s_waitcnt lgkmcnt(2)
    v_mfma_f32_16x16x32_bf16 v[144:147], v[60:63], a[8:11], v[144:147]
    ds_read_b128 v[76:79], v13 offset:8192
    v_mfma_f32_16x16x32_bf16 v[148:151], v[60:63], a[24:27], v[148:151]
    ds_read_b128 v[80:83], v13 offset:12288
    buffer_load_dwordx4 v27, s[12:15], s41 offen offset:1024 nt lds
    v_mfma_f32_16x16x32_bf16 v[156:159], v[64:67], a[24:27], v[156:159]
    v_mfma_f32_16x16x32_bf16 v[152:155], v[64:67], a[8:11], v[152:155]
    buffer_load_dwordx4 v26, s[12:15], s41 offen offset:2048 nt lds
    s_waitcnt lgkmcnt(2)
    v_mfma_f32_16x16x32_bf16 v[128:131], v[68:71], a[12:15], v[128:131]
    v_mfma_f32_16x16x32_bf16 v[132:135], v[68:71], a[28:31], v[132:135]
    buffer_load_dwordx4 v27, s[12:15], s41 offen offset:3072 nt lds
    v_mfma_f32_16x16x32_bf16 v[140:143], v[72:75], a[28:31], v[140:143]
    v_mfma_f32_16x16x32_bf16 v[136:139], v[72:75], a[12:15], v[136:139]
    s_add_u32 s41, s41, 16384
    s_waitcnt lgkmcnt(0)
    v_mfma_f32_16x16x32_bf16 v[144:147], v[76:79], a[12:15], v[144:147]
    v_mfma_f32_16x16x32_bf16 v[148:151], v[76:79], a[28:31], v[148:151]
    v_mfma_f32_16x16x32_bf16 v[156:159], v[80:83], a[28:31], v[156:159]
    v_mfma_f32_16x16x32_bf16 v[152:155], v[80:83], a[12:15], v[152:155]
    s_barrier
    s_add_u32 m0, s42, 0
    s_nop 0
    buffer_load_dwordx4 v22, s[8:11], s40 offen offset:0 nt lds
    buffer_load_dwordx4 v23, s[8:11], s40 offen offset:1024 nt lds
    buffer_load_dwordx4 v24, s[8:11], s40 offen offset:2048 nt lds
    buffer_load_dwordx4 v25, s[8:11], s40 offen offset:3072 nt lds
    s_add_u32 s40, s40, 16384
    ds_read_b128 v[52:55], v10 offset:16384
    ds_read_b128 v[56:59], v10 offset:20480
    ds_read_b128 v[60:63], v10 offset:24576
    ds_read_b128 v[64:67], v10 offset:28672
    v_mov_b32 v28, 0
    v_mov_b32 v29, 0
    s_mov_b32 s44, 0
    s_add_u32 s80, s42, 16384
    s_add_u32 s95, s94, 6144
    s_getpc_b64 s[88:89]
L_snrefa:
    s_add_u32 s88, s88, L_snip0+0-L_snrefa
    s_addc_u32 s89, s89, 0
    v_max3_f32 v32, v128, v129, v130
    v_max3_f32 v50, v132, v133, v134
    v_max3_f32 v32, v32, v131, v136
    v_max3_f32 v50, v50, v135, v140
    v_max3_f32 v32, v32, v137, v138
    v_max3_f32 v50, v50, v141, v142
    v_max3_f32 v32, v32, v139, v144
    v_max3_f32 v50, v50, v143, v148
    v_max3_f32 v32, v32, v145, v146
    v_max3_f32 v50, v50, v149, v150
    v_max3_f32 v32, v32, v147, v152
    v_max3_f32 v50, v50, v151, v156
    v_max3_f32 v32, v32, v153, v154
    v_max3_f32 v50, v50, v157, v158
    v_max_f32 v32, v32, v155
    v_max_f32 v50, v50, v159
    v_mov_b32 v33, v32
    v_mov_b32 v51, v50
    s_nop 0
    v_permlane32_swap_b32 v32, v33
    v_permlane32_swap_b32 v50, v51
    v_max_f32 v32, v32, v33
    v_max_f32 v50, v50, v51
    v_mov_b32 v33, v32
    v_mov_b32 v51, v50
    s_nop 0
    v_permlane16_swap_b32 v32, v33
    v_permlane16_swap_b32 v50, v51
    v_max_f32 v32, v32, v33
    v_max_f32 v50, v50, v51
    v_sub_f32 v36, 0, v32
    v_sub_f32 v37, 0, v32
    v_sub_f32 v38, 0, v32
    v_sub_f32 v39, 0, v32
    v_sub_f32 v40, 0, v50
    v_sub_f32 v41, 0, v50
    v_sub_f32 v42, 0, v50
    v_sub_f32 v43, 0, v50
    s_waitcnt lgkmcnt(2)
    v_mfma_f32_16x16x32_bf16 v[160:163], v[52:55], a[0:3], v[36:39]
    ds_read_b128 v[68:71], v11 offset:16384
    v_add_f32 v128, v128, v36
    v_add_f32 v129, v129, v36
    v_add_f32 v130, v130, v36
    v_add_f32 v131, v131, v36
    v_mfma_f32_16x16x32_bf16 v[164:167], v[52:55], a[16:19], v[40:43]
    ds_read_b128 v[72:75], v11 offset:20480
    v_exp_f32 v44, v128
    v_exp_f32 v45, v129
    v_exp_f32 v46, v130
    v_mfma_f32_16x16x32_bf16 v[172:175], v[56:59], a[16:19], v[40:43]
    v_exp_f32 v47, v131
    v_add_f32 v132, v132, v40
    v_add_f32 v133, v133, v40
    v_mfma_f32_16x16x32_bf16 v[168:171], v[56:59], a[0:3], v[36:39]
    v_add_f32 v134, v134, v40
    v_add_f32 v135, v135, v40
    v_exp_f32 v48, v132
    s_add_u32 m0, s43, 32768
    s_waitcnt vmcnt(8) lgkmcnt(2)
    v_mfma_f32_16x16x32_bf16 v[176:179], v[60:63], a[0:3], v[36:39]
    ds_read_b128 v[76:79], v11 offset:24576
    v_cvt_pk_bf16_f32 v96, v44, v45
    v_exp_f32 v49, v133
    v_cvt_pk_bf16_f32 v97, v46, v47
    v_exp_f32 v50, v134
    buffer_load_dwordx4 v26, s[12:15], s41 offen offset:0 nt lds
    v_mfma_f32_16x16x32_bf16 v[180:183], v[60:63], a[16:19], v[40:43]
    ds_read_b128 v[80:83], v11 offset:28672
    v_exp_f32 v51, v135
    v_add_f32 v136, v136, v36
    v_add_f32 v137, v137, v36
    v_mfma_f32_16x16x32_bf16 v[188:191], v[64:67], a[16:19], v[40:43]
    v_add_f32 v138, v138, v36
    v_add_f32 v139, v139, v36
    v_exp_f32 v44, v136
    v_mfma_f32_16x16x32_bf16 v[184:187], v[64:67], a[0:3], v[36:39]
    v_cvt_pk_bf16_f32 v100, v48, v49
    v_exp_f32 v45, v137
    v_cvt_pk_bf16_f32 v101, v50, v51
    s_waitcnt lgkmcnt(2)
    v_mfma_f32_16x16x32_bf16 v[160:163], v[68:71], a[4:7], v[160:163]
    ds_read_b128 v[52:55], v12 offset:16384
    v_exp_f32 v46, v138
    v_exp_f32 v47, v139
    v_add_f32 v140, v140, v40
    v_add_f32 v141, v141, v40
    v_mfma_f32_16x16x32_bf16 v[164:167], v[68:71], a[20:23], v[164:167]
    ds_read_b128 v[56:59], v12 offset:20480
    v_add_f32 v142, v142, v40
    v_add_f32 v143, v143, v40
    v_exp_f32 v48, v140
    v_mfma_f32_16x16x32_bf16 v[172:175], v[72:75], a[20:23], v[172:175]
    v_cvt_pk_bf16_f32 v98, v44, v45
    v_exp_f32 v49, v141
    v_cvt_pk_bf16_f32 v99, v46, v47
    v_mfma_f32_16x16x32_bf16 v[168:171], v[72:75], a[4:7], v[168:171]
    v_exp_f32 v50, v142
    v_exp_f32 v51, v143
    v_add_f32 v144, v144, v36
    s_waitcnt vmcnt(8) lgkmcnt(2)
    v_mfma_f32_16x16x32_bf16 v[176:179], v[76:79], a[4:7], v[176:179]
    ds_read_b128 v[60:63], v12 offset:24576
    v_add_f32 v145, v145, v36
    v_add_f32 v146, v146, v36
    v_add_f32 v147, v147, v36
    v_exp_f32 v44, v144
    buffer_load_dwordx4 v27, s[12:15], s41 offen offset:1024 nt lds
    v_mfma_f32_16x16x32_bf16 v[180:183], v[76:79], a[20:23], v[180:183]
    ds_read_b128 v[64:67], v12 offset:28672
    v_cvt_pk_bf16_f32 v102, v48, v49
    v_exp_f32 v45, v145
    v_cvt_pk_bf16_f32 v103, v50, v51
    v_mfma_f32_16x16x32_bf16 v[188:191], v[80:83], a[20:23], v[188:191]
    v_exp_f32 v46, v146
    v_exp_f32 v47, v147
    v_add_f32 v148, v148, v40
    v_mfma_f32_16x16x32_bf16 v[184:187], v[80:83], a[4:7], v[184:187]
    v_add_f32 v149, v149, v40
    v_add_f32 v150, v150, v40
    v_add_f32 v151, v151, v40
    s_waitcnt vmcnt(8) lgkmcnt(2)
    v_mfma_f32_16x16x32_bf16 v[160:163], v[52:55], a[8:11], v[160:163]
    ds_read_b128 v[68:71], v13 offset:16384
    v_exp_f32 v48, v148
    v_cvt_pk_bf16_f32 v104, v44, v45
    v_exp_f32 v49, v149
    v_cvt_pk_bf16_f32 v105, v46, v47
    buffer_load_dwordx4 v26, s[12:15], s41 offen offset:2048 nt lds
    v_mfma_f32_16x16x32_bf16 v[88:91], v[84:87], v[96:99], 0
    v_mfma_f32_16x16x32_bf16 v[164:167], v[52:55], a[24:27], v[164:167]
    ds_read_b128 v[72:75], v13 offset:20480
    v_exp_f32 v50, v150
    v_exp_f32 v51, v151
    v_add_f32 v152, v152, v36
    v_mfma_f32_16x16x32_bf16 v[92:95], v[84:87], v[100:103], 0
    v_mfma_f32_16x16x32_bf16 v[172:175], v[56:59], a[24:27], v[172:175]
    v_add_f32 v153, v153, v36
    v_add_f32 v154, v154, v36
    v_add_f32 v155, v155, v36
    v_mfma_f32_16x16x32_bf16 v[168:171], v[56:59], a[8:11], v[168:171]
    v_exp_f32 v44, v152
    v_cvt_pk_bf16_f32 v108, v48, v49
    v_exp_f32 v45, v153
    s_waitcnt lgkmcnt(2)
    v_mfma_f32_16x16x32_bf16 v[176:179], v[60:63], a[8:11], v[176:179]
    ds_read_b128 v[76:79], v13 offset:24576
    v_cvt_pk_bf16_f32 v109, v50, v51
    v_exp_f32 v46, v154
    v_exp_f32 v47, v155
    v_add_f32 v156, v156, v40
    v_mfma_f32_16x16x32_bf16 v[180:183], v[60:63], a[24:27], v[180:183]
    ds_read_b128 v[80:83], v13 offset:28672
    v_add_f32 v157, v157, v40
    v_add_f32 v158, v158, v40
    v_add_f32 v159, v159, v40
    v_mfma_f32_16x16x32_bf16 v[188:191], v[64:67], a[24:27], v[188:191]
    v_exp_f32 v48, v156
    v_cvt_pk_bf16_f32 v106, v44, v45
    v_exp_f32 v49, v157
    v_mfma_f32_16x16x32_bf16 v[184:187], v[64:67], a[8:11], v[184:187]
    v_cvt_pk_bf16_f32 v107, v46, v47
    v_exp_f32 v50, v158
    v_exp_f32 v51, v159
    s_waitcnt vmcnt(8) lgkmcnt(2)
    v_mfma_f32_16x16x32_bf16 v[160:163], v[68:71], a[12:15], v[160:163]
    s_nop 0
    v_cvt_pk_bf16_f32 v110, v48, v49
    v_cvt_pk_bf16_f32 v111, v50, v51
    buffer_load_dwordx4 v27, s[12:15], s41 offen offset:3072 nt lds
    s_add_u32 s41, s41, 16384
    v_mfma_f32_16x16x32_bf16 v[164:167], v[68:71], a[28:31], v[164:167]
    v_mfma_f32_16x16x32_bf16 v[88:91], v[84:87], v[104:107], v[88:91]
    v_mfma_f32_16x16x32_bf16 v[92:95], v[84:87], v[108:111], v[92:95]
    v_mfma_f32_16x16x32_bf16 v[172:175], v[72:75], a[28:31], v[172:175]
    s_waitcnt vmcnt(16) lgkmcnt(0)
    s_barrier
    ds_read_b64_tr_b16 v[52:53], v14 offset:0
    ds_read_b64_tr_b16 v[54:55], v14 offset:4096
    v_mfma_f32_16x16x32_bf16 v[168:171], v[72:75], a[12:15], v[168:171]
    ds_read_b64_tr_b16 v[56:57], v15 offset:0
    ds_read_b64_tr_b16 v[58:59], v15 offset:4096
    v_mfma_f32_16x16x32_bf16 v[176:179], v[76:79], a[12:15], v[176:179]
    ds_read_b64_tr_b16 v[60:61], v16 offset:0
    ds_read_b64_tr_b16 v[62:63], v16 offset:4096
    v_mfma_f32_16x16x32_bf16 v[180:183], v[76:79], a[28:31], v[180:183]
    ds_read_b64_tr_b16 v[64:65], v17 offset:0
    ds_read_b64_tr_b16 v[66:67], v17 offset:4096
    v_mfma_f32_16x16x32_bf16 v[188:191], v[80:83], a[28:31], v[188:191]
    v_max_f32 v32, v88, v92
    v_mfma_f32_16x16x32_bf16 v[184:187], v[80:83], a[12:15], v[184:187]
    v_cmp_lt_f32 vcc, 0x45800000, v32
    s_swappc_b64 s[90:91], s[88:89]
    s_cbranch_vccnz L_trJ1a
L_H0a:
    s_waitcnt lgkmcnt(12)
    v_mfma_f32_16x16x32_bf16 v[192:195], v[52:55], v[96:99], v[192:195]
    s_add_u32 s44, s44, 4
    ds_read_b64_tr_b16 v[68:69], v18 offset:0
    ds_read_b64_tr_b16 v[70:71], v18 offset:4096
    v_exp_f32 v44, v160
    v_mfma_f32_16x16x32_bf16 v[196:199], v[52:55], v[100:103], v[196:199]
    ds_read_b64_tr_b16 v[72:73], v19 offset:0
    ds_read_b64_tr_b16 v[74:75], v19 offset:4096
    v_exp_f32 v45, v161
    v_mfma_f32_16x16x32_bf16 v[204:207], v[56:59], v[100:103], v[204:207]
    v_exp_f32 v46, v162
    v_add_f32 v28, v28, v88
    v_mfma_f32_16x16x32_bf16 v[200:203], v[56:59], v[96:99], v[200:203]
    v_exp_f32 v47, v163
    v_add_f32 v29, v29, v92
    s_add_u32 m0, s42, 16384
    s_waitcnt vmcnt(10) lgkmcnt(12)
    v_mfma_f32_16x16x32_bf16 v[208:211], v[60:63], v[96:99], v[208:211]
    ds_read_b64_tr_b16 v[76:77], v20 offset:0
    ds_read_b64_tr_b16 v[78:79], v20 offset:4096
    v_exp_f32 v48, v164
    buffer_load_dwordx4 v22, s[8:11], s40 offen offset:0 nt lds
    v_mfma_f32_16x16x32_bf16 v[212:215], v[60:63], v[100:103], v[212:215]
    ds_read_b64_tr_b16 v[80:81], v21 offset:0
    ds_read_b64_tr_b16 v[82:83], v21 offset:4096
    v_cvt_pk_bf16_f32 v112, v44, v45
    v_mfma_f32_16x16x32_bf16 v[220:223], v[64:67], v[100:103], v[220:223]
    v_mfma_f32_16x16x32_bf16 v[216:219], v[64:67], v[96:99], v[216:219]
    v_exp_f32 v49, v165
    s_waitcnt lgkmcnt(4)
    v_mfma_f32_16x16x32_bf16 v[224:227], v[68:71], v[96:99], v[224:227]
    ds_read_b64_tr_b16 v[52:53], v14 offset:8192
    ds_read_b64_tr_b16 v[54:55], v14 offset:12288
    v_cvt_pk_bf16_f32 v113, v46, v47
    v_mfma_f32_16x16x32_bf16 v[228:231], v[68:71], v[100:103], v[228:231]
    ds_read_b64_tr_b16 v[56:57], v15 offset:8192
    ds_read_b64_tr_b16 v[58:59], v15 offset:12288
    v_exp_f32 v50, v166
    v_mfma_f32_16x16x32_bf16 v[236:239], v[72:75], v[100:103], v[236:239]
    v_exp_f32 v51, v167
    v_mfma_f32_16x16x32_bf16 v[232:235], v[72:75], v[96:99], v[232:235]
    v_exp_f32 v44, v168
    s_waitcnt vmcnt(10) lgkmcnt(4)
    v_mfma_f32_16x16x32_bf16 v[240:243], v[76:79], v[96:99], v[240:243]
    ds_read_b64_tr_b16 v[60:61], v16 offset:8192
    ds_read_b64_tr_b16 v[62:63], v16 offset:12288
    buffer_load_dwordx4 v23, s[8:11], s40 offen offset:1024 nt lds
    v_mfma_f32_16x16x32_bf16 v[244:247], v[76:79], v[100:103], v[244:247]
    ds_read_b64_tr_b16 v[64:65], v17 offset:8192
    ds_read_b64_tr_b16 v[66:67], v17 offset:12288
    v_cvt_pk_bf16_f32 v116, v48, v49
    v_mfma_f32_16x16x32_bf16 v[252:255], v[80:83], v[100:103], v[252:255]
    v_exp_f32 v45, v169
    v_mfma_f32_16x16x32_bf16 v[248:251], v[80:83], v[96:99], v[248:251]
    v_cvt_pk_bf16_f32 v117, v50, v51
    s_waitcnt lgkmcnt(4)
    v_mfma_f32_16x16x32_bf16 v[192:195], v[52:55], v[104:107], v[192:195]
    ds_read_b64_tr_b16 v[68:69], v18 offset:8192
    ds_read_b64_tr_b16 v[70:71], v18 offset:12288
    v_exp_f32 v46, v170
    v_mfma_f32_16x16x32_bf16 v[196:199], v[52:55], v[108:111], v[196:199]
    ds_read_b64_tr_b16 v[72:73], v19 offset:8192
    ds_read_b64_tr_b16 v[74:75], v19 offset:12288
    v_exp_f32 v47, v171
    v_mfma_f32_16x16x32_bf16 v[204:207], v[56:59], v[108:111], v[204:207]
    v_exp_f32 v48, v172
    v_mfma_f32_16x16x32_bf16 v[200:203], v[56:59], v[104:107], v[200:203]
    s_waitcnt vmcnt(10) lgkmcnt(4)
    v_mfma_f32_16x16x32_bf16 v[208:211], v[60:63], v[104:107], v[208:211]
    ds_read_b64_tr_b16 v[76:77], v20 offset:8192
    ds_read_b64_tr_b16 v[78:79], v20 offset:12288
    v_cvt_pk_bf16_f32 v114, v44, v45
    buffer_load_dwordx4 v24, s[8:11], s40 offen offset:2048 nt lds
    v_mfma_f32_16x16x32_bf16 v[212:215], v[60:63], v[108:111], v[212:215]
    ds_read_b64_tr_b16 v[80:81], v21 offset:8192
    ds_read_b64_tr_b16 v[82:83], v21 offset:12288
    v_exp_f32 v49, v173
    v_mfma_f32_16x16x32_bf16 v[220:223], v[64:67], v[108:111], v[220:223]
    v_cvt_pk_bf16_f32 v115, v46, v47
    v_mfma_f32_16x16x32_bf16 v[216:219], v[64:67], v[104:107], v[216:219]
    v_exp_f32 v50, v174
    s_waitcnt lgkmcnt(4)
    v_mfma_f32_16x16x32_bf16 v[224:227], v[68:71], v[104:107], v[224:227]
    ds_read_b128 v[52:55], v10 offset:32768
    v_exp_f32 v51, v175
    v_mfma_f32_16x16x32_bf16 v[228:231], v[68:71], v[108:111], v[228:231]
    ds_read_b128 v[56:59], v10 offset:36864
    v_mfma_f32_16x16x32_bf16 v[236:239], v[72:75], v[108:111], v[236:239]
    v_exp_f32 v44, v176
    v_mfma_f32_16x16x32_bf16 v[232:235], v[72:75], v[104:107], v[232:235]
    v_cvt_pk_bf16_f32 v118, v48, v49
    s_waitcnt vmcnt(10) lgkmcnt(2)
    v_mfma_f32_16x16x32_bf16 v[240:243], v[76:79], v[104:107], v[240:243]
    ds_read_b128 v[60:63], v10 offset:40960
    v_exp_f32 v45, v177
    buffer_load_dwordx4 v25, s[8:11], s40 offen offset:3072 nt lds
    s_add_u32 s40, s40, 16384
    v_mfma_f32_16x16x32_bf16 v[244:247], v[76:79], v[108:111], v[244:247]
    ds_read_b128 v[64:67], v10 offset:45056
    v_cvt_pk_bf16_f32 v119, v50, v51
    v_mfma_f32_16x16x32_bf16 v[252:255], v[80:83], v[108:111], v[252:255]
    v_exp_f32 v46, v178
    v_mfma_f32_16x16x32_bf16 v[248:251], v[80:83], v[104:107], v[248:251]
    s_waitcnt lgkmcnt(2)
    v_mfma_f32_16x16x32_bf16 v[128:131], v[52:55], a[0:3], v[36:39]
    ds_read_b128 v[68:71], v11 offset:32768
    v_exp_f32 v47, v179
    v_mfma_f32_16x16x32_bf16 v[132:135], v[52:55], a[16:19], v[40:43]
    ds_read_b128 v[72:75], v11 offset:36864
    v_exp_f32 v48, v180
    v_mfma_f32_16x16x32_bf16 v[140:143], v[56:59], a[16:19], v[40:43]
    v_cvt_pk_bf16_f32 v120, v44, v45
    v_mfma_f32_16x16x32_bf16 v[136:139], v[56:59], a[0:3], v[36:39]
    v_exp_f32 v49, v181
    s_add_u32 m0, s43, 49152
    s_waitcnt vmcnt(10) lgkmcnt(2)
    v_mfma_f32_16x16x32_bf16 v[144:147], v[60:63], a[0:3], v[36:39]
    ds_read_b128 v[76:79], v11 offset:40960
    v_cvt_pk_bf16_f32 v121, v46, v47
    buffer_load_dwordx4 v26, s[12:15], s41 offen offset:0 nt lds
    v_mfma_f32_16x16x32_bf16 v[148:151], v[60:63], a[16:19], v[40:43]
    ds_read_b128 v[80:83], v11 offset:45056
    v_exp_f32 v50, v182
    v_mfma_f32_16x16x32_bf16 v[156:159], v[64:67], a[16:19], v[40:43]
    v_exp_f32 v51, v183
    v_mfma_f32_16x16x32_bf16 v[88:91], v[84:87], v[112:115], 0
    v_mfma_f32_16x16x32_bf16 v[152:155], v[64:67], a[0:3], v[36:39]
    v_exp_f32 v44, v184
    v_mfma_f32_16x16x32_bf16 v[92:95], v[84:87], v[116:119], 0
    s_waitcnt lgkmcnt(2)
    v_mfma_f32_16x16x32_bf16 v[128:131], v[68:71], a[4:7], v[128:131]
    ds_read_b128 v[52:55], v12 offset:32768
    v_cvt_pk_bf16_f32 v124, v48, v49
    v_mfma_f32_16x16x32_bf16 v[132:135], v[68:71], a[20:23], v[132:135]
    ds_read_b128 v[56:59], v12 offset:36864
    v_exp_f32 v45, v185
    v_mfma_f32_16x16x32_bf16 v[140:143], v[72:75], a[20:23], v[140:143]
    v_cvt_pk_bf16_f32 v125, v50, v51
    v_mfma_f32_16x16x32_bf16 v[136:139], v[72:75], a[4:7], v[136:139]
    v_exp_f32 v46, v186
    s_waitcnt vmcnt(10) lgkmcnt(2)
    v_mfma_f32_16x16x32_bf16 v[144:147], v[76:79], a[4:7], v[144:147]
    ds_read_b128 v[60:63], v12 offset:40960
    v_exp_f32 v47, v187
    buffer_load_dwordx4 v27, s[12:15], s41 offen offset:1024 nt lds
    v_mfma_f32_16x16x32_bf16 v[148:151], v[76:79], a[20:23], v[148:151]
    ds_read_b128 v[64:67], v12 offset:45056
    v_exp_f32 v48, v188
    v_mfma_f32_16x16x32_bf16 v[156:159], v[80:83], a[20:23], v[156:159]
    v_cvt_pk_bf16_f32 v122, v44, v45
    v_mfma_f32_16x16x32_bf16 v[152:155], v[80:83], a[4:7], v[152:155]
    v_exp_f32 v49, v189
    s_waitcnt vmcnt(10) lgkmcnt(2)
    v_mfma_f32_16x16x32_bf16 v[128:131], v[52:55], a[8:11], v[128:131]
    ds_read_b128 v[68:71], v13 offset:32768
    v_cvt_pk_bf16_f32 v123, v46, v47
    buffer_load_dwordx4 v26, s[12:15], s41 offen offset:2048 nt lds
    v_mfma_f32_16x16x32_bf16 v[132:135], v[52:55], a[24:27], v[132:135]
    ds_read_b128 v[72:75], v13 offset:36864
    v_exp_f32 v50, v190
    v_mfma_f32_16x16x32_bf16 v[140:143], v[56:59], a[24:27], v[140:143]
    v_exp_f32 v51, v191
    v_mfma_f32_16x16x32_bf16 v[136:139], v[56:59], a[8:11], v[136:139]
    s_nop 0
    s_waitcnt lgkmcnt(2)
    v_mfma_f32_16x16x32_bf16 v[144:147], v[60:63], a[8:11], v[144:147]
    ds_read_b128 v[76:79], v13 offset:40960
    v_cvt_pk_bf16_f32 v126, v48, v49
    v_mfma_f32_16x16x32_bf16 v[148:151], v[60:63], a[24:27], v[148:151]
    ds_read_b128 v[80:83], v13 offset:45056
    v_cvt_pk_bf16_f32 v127, v50, v51
    v_mfma_f32_16x16x32_bf16 v[156:159], v[64:67], a[24:27], v[156:159]
    v_mfma_f32_16x16x32_bf16 v[152:155], v[64:67], a[8:11], v[152:155]
    s_waitcnt vmcnt(6) lgkmcnt(2)
    v_mfma_f32_16x16x32_bf16 v[128:131], v[68:71], a[12:15], v[128:131]
    buffer_load_dwordx4 v27, s[12:15], s41 offen offset:3072 nt lds
    s_add_u32 s41, s41, 16384
    v_mfma_f32_16x16x32_bf16 v[88:91], v[84:87], v[120:123], v[88:91]
    v_mfma_f32_16x16x32_bf16 v[132:135], v[68:71], a[28:31], v[132:135]
    v_mfma_f32_16x16x32_bf16 v[92:95], v[84:87], v[124:127], v[92:95]
    v_mfma_f32_16x16x32_bf16 v[140:143], v[72:75], a[28:31], v[140:143]
    s_waitcnt vmcnt(8) lgkmcnt(0)
    s_barrier
    ds_read_b64_tr_b16 v[52:53], v14 offset:16384
    ds_read_b64_tr_b16 v[54:55], v14 offset:20480
    v_mfma_f32_16x16x32_bf16 v[136:139], v[72:75], a[12:15], v[136:139]
    s_add_u32 m0, s84, 4096
    ds_read_b64_tr_b16 v[56:57], v15 offset:16384
    ds_read_b64_tr_b16 v[58:59], v15 offset:20480
    v_mfma_f32_16x16x32_bf16 v[144:147], v[76:79], a[12:15], v[144:147]
    ds_read_b64_tr_b16 v[60:61], v16 offset:16384
    ds_read_b64_tr_b16 v[62:63], v16 offset:20480
    buffer_load_dwordx4 v30, s[28:31], s94 offen offset:0 lds
    v_mfma_f32_16x16x32_bf16 v[148:151], v[76:79], a[28:31], v[148:151]
    ds_read_b64_tr_b16 v[64:65], v17 offset:16384
    ds_read_b64_tr_b16 v[66:67], v17 offset:20480
    buffer_load_dwordx4 v31, s[28:31], s94 offen offset:1024 lds
    v_mfma_f32_16x16x32_bf16 v[156:159], v[80:83], a[28:31], v[156:159]
    buffer_load_dwordx4 v30, s[28:31], s95 offen offset:2048 lds
    v_max_f32 v32, v88, v92
    v_mfma_f32_16x16x32_bf16 v[152:155], v[80:83], a[12:15], v[152:155]
    buffer_load_dwordx4 v31, s[28:31], s95 offen offset:3072 lds
    v_cmp_lt_f32 vcc, 0x45800000, v32
    s_swappc_b64 s[90:91], s[88:89]
    s_cbranch_vccnz L_trH0a
L_Hret0a:
    s_waitcnt lgkmcnt(12)
    v_mfma_f32_16x16x32_bf16 v[192:195], v[52:55], v[112:115], v[192:195]
    ds_read_b64_tr_b16 v[68:69], v18 offset:16384
    ds_read_b64_tr_b16 v[70:71], v18 offset:20480
    v_exp_f32 v44, v128
    v_mfma_f32_16x16x32_bf16 v[196:199], v[52:55], v[116:119], v[196:199]
    ds_read_b64_tr_b16 v[72:73], v19 offset:16384
    ds_read_b64_tr_b16 v[74:75], v19 offset:20480
    v_exp_f32 v45, v129
    v_mfma_f32_16x16x32_bf16 v[204:207], v[56:59], v[116:119], v[204:207]
    v_exp_f32 v46, v130
    v_add_f32 v28, v28, v88
    v_mfma_f32_16x16x32_bf16 v[200:203], v[56:59], v[112:115], v[200:203]
    v_exp_f32 v47, v131
    v_add_f32 v29, v29, v92
    s_add_u32 m0, s42, 32768
    s_waitcnt vmcnt(10) lgkmcnt(12)
    v_mfma_f32_16x16x32_bf16 v[208:211], v[60:63], v[112:115], v[208:211]
    ds_read_b64_tr_b16 v[76:77], v20 offset:16384
    ds_read_b64_tr_b16 v[78:79], v20 offset:20480
    v_exp_f32 v48, v132
    buffer_load_dwordx4 v22, s[8:11], s40 offen offset:0 nt lds
    v_mfma_f32_16x16x32_bf16 v[212:215], v[60:63], v[116:119], v[212:215]
    ds_read_b64_tr_b16 v[80:81], v21 offset:16384
    ds_read_b64_tr_b16 v[82:83], v21 offset:20480
    v_cvt_pk_bf16_f32 v96, v44, v45
    v_mfma_f32_16x16x32_bf16 v[220:223], v[64:67], v[116:119], v[220:223]
    v_mfma_f32_16x16x32_bf16 v[216:219], v[64:67], v[112:115], v[216:219]
    v_exp_f32 v49, v133
    s_waitcnt lgkmcnt(4)
    v_mfma_f32_16x16x32_bf16 v[224:227], v[68:71], v[112:115], v[224:227]
    ds_read_b64_tr_b16 v[52:53], v14 offset:24576
    ds_read_b64_tr_b16 v[54:55], v14 offset:28672
    v_cvt_pk_bf16_f32 v97, v46, v47
    v_mfma_f32_16x16x32_bf16 v[228:231], v[68:71], v[116:119], v[228:231]
    ds_read_b64_tr_b16 v[56:57], v15 offset:24576
    ds_read_b64_tr_b16 v[58:59], v15 offset:28672
    v_exp_f32 v50, v134
    v_mfma_f32_16x16x32_bf16 v[236:239], v[72:75], v[116:119], v[236:239]
    v_exp_f32 v51, v135
    v_mfma_f32_16x16x32_bf16 v[232:235], v[72:75], v[112:115], v[232:235]
    v_exp_f32 v44, v136
    s_waitcnt vmcnt(10) lgkmcnt(4)
    v_mfma_f32_16x16x32_bf16 v[240:243], v[76:79], v[112:115], v[240:243]
    ds_read_b64_tr_b16 v[60:61], v16 offset:24576
    ds_read_b64_tr_b16 v[62:63], v16 offset:28672
    buffer_load_dwordx4 v23, s[8:11], s40 offen offset:1024 nt lds
    v_mfma_f32_16x16x32_bf16 v[244:247], v[76:79], v[116:119], v[244:247]
    ds_read_b64_tr_b16 v[64:65], v17 offset:24576
    ds_read_b64_tr_b16 v[66:67], v17 offset:28672
    v_cvt_pk_bf16_f32 v100, v48, v49
    v_mfma_f32_16x16x32_bf16 v[252:255], v[80:83], v[116:119], v[252:255]
    v_exp_f32 v45, v137
    v_mfma_f32_16x16x32_bf16 v[248:251], v[80:83], v[112:115], v[248:251]
    v_cvt_pk_bf16_f32 v101, v50, v51
    s_waitcnt lgkmcnt(4)
    v_mfma_f32_16x16x32_bf16 v[192:195], v[52:55], v[120:123], v[192:195]
    ds_read_b64_tr_b16 v[68:69], v18 offset:24576
    ds_read_b64_tr_b16 v[70:71], v18 offset:28672
    v_exp_f32 v46, v138
    v_mfma_f32_16x16x32_bf16 v[196:199], v[52:55], v[124:127], v[196:199]
    ds_read_b64_tr_b16 v[72:73], v19 offset:24576
    ds_read_b64_tr_b16 v[74:75], v19 offset:28672
    v_exp_f32 v47, v139
    v_mfma_f32_16x16x32_bf16 v[204:207], v[56:59], v[124:127], v[204:207]
    v_exp_f32 v48, v140
    v_mfma_f32_16x16x32_bf16 v[200:203], v[56:59], v[120:123], v[200:203]
    s_waitcnt vmcnt(10) lgkmcnt(4)
    v_mfma_f32_16x16x32_bf16 v[208:211], v[60:63], v[120:123], v[208:211]
    ds_read_b64_tr_b16 v[76:77], v20 offset:24576
    ds_read_b64_tr_b16 v[78:79], v20 offset:28672
    v_cvt_pk_bf16_f32 v98, v44, v45
    buffer_load_dwordx4 v24, s[8:11], s40 offen offset:2048 nt lds
    v_mfma_f32_16x16x32_bf16 v[212:215], v[60:63], v[124:127], v[212:215]
    ds_read_b64_tr_b16 v[80:81], v21 offset:24576
    ds_read_b64_tr_b16 v[82:83], v21 offset:28672
    v_exp_f32 v49, v141
    v_mfma_f32_16x16x32_bf16 v[220:223], v[64:67], v[124:127], v[220:223]
    v_cvt_pk_bf16_f32 v99, v46, v47
    v_mfma_f32_16x16x32_bf16 v[216:219], v[64:67], v[120:123], v[216:219]
    v_exp_f32 v50, v142
    s_waitcnt lgkmcnt(4)
    v_mfma_f32_16x16x32_bf16 v[224:227], v[68:71], v[120:123], v[224:227]
    ds_read_b128 v[52:55], v10 offset:49152
    v_exp_f32 v51, v143
    v_mfma_f32_16x16x32_bf16 v[228:231], v[68:71], v[124:127], v[228:231]
    ds_read_b128 v[56:59], v10 offset:53248
    v_mfma_f32_16x16x32_bf16 v[236:239], v[72:75], v[124:127], v[236:239]
    v_exp_f32 v44, v144
    v_mfma_f32_16x16x32_bf16 v[232:235], v[72:75], v[120:123], v[232:235]
    v_cvt_pk_bf16_f32 v102, v48, v49
    s_waitcnt vmcnt(10) lgkmcnt(2)
    v_mfma_f32_16x16x32_bf16 v[240:243], v[76:79], v[120:123], v[240:243]
    ds_read_b128 v[60:63], v10 offset:57344
    v_exp_f32 v45, v145
    buffer_load_dwordx4 v25, s[8:11], s40 offen offset:3072 nt lds
    s_add_u32 s40, s40, 16384
    v_mfma_f32_16x16x32_bf16 v[244:247], v[76:79], v[124:127], v[244:247]
    ds_read_b128 v[64:67], v10 offset:61440
    v_cvt_pk_bf16_f32 v103, v50, v51
    v_mfma_f32_16x16x32_bf16 v[252:255], v[80:83], v[124:127], v[252:255]
    v_exp_f32 v46, v146
    v_mfma_f32_16x16x32_bf16 v[248:251], v[80:83], v[120:123], v[248:251]
    s_waitcnt lgkmcnt(2)
    v_mfma_f32_16x16x32_bf16 v[160:163], v[52:55], a[0:3], v[36:39]
    ds_read_b128 v[68:71], v11 offset:49152
    v_exp_f32 v47, v147
    v_mfma_f32_16x16x32_bf16 v[164:167], v[52:55], a[16:19], v[40:43]
    ds_read_b128 v[72:75], v11 offset:53248
    v_exp_f32 v48, v148
    v_mfma_f32_16x16x32_bf16 v[172:175], v[56:59], a[16:19], v[40:43]
    v_cvt_pk_bf16_f32 v104, v44, v45
    v_mfma_f32_16x16x32_bf16 v[168:171], v[56:59], a[0:3], v[36:39]
    v_exp_f32 v49, v149
    s_add_u32 m0, s43, 0
    s_waitcnt vmcnt(10) lgkmcnt(2)
    v_mfma_f32_16x16x32_bf16 v[176:179], v[60:63], a[0:3], v[36:39]
    ds_read_b128 v[76:79], v11 offset:57344
    v_cvt_pk_bf16_f32 v105, v46, v47
    buffer_load_dwordx4 v26, s[12:15], s41 offen offset:0 nt lds
    v_mfma_f32_16x16x32_bf16 v[180:183], v[60:63], a[16:19], v[40:43]
    ds_read_b128 v[80:83], v11 offset:61440
    v_exp_f32 v50, v150
    v_mfma_f32_16x16x32_bf16 v[188:191], v[64:67], a[16:19], v[40:43]
    v_exp_f32 v51, v151
    v_mfma_f32_16x16x32_bf16 v[88:91], v[84:87], v[96:99], 0
    v_mfma_f32_16x16x32_bf16 v[184:187], v[64:67], a[0:3], v[36:39]
    v_exp_f32 v44, v152
    v_mfma_f32_16x16x32_bf16 v[92:95], v[84:87], v[100:103], 0
    s_waitcnt lgkmcnt(2)
    v_mfma_f32_16x16x32_bf16 v[160:163], v[68:71], a[4:7], v[160:163]
    ds_read_b128 v[52:55], v12 offset:49152
    v_cvt_pk_bf16_f32 v108, v48, v49
    v_mfma_f32_16x16x32_bf16 v[164:167], v[68:71], a[20:23], v[164:167]
    ds_read_b128 v[56:59], v12 offset:53248
    v_exp_f32 v45, v153
    v_mfma_f32_16x16x32_bf16 v[172:175], v[72:75], a[20:23], v[172:175]
    v_cvt_pk_bf16_f32 v109, v50, v51
    v_mfma_f32_16x16x32_bf16 v[168:171], v[72:75], a[4:7], v[168:171]
    v_exp_f32 v46, v154
    s_waitcnt vmcnt(10) lgkmcnt(2)
    v_mfma_f32_16x16x32_bf16 v[176:179], v[76:79], a[4:7], v[176:179]
    ds_read_b128 v[60:63], v12 offset:57344
    v_exp_f32 v47, v155
    buffer_load_dwordx4 v27, s[12:15], s41 offen offset:1024 nt lds
    v_mfma_f32_16x16x32_bf16 v[180:183], v[76:79], a[20:23], v[180:183]
    ds_read_b128 v[64:67], v12 offset:61440
    v_exp_f32 v48, v156
    v_mfma_f32_16x16x32_bf16 v[188:191], v[80:83], a[20:23], v[188:191]
    v_cvt_pk_bf16_f32 v106, v44, v45
    v_mfma_f32_16x16x32_bf16 v[184:187], v[80:83], a[4:7], v[184:187]
    v_exp_f32 v49, v157
    s_waitcnt vmcnt(10) lgkmcnt(2)
    v_mfma_f32_16x16x32_bf16 v[160:163], v[52:55], a[8:11], v[160:163]
    ds_read_b128 v[68:71], v13 offset:49152
    v_cvt_pk_bf16_f32 v107, v46, v47
    buffer_load_dwordx4 v26, s[12:15], s41 offen offset:2048 nt lds
    v_mfma_f32_16x16x32_bf16 v[164:167], v[52:55], a[24:27], v[164:167]
    ds_read_b128 v[72:75], v13 offset:53248
    v_exp_f32 v50, v158
    v_mfma_f32_16x16x32_bf16 v[172:175], v[56:59], a[24:27], v[172:175]
    v_exp_f32 v51, v159
    v_mfma_f32_16x16x32_bf16 v[168:171], v[56:59], a[8:11], v[168:171]
    s_nop 0
    s_waitcnt lgkmcnt(2)
    v_mfma_f32_16x16x32_bf16 v[176:179], v[60:63], a[8:11], v[176:179]
    ds_read_b128 v[76:79], v13 offset:57344
    v_cvt_pk_bf16_f32 v110, v48, v49
    v_mfma_f32_16x16x32_bf16 v[180:183], v[60:63], a[24:27], v[180:183]
    ds_read_b128 v[80:83], v13 offset:61440
    v_cvt_pk_bf16_f32 v111, v50, v51
    v_mfma_f32_16x16x32_bf16 v[188:191], v[64:67], a[24:27], v[188:191]
    v_mfma_f32_16x16x32_bf16 v[184:187], v[64:67], a[8:11], v[184:187]
    s_waitcnt vmcnt(6) lgkmcnt(2)
    v_mfma_f32_16x16x32_bf16 v[160:163], v[68:71], a[12:15], v[160:163]
    buffer_load_dwordx4 v27, s[12:15], s41 offen offset:3072 nt lds
    s_add_u32 s41, s41, 16384
    v_mfma_f32_16x16x32_bf16 v[88:91], v[84:87], v[104:107], v[88:91]
    v_mfma_f32_16x16x32_bf16 v[164:167], v[68:71], a[28:31], v[164:167]
    v_mfma_f32_16x16x32_bf16 v[92:95], v[84:87], v[108:111], v[92:95]
    v_mfma_f32_16x16x32_bf16 v[172:175], v[72:75], a[28:31], v[172:175]
    s_waitcnt vmcnt(8) lgkmcnt(0)
    s_barrier
    ds_read_b64_tr_b16 v[52:53], v14 offset:32768
    ds_read_b64_tr_b16 v[54:55], v14 offset:36864
    v_mfma_f32_16x16x32_bf16 v[168:171], v[72:75], a[12:15], v[168:171]
    s_add_u32 m0, s84, 0
    ds_read_b64_tr_b16 v[56:57], v15 offset:32768
    ds_read_b64_tr_b16 v[58:59], v15 offset:36864
    v_mfma_f32_16x16x32_bf16 v[176:179], v[76:79], a[12:15], v[176:179]
    ds_read_b64_tr_b16 v[60:61], v16 offset:32768
    ds_read_b64_tr_b16 v[62:63], v16 offset:36864
    buffer_load_dwordx4 v30, s[28:31], s94 offen offset:0 lds
    v_mfma_f32_16x16x32_bf16 v[180:183], v[76:79], a[28:31], v[180:183]
    ds_read_b64_tr_b16 v[64:65], v17 offset:32768
    ds_read_b64_tr_b16 v[66:67], v17 offset:36864
    buffer_load_dwordx4 v31, s[28:31], s94 offen offset:1024 lds
    v_mfma_f32_16x16x32_bf16 v[188:191], v[80:83], a[28:31], v[188:191]
    buffer_load_dwordx4 v30, s[28:31], s95 offen offset:2048 lds
    v_max_f32 v32, v88, v92
    v_mfma_f32_16x16x32_bf16 v[184:187], v[80:83], a[12:15], v[184:187]
    buffer_load_dwordx4 v31, s[28:31], s95 offen offset:3072 lds
    v_cmp_lt_f32 vcc, 0x45800000, v32
    s_swappc_b64 s[90:91], s[88:89]
    s_cbranch_vccnz L_trH1a
L_Hret1a:
    s_waitcnt lgkmcnt(12)
    v_mfma_f32_16x16x32_bf16 v[192:195], v[52:55], v[96:99], v[192:195]
    ds_read_b64_tr_b16 v[68:69], v18 offset:32768
    ds_read_b64_tr_b16 v[70:71], v18 offset:36864
    v_exp_f32 v44, v160
    v_mfma_f32_16x16x32_bf16 v[196:199], v[52:55], v[100:103], v[196:199]
    ds_read_b64_tr_b16 v[72:73], v19 offset:32768
    ds_read_b64_tr_b16 v[74:75], v19 offset:36864
    v_exp_f32 v45, v161
    v_mfma_f32_16x16x32_bf16 v[204:207], v[56:59], v[100:103], v[204:207]
    v_exp_f32 v46, v162
    v_add_f32 v28, v28, v88
    v_mfma_f32_16x16x32_bf16 v[200:203], v[56:59], v[96:99], v[200:203]
    v_exp_f32 v47, v163
    v_add_f32 v29, v29, v92
    s_add_u32 m0, s42, 49152
    s_waitcnt vmcnt(10) lgkmcnt(12)
    v_mfma_f32_16x16x32_bf16 v[208:211], v[60:63], v[96:99], v[208:211]
    ds_read_b64_tr_b16 v[76:77], v20 offset:32768
    ds_read_b64_tr_b16 v[78:79], v20 offset:36864
    v_exp_f32 v48, v164
    buffer_load_dwordx4 v22, s[8:11], s40 offen offset:0 nt lds
    v_mfma_f32_16x16x32_bf16 v[212:215], v[60:63], v[100:103], v[212:215]
    ds_read_b64_tr_b16 v[80:81], v21 offset:32768
    ds_read_b64_tr_b16 v[82:83], v21 offset:36864
    v_cvt_pk_bf16_f32 v112, v44, v45
    v_mfma_f32_16x16x32_bf16 v[220:223], v[64:67], v[100:103], v[220:223]
    v_mfma_f32_16x16x32_bf16 v[216:219], v[64:67], v[96:99], v[216:219]
    v_exp_f32 v49, v165
    s_waitcnt lgkmcnt(4)
    v_mfma_f32_16x16x32_bf16 v[224:227], v[68:71], v[96:99], v[224:227]
    ds_read_b64_tr_b16 v[52:53], v14 offset:40960
    ds_read_b64_tr_b16 v[54:55], v14 offset:45056
    v_cvt_pk_bf16_f32 v113, v46, v47
    v_mfma_f32_16x16x32_bf16 v[228:231], v[68:71], v[100:103], v[228:231]
    ds_read_b64_tr_b16 v[56:57], v15 offset:40960
    ds_read_b64_tr_b16 v[58:59], v15 offset:45056
    v_exp_f32 v50, v166
    v_mfma_f32_16x16x32_bf16 v[236:239], v[72:75], v[100:103], v[236:239]
    v_exp_f32 v51, v167
    v_mfma_f32_16x16x32_bf16 v[232:235], v[72:75], v[96:99], v[232:235]
    v_exp_f32 v44, v168
    s_waitcnt vmcnt(10) lgkmcnt(4)
    v_mfma_f32_16x16x32_bf16 v[240:243], v[76:79], v[96:99], v[240:243]
    ds_read_b64_tr_b16 v[60:61], v16 offset:40960
    ds_read_b64_tr_b16 v[62:63], v16 offset:45056
    buffer_load_dwordx4 v23, s[8:11], s40 offen offset:1024 nt lds
    v_mfma_f32_16x16x32_bf16 v[244:247], v[76:79], v[100:103], v[244:247]
    ds_read_b64_tr_b16 v[64:65], v17 offset:40960
    ds_read_b64_tr_b16 v[66:67], v17 offset:45056
    v_cvt_pk_bf16_f32 v116, v48, v49
    v_mfma_f32_16x16x32_bf16 v[252:255], v[80:83], v[100:103], v[252:255]
    v_exp_f32 v45, v169
    v_mfma_f32_16x16x32_bf16 v[248:251], v[80:83], v[96:99], v[248:251]
    v_cvt_pk_bf16_f32 v117, v50, v51
    s_waitcnt lgkmcnt(4)
    v_mfma_f32_16x16x32_bf16 v[192:195], v[52:55], v[104:107], v[192:195]
    ds_read_b64_tr_b16 v[68:69], v18 offset:40960
    ds_read_b64_tr_b16 v[70:71], v18 offset:45056
    v_exp_f32 v46, v170
    v_mfma_f32_16x16x32_bf16 v[196:199], v[52:55], v[108:111], v[196:199]
    ds_read_b64_tr_b16 v[72:73], v19 offset:40960
    ds_read_b64_tr_b16 v[74:75], v19 offset:45056
    v_exp_f32 v47, v171
    v_mfma_f32_16x16x32_bf16 v[204:207], v[56:59], v[108:111], v[204:207]
    v_exp_f32 v48, v172
    v_mfma_f32_16x16x32_bf16 v[200:203], v[56:59], v[104:107], v[200:203]
    s_waitcnt vmcnt(10) lgkmcnt(4)
    v_mfma_f32_16x16x32_bf16 v[208:211], v[60:63], v[104:107], v[208:211]
    ds_read_b64_tr_b16 v[76:77], v20 offset:40960
    ds_read_b64_tr_b16 v[78:79], v20 offset:45056
    v_cvt_pk_bf16_f32 v114, v44, v45
    buffer_load_dwordx4 v24, s[8:11], s40 offen offset:2048 nt lds
    v_mfma_f32_16x16x32_bf16 v[212:215], v[60:63], v[108:111], v[212:215]
    ds_read_b64_tr_b16 v[80:81], v21 offset:40960
    ds_read_b64_tr_b16 v[82:83], v21 offset:45056
    v_exp_f32 v49, v173
    v_mfma_f32_16x16x32_bf16 v[220:223], v[64:67], v[108:111], v[220:223]
    v_cvt_pk_bf16_f32 v115, v46, v47
    v_mfma_f32_16x16x32_bf16 v[216:219], v[64:67], v[104:107], v[216:219]
    v_exp_f32 v50, v174
    s_waitcnt lgkmcnt(4)
    v_mfma_f32_16x16x32_bf16 v[224:227], v[68:71], v[104:107], v[224:227]
    ds_read_b128 v[52:55], v10 offset:0
    v_exp_f32 v51, v175
    v_mfma_f32_16x16x32_bf16 v[228:231], v[68:71], v[108:111], v[228:231]
    ds_read_b128 v[56:59], v10 offset:4096
    v_mfma_f32_16x16x32_bf16 v[236:239], v[72:75], v[108:111], v[236:239]
    v_exp_f32 v44, v176
    v_mfma_f32_16x16x32_bf16 v[232:235], v[72:75], v[104:107], v[232:235]
    v_cvt_pk_bf16_f32 v118, v48, v49
    s_waitcnt vmcnt(10) lgkmcnt(2)
    v_mfma_f32_16x16x32_bf16 v[240:243], v[76:79], v[104:107], v[240:243]
    ds_read_b128 v[60:63], v10 offset:8192
    v_exp_f32 v45, v177
    buffer_load_dwordx4 v25, s[8:11], s40 offen offset:3072 nt lds
    s_add_u32 s40, s40, 16384
    v_mfma_f32_16x16x32_bf16 v[244:247], v[76:79], v[108:111], v[244:247]
    ds_read_b128 v[64:67], v10 offset:12288
    v_cvt_pk_bf16_f32 v119, v50, v51
    v_mfma_f32_16x16x32_bf16 v[252:255], v[80:83], v[108:111], v[252:255]
    v_exp_f32 v46, v178
    v_mfma_f32_16x16x32_bf16 v[248:251], v[80:83], v[104:107], v[248:251]
    s_waitcnt lgkmcnt(2)
    v_mfma_f32_16x16x32_bf16 v[128:131], v[52:55], a[0:3], v[36:39]
    ds_read_b128 v[68:71], v11 offset:0
    v_exp_f32 v47, v179
    v_mfma_f32_16x16x32_bf16 v[132:135], v[52:55], a[16:19], v[40:43]
    ds_read_b128 v[72:75], v11 offset:4096
    v_exp_f32 v48, v180
    v_mfma_f32_16x16x32_bf16 v[140:143], v[56:59], a[16:19], v[40:43]
    v_cvt_pk_bf16_f32 v120, v44, v45
    v_mfma_f32_16x16x32_bf16 v[136:139], v[56:59], a[0:3], v[36:39]
    v_exp_f32 v49, v181
    s_add_u32 m0, s43, 16384
    s_waitcnt vmcnt(10) lgkmcnt(2)
    v_mfma_f32_16x16x32_bf16 v[144:147], v[60:63], a[0:3], v[36:39]
    ds_read_b128 v[76:79], v11 offset:8192
    v_cvt_pk_bf16_f32 v121, v46, v47
    buffer_load_dwordx4 v26, s[12:15], s41 offen offset:0 nt lds
    v_mfma_f32_16x16x32_bf16 v[148:151], v[60:63], a[16:19], v[40:43]
    ds_read_b128 v[80:83], v11 offset:12288
    v_exp_f32 v50, v182
    v_mfma_f32_16x16x32_bf16 v[156:159], v[64:67], a[16:19], v[40:43]
    v_exp_f32 v51, v183
    v_mfma_f32_16x16x32_bf16 v[88:91], v[84:87], v[112:115], 0
    v_mfma_f32_16x16x32_bf16 v[152:155], v[64:67], a[0:3], v[36:39]
    v_exp_f32 v44, v184
    v_mfma_f32_16x16x32_bf16 v[92:95], v[84:87], v[116:119], 0
    s_waitcnt lgkmcnt(2)
    v_mfma_f32_16x16x32_bf16 v[128:131], v[68:71], a[4:7], v[128:131]
    ds_read_b128 v[52:55], v12 offset:0
    v_cvt_pk_bf16_f32 v124, v48, v49
    v_mfma_f32_16x16x32_bf16 v[132:135], v[68:71], a[20:23], v[132:135]
    ds_read_b128 v[56:59], v12 offset:4096
    v_exp_f32 v45, v185
    v_mfma_f32_16x16x32_bf16 v[140:143], v[72:75], a[20:23], v[140:143]
    v_cvt_pk_bf16_f32 v125, v50, v51
    v_mfma_f32_16x16x32_bf16 v[136:139], v[72:75], a[4:7], v[136:139]
    v_exp_f32 v46, v186
    s_waitcnt vmcnt(10) lgkmcnt(2)
    v_mfma_f32_16x16x32_bf16 v[144:147], v[76:79], a[4:7], v[144:147]
    ds_read_b128 v[60:63], v12 offset:8192
    v_exp_f32 v47, v187
    buffer_load_dwordx4 v27, s[12:15], s41 offen offset:1024 nt lds
    v_mfma_f32_16x16x32_bf16 v[148:151], v[76:79], a[20:23], v[148:151]
    ds_read_b128 v[64:67], v12 offset:12288
    v_exp_f32 v48, v188
    v_mfma_f32_16x16x32_bf16 v[156:159], v[80:83], a[20:23], v[156:159]
    v_cvt_pk_bf16_f32 v122, v44, v45
    v_mfma_f32_16x16x32_bf16 v[152:155], v[80:83], a[4:7], v[152:155]
    v_exp_f32 v49, v189
    s_waitcnt vmcnt(10) lgkmcnt(2)
    v_mfma_f32_16x16x32_bf16 v[128:131], v[52:55], a[8:11], v[128:131]
    ds_read_b128 v[68:71], v13 offset:0
    v_cvt_pk_bf16_f32 v123, v46, v47
    buffer_load_dwordx4 v26, s[12:15], s41 offen offset:2048 nt lds
    v_mfma_f32_16x16x32_bf16 v[132:135], v[52:55], a[24:27], v[132:135]
    ds_read_b128 v[72:75], v13 offset:4096
    v_exp_f32 v50, v190
    v_mfma_f32_16x16x32_bf16 v[140:143], v[56:59], a[24:27], v[140:143]
    v_exp_f32 v51, v191
    v_mfma_f32_16x16x32_bf16 v[136:139], v[56:59], a[8:11], v[136:139]
    s_nop 0
    s_waitcnt lgkmcnt(2)
    v_mfma_f32_16x16x32_bf16 v[144:147], v[60:63], a[8:11], v[144:147]
    ds_read_b128 v[76:79], v13 offset:8192
    v_cvt_pk_bf16_f32 v126, v48, v49
    v_mfma_f32_16x16x32_bf16 v[148:151], v[60:63], a[24:27], v[148:151]
    ds_read_b128 v[80:83], v13 offset:12288
    v_cvt_pk_bf16_f32 v127, v50, v51
    v_mfma_f32_16x16x32_bf16 v[156:159], v[64:67], a[24:27], v[156:159]
    v_mfma_f32_16x16x32_bf16 v[152:155], v[64:67], a[8:11], v[152:155]
    s_waitcnt vmcnt(6) lgkmcnt(2)
    v_mfma_f32_16x16x32_bf16 v[128:131], v[68:71], a[12:15], v[128:131]
    buffer_load_dwordx4 v27, s[12:15], s41 offen offset:3072 nt lds
    s_add_u32 s41, s41, 16384
    v_mfma_f32_16x16x32_bf16 v[88:91], v[84:87], v[120:123], v[88:91]
    v_mfma_f32_16x16x32_bf16 v[132:135], v[68:71], a[28:31], v[132:135]
    v_mfma_f32_16x16x32_bf16 v[92:95], v[84:87], v[124:127], v[92:95]
    v_mfma_f32_16x16x32_bf16 v[140:143], v[72:75], a[28:31], v[140:143]
    s_waitcnt vmcnt(8) lgkmcnt(0)
    s_barrier
    ds_read_b64_tr_b16 v[52:53], v14 offset:49152
    ds_read_b64_tr_b16 v[54:55], v14 offset:53248
    v_mfma_f32_16x16x32_bf16 v[136:139], v[72:75], a[12:15], v[136:139]
    s_add_u32 m0, s84, 4096
    ds_read_b64_tr_b16 v[56:57], v15 offset:49152
    ds_read_b64_tr_b16 v[58:59], v15 offset:53248
    v_mfma_f32_16x16x32_bf16 v[144:147], v[76:79], a[12:15], v[144:147]
    ds_read_b64_tr_b16 v[60:61], v16 offset:49152
    ds_read_b64_tr_b16 v[62:63], v16 offset:53248
    buffer_load_dwordx4 v30, s[28:31], s94 offen offset:0 lds
    v_mfma_f32_16x16x32_bf16 v[148:151], v[76:79], a[28:31], v[148:151]
    ds_read_b64_tr_b16 v[64:65], v17 offset:49152
    ds_read_b64_tr_b16 v[66:67], v17 offset:53248
    buffer_load_dwordx4 v31, s[28:31], s94 offen offset:1024 lds
    v_mfma_f32_16x16x32_bf16 v[156:159], v[80:83], a[28:31], v[156:159]
    buffer_load_dwordx4 v30, s[28:31], s95 offen offset:2048 lds
    v_max_f32 v32, v88, v92
    v_mfma_f32_16x16x32_bf16 v[152:155], v[80:83], a[12:15], v[152:155]
    buffer_load_dwordx4 v31, s[28:31], s95 offen offset:3072 lds
    v_cmp_lt_f32 vcc, 0x45800000, v32
    s_swappc_b64 s[90:91], s[88:89]
    s_cbranch_vccnz L_trH2a
L_Hret2a:
    s_waitcnt lgkmcnt(12)
    v_mfma_f32_16x16x32_bf16 v[192:195], v[52:55], v[112:115], v[192:195]
    ds_read_b64_tr_b16 v[68:69], v18 offset:49152
    ds_read_b64_tr_b16 v[70:71], v18 offset:53248
    v_exp_f32 v44, v128
    v_mfma_f32_16x16x32_bf16 v[196:199], v[52:55], v[116:119], v[196:199]
    ds_read_b64_tr_b16 v[72:73], v19 offset:49152
    ds_read_b64_tr_b16 v[74:75], v19 offset:53248
    v_exp_f32 v45, v129
    v_mfma_f32_16x16x32_bf16 v[204:207], v[56:59], v[116:119], v[204:207]
    v_exp_f32 v46, v130
    v_add_f32 v28, v28, v88
    v_mfma_f32_16x16x32_bf16 v[200:203], v[56:59], v[112:115], v[200:203]
    v_exp_f32 v47, v131
    v_add_f32 v29, v29, v92
    s_add_u32 m0, s42, 0
    s_waitcnt vmcnt(10) lgkmcnt(12)
    v_mfma_f32_16x16x32_bf16 v[208:211], v[60:63], v[112:115], v[208:211]
    ds_read_b64_tr_b16 v[76:77], v20 offset:49152
    ds_read_b64_tr_b16 v[78:79], v20 offset:53248
    v_exp_f32 v48, v132
    buffer_load_dwordx4 v22, s[8:11], s40 offen offset:0 nt lds
    v_mfma_f32_16x16x32_bf16 v[212:215], v[60:63], v[116:119], v[212:215]
    ds_read_b64_tr_b16 v[80:81], v21 offset:49152
    ds_read_b64_tr_b16 v[82:83], v21 offset:53248
    v_cvt_pk_bf16_f32 v96, v44, v45
    v_mfma_f32_16x16x32_bf16 v[220:223], v[64:67], v[116:119], v[220:223]
    v_mfma_f32_16x16x32_bf16 v[216:219], v[64:67], v[112:115], v[216:219]
    v_exp_f32 v49, v133
    s_waitcnt lgkmcnt(4)
    v_mfma_f32_16x16x32_bf16 v[224:227], v[68:71], v[112:115], v[224:227]
    ds_read_b64_tr_b16 v[52:53], v14 offset:57344
    ds_read_b64_tr_b16 v[54:55], v14 offset:61440
    v_cvt_pk_bf16_f32 v97, v46, v47
    v_mfma_f32_16x16x32_bf16 v[228:231], v[68:71], v[116:119], v[228:231]
    ds_read_b64_tr_b16 v[56:57], v15 offset:57344
    ds_read_b64_tr_b16 v[58:59], v15 offset:61440
    v_exp_f32 v50, v134
    v_mfma_f32_16x16x32_bf16 v[236:239], v[72:75], v[116:119], v[236:239]
    v_exp_f32 v51, v135
    v_mfma_f32_16x16x32_bf16 v[232:235], v[72:75], v[112:115], v[232:235]
    v_exp_f32 v44, v136
    s_waitcnt vmcnt(10) lgkmcnt(4)
    v_mfma_f32_16x16x32_bf16 v[240:243], v[76:79], v[112:115], v[240:243]
    ds_read_b64_tr_b16 v[60:61], v16 offset:57344
    ds_read_b64_tr_b16 v[62:63], v16 offset:61440
    buffer_load_dwordx4 v23, s[8:11], s40 offen offset:1024 nt lds
    v_mfma_f32_16x16x32_bf16 v[244:247], v[76:79], v[116:119], v[244:247]
    ds_read_b64_tr_b16 v[64:65], v17 offset:57344
    ds_read_b64_tr_b16 v[66:67], v17 offset:61440
    v_cvt_pk_bf16_f32 v100, v48, v49
    v_mfma_f32_16x16x32_bf16 v[252:255], v[80:83], v[116:119], v[252:255]
    v_exp_f32 v45, v137
    v_mfma_f32_16x16x32_bf16 v[248:251], v[80:83], v[112:115], v[248:251]
    v_cvt_pk_bf16_f32 v101, v50, v51
    s_waitcnt lgkmcnt(4)
    v_mfma_f32_16x16x32_bf16 v[192:195], v[52:55], v[120:123], v[192:195]
    ds_read_b64_tr_b16 v[68:69], v18 offset:57344
    ds_read_b64_tr_b16 v[70:71], v18 offset:61440
    v_exp_f32 v46, v138
    v_mfma_f32_16x16x32_bf16 v[196:199], v[52:55], v[124:127], v[196:199]
    ds_read_b64_tr_b16 v[72:73], v19 offset:57344
    ds_read_b64_tr_b16 v[74:75], v19 offset:61440
    v_exp_f32 v47, v139
    v_mfma_f32_16x16x32_bf16 v[204:207], v[56:59], v[124:127], v[204:207]
    v_exp_f32 v48, v140
    v_mfma_f32_16x16x32_bf16 v[200:203], v[56:59], v[120:123], v[200:203]
    s_waitcnt vmcnt(10) lgkmcnt(4)
    v_mfma_f32_16x16x32_bf16 v[208:211], v[60:63], v[120:123], v[208:211]
    ds_read_b64_tr_b16 v[76:77], v20 offset:57344
    ds_read_b64_tr_b16 v[78:79], v20 offset:61440
    v_cvt_pk_bf16_f32 v98, v44, v45
    buffer_load_dwordx4 v24, s[8:11], s40 offen offset:2048 nt lds
    v_mfma_f32_16x16x32_bf16 v[212:215], v[60:63], v[124:127], v[212:215]
    ds_read_b64_tr_b16 v[80:81], v21 offset:57344
    ds_read_b64_tr_b16 v[82:83], v21 offset:61440
    v_exp_f32 v49, v141
    v_mfma_f32_16x16x32_bf16 v[220:223], v[64:67], v[124:127], v[220:223]
    v_cvt_pk_bf16_f32 v99, v46, v47
    v_mfma_f32_16x16x32_bf16 v[216:219], v[64:67], v[120:123], v[216:219]
    v_exp_f32 v50, v142
    s_waitcnt lgkmcnt(4)
    v_mfma_f32_16x16x32_bf16 v[224:227], v[68:71], v[120:123], v[224:227]
    ds_read_b128 v[52:55], v10 offset:16384
    v_exp_f32 v51, v143
    v_mfma_f32_16x16x32_bf16 v[228:231], v[68:71], v[124:127], v[228:231]
    ds_read_b128 v[56:59], v10 offset:20480
    v_mfma_f32_16x16x32_bf16 v[236:239], v[72:75], v[124:127], v[236:239]
    v_exp_f32 v44, v144
    v_mfma_f32_16x16x32_bf16 v[232:235], v[72:75], v[120:123], v[232:235]
    v_cvt_pk_bf16_f32 v102, v48, v49
    s_waitcnt vmcnt(10) lgkmcnt(2)
    v_mfma_f32_16x16x32_bf16 v[240:243], v[76:79], v[120:123], v[240:243]
    ds_read_b128 v[60:63], v10 offset:24576
    v_exp_f32 v45, v145
    buffer_load_dwordx4 v25, s[8:11], s40 offen offset:3072 nt lds
    s_add_u32 s40, s40, 16384
    v_mfma_f32_16x16x32_bf16 v[244:247], v[76:79], v[124:127], v[244:247]
    ds_read_b128 v[64:67], v10 offset:28672
    v_cvt_pk_bf16_f32 v103, v50, v51
    v_mfma_f32_16x16x32_bf16 v[252:255], v[80:83], v[124:127], v[252:255]
    v_exp_f32 v46, v146
    v_mfma_f32_16x16x32_bf16 v[248:251], v[80:83], v[120:123], v[248:251]
    s_waitcnt lgkmcnt(2)
    v_mfma_f32_16x16x32_bf16 v[160:163], v[52:55], a[0:3], v[36:39]
    ds_read_b128 v[68:71], v11 offset:16384
    v_exp_f32 v47, v147
    v_mfma_f32_16x16x32_bf16 v[164:167], v[52:55], a[16:19], v[40:43]
    ds_read_b128 v[72:75], v11 offset:20480
    v_exp_f32 v48, v148
    v_mfma_f32_16x16x32_bf16 v[172:175], v[56:59], a[16:19], v[40:43]
    v_cvt_pk_bf16_f32 v104, v44, v45
    v_mfma_f32_16x16x32_bf16 v[168:171], v[56:59], a[0:3], v[36:39]
    v_exp_f32 v49, v149
    s_add_u32 m0, s43, 32768
    s_waitcnt vmcnt(10) lgkmcnt(2)
    v_mfma_f32_16x16x32_bf16 v[176:179], v[60:63], a[0:3], v[36:39]
    ds_read_b128 v[76:79], v11 offset:24576
    v_cvt_pk_bf16_f32 v105, v46, v47
    buffer_load_dwordx4 v26, s[12:15], s41 offen offset:0 nt lds
    v_mfma_f32_16x16x32_bf16 v[180:183], v[60:63], a[16:19], v[40:43]
    ds_read_b128 v[80:83], v11 offset:28672
    v_exp_f32 v50, v150
    v_mfma_f32_16x16x32_bf16 v[188:191], v[64:67], a[16:19], v[40:43]
    v_exp_f32 v51, v151
    v_mfma_f32_16x16x32_bf16 v[88:91], v[84:87], v[96:99], 0
    v_mfma_f32_16x16x32_bf16 v[184:187], v[64:67], a[0:3], v[36:39]
    v_exp_f32 v44, v152
    v_mfma_f32_16x16x32_bf16 v[92:95], v[84:87], v[100:103], 0
    s_waitcnt lgkmcnt(2)
    v_mfma_f32_16x16x32_bf16 v[160:163], v[68:71], a[4:7], v[160:163]
    ds_read_b128 v[52:55], v12 offset:16384
    v_cvt_pk_bf16_f32 v108, v48, v49
    v_mfma_f32_16x16x32_bf16 v[164:167], v[68:71], a[20:23], v[164:167]
    ds_read_b128 v[56:59], v12 offset:20480
    v_exp_f32 v45, v153
    v_mfma_f32_16x16x32_bf16 v[172:175], v[72:75], a[20:23], v[172:175]
    v_cvt_pk_bf16_f32 v109, v50, v51
    v_mfma_f32_16x16x32_bf16 v[168:171], v[72:75], a[4:7], v[168:171]
    v_exp_f32 v46, v154
    s_waitcnt vmcnt(10) lgkmcnt(2)
    v_mfma_f32_16x16x32_bf16 v[176:179], v[76:79], a[4:7], v[176:179]
    ds_read_b128 v[60:63], v12 offset:24576
    v_exp_f32 v47, v155
    buffer_load_dwordx4 v27, s[12:15], s41 offen offset:1024 nt lds
    v_mfma_f32_16x16x32_bf16 v[180:183], v[76:79], a[20:23], v[180:183]
    ds_read_b128 v[64:67], v12 offset:28672
    v_exp_f32 v48, v156
    v_mfma_f32_16x16x32_bf16 v[188:191], v[80:83], a[20:23], v[188:191]
    v_cvt_pk_bf16_f32 v106, v44, v45
    v_mfma_f32_16x16x32_bf16 v[184:187], v[80:83], a[4:7], v[184:187]
    v_exp_f32 v49, v157
    s_waitcnt vmcnt(10) lgkmcnt(2)
    v_mfma_f32_16x16x32_bf16 v[160:163], v[52:55], a[8:11], v[160:163]
    ds_read_b128 v[68:71], v13 offset:16384
    v_cvt_pk_bf16_f32 v107, v46, v47
    buffer_load_dwordx4 v26, s[12:15], s41 offen offset:2048 nt lds
    v_mfma_f32_16x16x32_bf16 v[164:167], v[52:55], a[24:27], v[164:167]
    ds_read_b128 v[72:75], v13 offset:20480
    v_exp_f32 v50, v158
    v_mfma_f32_16x16x32_bf16 v[172:175], v[56:59], a[24:27], v[172:175]
    v_exp_f32 v51, v159
    v_mfma_f32_16x16x32_bf16 v[168:171], v[56:59], a[8:11], v[168:171]
    s_nop 0
    s_waitcnt lgkmcnt(2)
    v_mfma_f32_16x16x32_bf16 v[176:179], v[60:63], a[8:11], v[176:179]
    ds_read_b128 v[76:79], v13 offset:24576
    v_cvt_pk_bf16_f32 v110, v48, v49
    v_mfma_f32_16x16x32_bf16 v[180:183], v[60:63], a[24:27], v[180:183]
    ds_read_b128 v[80:83], v13 offset:28672
    v_cvt_pk_bf16_f32 v111, v50, v51
    v_mfma_f32_16x16x32_bf16 v[188:191], v[64:67], a[24:27], v[188:191]
    v_mfma_f32_16x16x32_bf16 v[184:187], v[64:67], a[8:11], v[184:187]
    s_waitcnt vmcnt(6) lgkmcnt(2)
    v_mfma_f32_16x16x32_bf16 v[160:163], v[68:71], a[12:15], v[160:163]
    buffer_load_dwordx4 v27, s[12:15], s41 offen offset:3072 nt lds
    s_add_u32 s41, s41, 16384
    v_mfma_f32_16x16x32_bf16 v[88:91], v[84:87], v[104:107], v[88:91]
    v_mfma_f32_16x16x32_bf16 v[164:167], v[68:71], a[28:31], v[164:167]
    v_mfma_f32_16x16x32_bf16 v[92:95], v[84:87], v[108:111], v[92:95]
    v_mfma_f32_16x16x32_bf16 v[172:175], v[72:75], a[28:31], v[172:175]
    s_waitcnt vmcnt(8) lgkmcnt(0)
    s_barrier
    ds_read_b64_tr_b16 v[52:53], v14 offset:0
    ds_read_b64_tr_b16 v[54:55], v14 offset:4096
    v_mfma_f32_16x16x32_bf16 v[168:171], v[72:75], a[12:15], v[168:171]
    s_add_u32 m0, s84, 0
    ds_read_b64_tr_b16 v[56:57], v15 offset:0
    ds_read_b64_tr_b16 v[58:59], v15 offset:4096
    v_mfma_f32_16x16x32_bf16 v[176:179], v[76:79], a[12:15], v[176:179]
    ds_read_b64_tr_b16 v[60:61], v16 offset:0
    ds_read_b64_tr_b16 v[62:63], v16 offset:4096
    buffer_load_dwordx4 v30, s[28:31], s94 offen offset:0 lds
    v_mfma_f32_16x16x32_bf16 v[180:183], v[76:79], a[28:31], v[180:183]
    ds_read_b64_tr_b16 v[64:65], v17 offset:0
    ds_read_b64_tr_b16 v[66:67], v17 offset:4096
    buffer_load_dwordx4 v31, s[28:31], s94 offen offset:1024 lds
    v_mfma_f32_16x16x32_bf16 v[188:191], v[80:83], a[28:31], v[188:191]
    buffer_load_dwordx4 v30, s[28:31], s95 offen offset:2048 lds
    v_max_f32 v32, v88, v92
    v_mfma_f32_16x16x32_bf16 v[184:187], v[80:83], a[12:15], v[184:187]
    buffer_load_dwordx4 v31, s[28:31], s95 offen offset:3072 lds
    v_cmp_lt_f32 vcc, 0x45800000, v32
    s_swappc_b64 s[90:91], s[88:89]
    s_cbranch_vccnz L_trH3a
L_Hret3a:
    s_cmp_eq_u32 s44, 16
    s_cbranch_scc0 L_H0a
    s_branch L_L0i
L_cons:
    s_mov_b32 s16, s90
    s_mov_b32 s17, s91
    s_mov_b32 s18, 536870912
    s_mov_b32 s19, 0x20000
    s_mov_b32 s28, s84
    s_mov_b32 s29, s85
    s_mov_b32 s30, 4194304
    s_mov_b32 s31, 0x20000
    s_mov_b32 s32, s86
    s_mov_b32 s33, s87
    s_mov_b32 s34, 524288
    s_mov_b32 s35, 0x20000
    s_lshl_b32 s4, s39, 7
    s_and_b32 s5, s39, 12
    s_add_u32 s5, s5, s36
    s_lshl_b32 s5, s5, 7
    s_load_dword s46, s[16:17], s4
    s_load_dword s47, s[16:17], s5
    v_xor_b32 v4, v3, v2
    v_lshlrev_b32 v4, 4, v4
    v_lshl_add_u32 v4, v3, 8, v4
    v_xor_b32 v10, 0, v4
    v_xor_b32 v11, 64, v4
    v_xor_b32 v12, 128, v4
    v_xor_b32 v13, 192, v4
    v_lshrrev_b32 v4, 2, v1
    v_and_b32 v5, 7, v4
    v_lshlrev_b32 v5, 5, v5
    v_lshl_add_u32 v5, v4, 8, v5
    v_and_b32 v6, 3, v1
    v_lshl_add_u32 v5, v6, 3, v5
    v_add_u32 v5, 65536, v5
    s_lshl_b32 s4, s38, 7
    v_xor_b32 v5, s4, v5
    v_xor_b32 v14, 0, v5
    v_xor_b32 v15, 32, v5
    v_xor_b32 v16, 64, v5
    v_xor_b32 v17, 96, v5
    v_xor_b32 v18, 128, v5
    v_xor_b32 v19, 160, v5
    v_xor_b32 v20, 192, v5
    v_xor_b32 v21, 224, v5
    v_lshlrev_b32 v6, 1, v2
    v_xor_b32 v6, v3, v6
    v_lshlrev_b32 v6, 4, v6
    v_lshl_add_u32 v6, v2, 10, v6
    s_lshl_b32 s4, s36, 8
    v_add_u32 v30, s4, v6
    v_xor_b32 v6, 128, v30
    v_add_u32 v31, 3072, v6
    s_lshl_b32 s94, s37, 19
    s_lshl_b32 s4, s38, 16
    s_add_u32 s94, s94, s4
    s_lshl_b32 s84, s36, 13
    s_add_u32 s86, s84, 65536
    s_add_u32 s84, s84, 131072
    v_mov_b32 v84, 0x3f803f80
    v_mov_b32 v85, v84
    v_mov_b32 v86, v84
    v_mov_b32 v87, v84
    s_lshr_b32 s4, s2, 3
    s_mul_i32 s4, s4, 7
    s_lshr_b32 s4, s4, 5
    s_add_u32 s45, s4, 6
    s_mov_b32 s82, 16384
    s_lshl_b32 s4, s2, 2
    s_add_u32 s4, s4, s36
    s_xor_b32 s5, s4, 32
    s_lshl_b32 s48, s4, 13
    s_add_u32 s48, s48, 8388608
    s_lshl_b32 s49, s5, 13
    s_add_u32 s49, s49, 8388608
    s_lshl_b32 s50, s4, 7
    s_add_u32 s59, s50, 131072
    s_add_u32 s50, s50, 262144
    s_lshl_b32 s83, s5, 7
    s_add_u32 s83, s83, 131072
    s_and_b32 s4, s2, 0xf0
    s_lshl_b32 s4, s4, 2
    s_bfe_u32 s5, s2, 0x20002
    s_add_u32 s4, s4, s5
    s_lshl_b32 s4, s4, 7
    s_add_u32 s51, s4, 262144
    s_and_b32 s4, s2, 0xf0
    s_lshl_b32 s5, s36, 2
    s_add_u32 s4, s4, s5
    s_lshl_b32 s5, s38, 1
    s_and_b32 s7, s2, 15
    s_xor_b32 s6, s5, 0
    s_add_u32 s6, s6, s4
    s_lshl_b32 s6, s6, 4
    s_add_u32 s6, s6, s7
    s_lshl_b32 s6, s6, 11
    s_add_u32 s52, s6, 16777216
    s_xor_b32 s6, s5, 1
    s_add_u32 s6, s6, s4
    s_lshl_b32 s6, s6, 4
    s_add_u32 s6, s6, s7
    s_lshl_b32 s6, s6, 11
    s_add_u32 s53, s6, 16777216
    s_xor_b32 s6, s5, 2
    s_add_u32 s6, s6, s4
    s_lshl_b32 s6, s6, 4
    s_add_u32 s6, s6, s7
    s_lshl_b32 s6, s6, 11
    s_add_u32 s54, s6, 16777216
    s_xor_b32 s6, s5, 3
    s_add_u32 s6, s6, s4
    s_lshl_b32 s6, s6, 4
    s_add_u32 s6, s6, s7
    s_lshl_b32 s6, s6, 11
    s_add_u32 s55, s6, 16777216
    s_lshl_b32 s4, s2, 15
    s_lshl_b32 s5, s36, 9
    s_add_u32 s4, s4, s5
    s_add_u32 s56, s4, 16777216
    s_lshr_b32 s4, s36, 1
    s_lshl_b32 s4, s4, 14
    s_lshl_b32 s5, s39, 15
    s_add_u32 s4, s4, s5
    s_lshl_b32 s5, s7, 6
    s_add_u32 s4, s4, s5
    s_and_b32 s5, s36, 1
    s_lshl_b32 s5, s5, 4
    s_add_u32 s57, s4, s5
    s_lshl_b32 s58, s39, 7
    v_mov_b32 v192, 0
    v_mov_b32 v193, 0
    v_mov_b32 v194, 0
    v_mov_b32 v195, 0
    v_mov_b32 v196, 0
    v_mov_b32 v197, 0
    v_mov_b32 v198, 0
    v_mov_b32 v199, 0
    v_mov_b32 v200, 0
    v_mov_b32 v201, 0
    v_mov_b32 v202, 0
    v_mov_b32 v203, 0
    v_mov_b32 v204, 0
    v_mov_b32 v205, 0
    v_mov_b32 v206, 0
    v_mov_b32 v207, 0
    v_mov_b32 v208, 0
    v_mov_b32 v209, 0
    v_mov_b32 v210, 0
    v_mov_b32 v211, 0
    v_mov_b32 v212, 0
    v_mov_b32 v213, 0
    v_mov_b32 v214, 0
    v_mov_b32 v215, 0
    v_mov_b32 v216, 0
    v_mov_b32 v217, 0
    v_mov_b32 v218, 0
    v_mov_b32 v219, 0
    v_mov_b32 v220, 0
    v_mov_b32 v221, 0
    v_mov_b32 v222, 0
    v_mov_b32 v223, 0
    v_mov_b32 v224, 0
    v_mov_b32 v225, 0
    v_mov_b32 v226, 0
    v_mov_b32 v227, 0
    v_mov_b32 v228, 0
    v_mov_b32 v229, 0
    v_mov_b32 v230, 0
    v_mov_b32 v231, 0
    v_mov_b32 v232, 0
    v_mov_b32 v233, 0
    v_mov_b32 v234, 0
    v_mov_b32 v235, 0
    v_mov_b32 v236, 0
    v_mov_b32 v237, 0
    v_mov_b32 v238, 0
    v_mov_b32 v239, 0
    v_mov_b32 v240, 0
    v_mov_b32 v241, 0
    v_mov_b32 v242, 0
    v_mov_b32 v243, 0
    v_mov_b32 v244, 0
    v_mov_b32 v245, 0
    v_mov_b32 v246, 0
    v_mov_b32 v247, 0
    v_mov_b32 v248, 0
    v_mov_b32 v249, 0
    v_mov_b32 v250, 0
    v_mov_b32 v251, 0
    v_mov_b32 v252, 0
    v_mov_b32 v253, 0
    v_mov_b32 v254, 0
    v_mov_b32 v255, 0
    s_add_u32 m0, s42, 32768
    s_nop 0
    buffer_load_dwordx4 v22, s[8:11], s40 offen offset:0 nt lds
    buffer_load_dwordx4 v23, s[8:11], s40 offen offset:1024 nt lds
    buffer_load_dwordx4 v24, s[8:11], s40 offen offset:2048 nt lds
    buffer_load_dwordx4 v25, s[8:11], s40 offen offset:3072 nt lds
    s_add_u32 s40, s40, 16384
    s_add_u32 m0, s43, 0
    s_nop 0
    buffer_load_dwordx4 v26, s[12:15], s41 offen offset:0 nt lds
    buffer_load_dwordx4 v27, s[12:15], s41 offen offset:1024 nt lds
    buffer_load_dwordx4 v26, s[12:15], s41 offen offset:2048 nt lds
    buffer_load_dwordx4 v27, s[12:15], s41 offen offset:3072 nt lds
    s_add_u32 s41, s41, 16384
    s_add_u32 m0, s42, 49152
    s_nop 0
    buffer_load_dwordx4 v22, s[8:11], s40 offen offset:0 nt lds
    buffer_load_dwordx4 v23, s[8:11], s40 offen offset:1024 nt lds
    buffer_load_dwordx4 v24, s[8:11], s40 offen offset:2048 nt lds
    buffer_load_dwordx4 v25, s[8:11], s40 offen offset:3072 nt lds
    s_add_u32 s40, s40, 16384
    s_add_u32 m0, s43, 16384
    s_nop 0
    buffer_load_dwordx4 v26, s[12:15], s41 offen offset:0 nt lds
    buffer_load_dwordx4 v27, s[12:15], s41 offen offset:1024 nt lds
    buffer_load_dwordx4 v26, s[12:15], s41 offen offset:2048 nt lds
    buffer_load_dwordx4 v27, s[12:15], s41 offen offset:3072 nt lds
    s_add_u32 s41, s41, 16384
    s_add_u32 m0, s43, 32768
    s_nop 0
    buffer_load_dwordx4 v26, s[12:15], s41 offen offset:0 nt lds
    buffer_load_dwordx4 v27, s[12:15], s41 offen offset:1024 nt lds
    buffer_load_dwordx4 v26, s[12:15], s41 offen offset:2048 nt lds
    buffer_load_dwordx4 v27, s[12:15], s41 offen offset:3072 nt lds
    s_add_u32 s41, s41, 16384
    s_add_u32 s81, s42, 49152
    s_lshr_b32 s4, s39, 1
    s_add_u32 s45, s4, 3
    v_lshlrev_b32 v6, 7, v0
    s_lshl_b32 s4, s37, 19
    s_lshl_b32 s5, s39, 15
    s_add_u32 s4, s4, s5
    buffer_load_dword v7, v6, s[28:31], s4 offen
    s_waitcnt lgkmcnt(0)
    s_add_u32 s46, s46, 0x9e3779b9
    s_lshl_b32 s96, s39, 3
    s_add_u32 s96, s96, s37
    s_lshl_b32 s96, s96, 2
    s_add_u32 s96, s96, s36
    s_lshl_b32 s97, s96, 7
    s_add_u32 s97, s97, 65536
    s_lshl_b32 s98, s96, 13
    s_add_u32 s98, s98, 1048576
    v_mov_b32 v8, 0
    v_lshlrev_b32 v33, 4, v1
    s_mov_b32 s4, 0
    s_mov_b64 exec, 0x1
L_pollB:
    v_mov_b32 v4, 0
    buffer_atomic_add v4, v8, s[16:19], s97 offen sc0 sc1
    s_waitcnt vmcnt(0)
    v_cmp_ne_u32 vcc, s46, v4
    s_cbranch_vccz L_gotB
    s_add_u32 s4, s4, 1
    s_cmp_lt_u32 s4, 400000
    s_cbranch_scc1 L_pollB
L_gotB:
    s_mov_b64 exec, -1
    buffer_load_dwordx4 a[0:3], v33, s[16:19], s98 offen offset:0 sc1
    buffer_load_dwordx4 a[4:7], v33, s[16:19], s98 offen offset:1024 sc1
    buffer_load_dwordx4 a[8:11], v33, s[16:19], s98 offen offset:2048 sc1
    buffer_load_dwordx4 a[12:15], v33, s[16:19], s98 offen offset:3072 sc1
    s_add_u32 s98, s98, 4096
    buffer_load_dwordx4 a[16:19], v33, s[16:19], s98 offen offset:0 sc1
    buffer_load_dwordx4 a[20:23], v33, s[16:19], s98 offen offset:1024 sc1
    buffer_load_dwordx4 a[24:27], v33, s[16:19], s98 offen offset:2048 sc1
    buffer_load_dwordx4 a[28:31], v33, s[16:19], s98 offen offset:3072 sc1
    s_waitcnt vmcnt(0)
    s_barrier
    ds_read_b128 v[52:55], v10 offset:0
    ds_read_b128 v[56:59], v10 offset:4096
    ds_read_b128 v[60:63], v10 offset:8192
    ds_read_b128 v[64:67], v10 offset:12288
    s_waitcnt lgkmcnt(2)
    v_mfma_f32_16x16x32_bf16 v[128:131], v[52:55], a[0:3], 0
    ds_read_b128 v[68:71], v11 offset:0
    v_mfma_f32_16x16x32_bf16 v[132:135], v[52:55], a[16:19], 0
    ds_read_b128 v[72:75], v11 offset:4096
    v_mfma_f32_16x16x32_bf16 v[140:143], v[56:59], a[16:19], 0
    v_mfma_f32_16x16x32_bf16 v[136:139], v[56:59], a[0:3], 0
    s_waitcnt lgkmcnt(2)
    v_mfma_f32_16x16x32_bf16 v[144:147], v[60:63], a[0:3], 0
    ds_read_b128 v[76:79], v11 offset:8192
    v_mfma_f32_16x16x32_bf16 v[148:151], v[60:63], a[16:19], 0
    ds_read_b128 v[80:83], v11 offset:12288
    v_mfma_f32_16x16x32_bf16 v[156:159], v[64:67], a[16:19], 0
    v_mfma_f32_16x16x32_bf16 v[152:155], v[64:67], a[0:3], 0
    s_waitcnt lgkmcnt(2)
    v_mfma_f32_16x16x32_bf16 v[128:131], v[68:71], a[4:7], v[128:131]
    ds_read_b128 v[52:55], v12 offset:0
    v_mfma_f32_16x16x32_bf16 v[132:135], v[68:71], a[20:23], v[132:135]
    ds_read_b128 v[56:59], v12 offset:4096
    v_mfma_f32_16x16x32_bf16 v[140:143], v[72:75], a[20:23], v[140:143]
    v_mfma_f32_16x16x32_bf16 v[136:139], v[72:75], a[4:7], v[136:139]
    s_waitcnt lgkmcnt(2)
    v_mfma_f32_16x16x32_bf16 v[144:147], v[76:79], a[4:7], v[144:147]
    ds_read_b128 v[60:63], v12 offset:8192
    v_mfma_f32_16x16x32_bf16 v[148:151], v[76:79], a[20:23], v[148:151]
    ds_read_b128 v[64:67], v12 offset:12288
    v_mfma_f32_16x16x32_bf16 v[156:159], v[80:83], a[20:23], v[156:159]
    v_mfma_f32_16x16x32_bf16 v[152:155], v[80:83], a[4:7], v[152:155]
    s_waitcnt lgkmcnt(2)
    v_mfma_f32_16x16x32_bf16 v[128:131], v[52:55], a[8:11], v[128:131]
    ds_read_b128 v[68:71], v13 offset:0
    v_mfma_f32_16x16x32_bf16 v[132:135], v[52:55], a[24:27], v[132:135]
    ds_read_b128 v[72:75], v13 offset:4096
    v_mfma_f32_16x16x32_bf16 v[140:143], v[56:59], a[24:27], v[140:143]
    v_mfma_f32_16x16x32_bf16 v[136:139], v[56:59], a[8:11], v[136:139]
    s_waitcnt lgkmcnt(2)
    v_mfma_f32_16x16x32_bf16 v[144:147], v[60:63], a[8:11], v[144:147]
    ds_read_b128 v[76:79], v13 offset:8192
    v_mfma_f32_16x16x32_bf16 v[148:151], v[60:63], a[24:27], v[148:151]
    ds_read_b128 v[80:83], v13 offset:12288
    v_mfma_f32_16x16x32_bf16 v[156:159], v[64:67], a[24:27], v[156:159]
    v_mfma_f32_16x16x32_bf16 v[152:155], v[64:67], a[8:11], v[152:155]
    s_waitcnt lgkmcnt(2)
    v_mfma_f32_16x16x32_bf16 v[128:131], v[68:71], a[12:15], v[128:131]
    v_mfma_f32_16x16x32_bf16 v[132:135], v[68:71], a[28:31], v[132:135]
    v_mfma_f32_16x16x32_bf16 v[140:143], v[72:75], a[28:31], v[140:143]
    v_mfma_f32_16x16x32_bf16 v[136:139], v[72:75], a[12:15], v[136:139]
    s_waitcnt lgkmcnt(0)
    v_mfma_f32_16x16x32_bf16 v[144:147], v[76:79], a[12:15], v[144:147]
    v_mfma_f32_16x16x32_bf16 v[148:151], v[76:79], a[28:31], v[148:151]
    v_mfma_f32_16x16x32_bf16 v[156:159], v[80:83], a[28:31], v[156:159]
    v_mfma_f32_16x16x32_bf16 v[152:155], v[80:83], a[12:15], v[152:155]
    s_barrier
    s_add_u32 m0, s42, 0
    s_nop 0
    buffer_load_dwordx4 v22, s[8:11], s40 offen offset:0 nt lds
    buffer_load_dwordx4 v23, s[8:11], s40 offen offset:1024 nt lds
    buffer_load_dwordx4 v24, s[8:11], s40 offen offset:2048 nt lds
    buffer_load_dwordx4 v25, s[8:11], s40 offen offset:3072 nt lds
    s_add_u32 s40, s40, 16384
    ds_read_b128 v[52:55], v10 offset:16384
    ds_read_b128 v[56:59], v10 offset:20480
    ds_read_b128 v[60:63], v10 offset:24576
    ds_read_b128 v[64:67], v10 offset:28672
    v_mov_b32 v28, 0
    v_mov_b32 v29, 0
    s_mov_b32 s44, 0
    s_add_u32 s80, s42, 16384
    s_add_u32 s95, s94, 6144
    s_getpc_b64 s[88:89]
L_snrefb:
    s_add_u32 s88, s88, L_snip0+128-L_snrefb
    s_addc_u32 s89, s89, 0
    v_max3_f32 v32, v128, v129, v130
    v_max3_f32 v50, v132, v133, v134
    v_max3_f32 v32, v32, v131, v136
    v_max3_f32 v50, v50, v135, v140
    v_max3_f32 v32, v32, v137, v138
    v_max3_f32 v50, v50, v141, v142
    v_max3_f32 v32, v32, v139, v144
    v_max3_f32 v50, v50, v143, v148
    v_max3_f32 v32, v32, v145, v146
    v_max3_f32 v50, v50, v149, v150
    v_max3_f32 v32, v32, v147, v152
    v_max3_f32 v50, v50, v151, v156
    v_max3_f32 v32, v32, v153, v154
    v_max3_f32 v50, v50, v157, v158
    v_max_f32 v32, v32, v155
    v_max_f32 v50, v50, v159
    v_mov_b32 v33, v32
    v_mov_b32 v51, v50
    s_nop 0
    v_permlane32_swap_b32 v32, v33
    v_permlane32_swap_b32 v50, v51
    v_max_f32 v32, v32, v33
    v_max_f32 v50, v50, v51
    v_mov_b32 v33, v32
    v_mov_b32 v51, v50
    s_nop 0
    v_permlane16_swap_b32 v32, v33
    v_permlane16_swap_b32 v50, v51
    v_max_f32 v32, v32, v33
    v_max_f32 v50, v50, v51
    v_sub_f32 v36, 0, v32
    v_sub_f32 v37, 0, v32
    v_sub_f32 v38, 0, v32
    v_sub_f32 v39, 0, v32
    v_sub_f32 v40, 0, v50
    v_sub_f32 v41, 0, v50
    v_sub_f32 v42, 0, v50
    v_sub_f32 v43, 0, v50
    s_waitcnt lgkmcnt(2)
    v_mfma_f32_16x16x32_bf16 v[160:163], v[52:55], a[0:3], v[36:39]
    ds_read_b128 v[68:71], v11 offset:16384
    v_add_f32 v128, v128, v36
    v_add_f32 v129, v129, v36
    v_add_f32 v130, v130, v36
    v_add_f32 v131, v131, v36
    v_mfma_f32_16x16x32_bf16 v[164:167], v[52:55], a[16:19], v[40:43]
    ds_read_b128 v[72:75], v11 offset:20480
    v_exp_f32 v44, v128
    v_exp_f32 v45, v129
    v_exp_f32 v46, v130
    v_mfma_f32_16x16x32_bf16 v[172:175], v[56:59], a[16:19], v[40:43]
    v_exp_f32 v47, v131
    v_add_f32 v132, v132, v40
    v_add_f32 v133, v133, v40
    v_mfma_f32_16x16x32_bf16 v[168:171], v[56:59], a[0:3], v[36:39]
    v_add_f32 v134, v134, v40
    v_add_f32 v135, v135, v40
    v_exp_f32 v48, v132
    s_waitcnt lgkmcnt(2)
    v_mfma_f32_16x16x32_bf16 v[176:179], v[60:63], a[0:3], v[36:39]
    ds_read_b128 v[76:79], v11 offset:24576
    v_cvt_pk_bf16_f32 v96, v44, v45
    v_exp_f32 v49, v133
    v_cvt_pk_bf16_f32 v97, v46, v47
    v_exp_f32 v50, v134
    v_mfma_f32_16x16x32_bf16 v[180:183], v[60:63], a[16:19], v[40:43]
    ds_read_b128 v[80:83], v11 offset:28672
    v_exp_f32 v51, v135
    v_add_f32 v136, v136, v36
    v_add_f32 v137, v137, v36
    v_mfma_f32_16x16x32_bf16 v[188:191], v[64:67], a[16:19], v[40:43]
    v_add_f32 v138, v138, v36
    v_add_f32 v139, v139, v36
    v_exp_f32 v44, v136
    v_mfma_f32_16x16x32_bf16 v[184:187], v[64:67], a[0:3], v[36:39]
    v_cvt_pk_bf16_f32 v100, v48, v49
    v_exp_f32 v45, v137
    v_cvt_pk_bf16_f32 v101, v50, v51
    s_waitcnt lgkmcnt(2)
    v_mfma_f32_16x16x32_bf16 v[160:163], v[68:71], a[4:7], v[160:163]
    ds_read_b128 v[52:55], v12 offset:16384
    v_exp_f32 v46, v138
    v_exp_f32 v47, v139
    v_add_f32 v140, v140, v40
    v_add_f32 v141, v141, v40
    v_mfma_f32_16x16x32_bf16 v[164:167], v[68:71], a[20:23], v[164:167]
    ds_read_b128 v[56:59], v12 offset:20480
    v_add_f32 v142, v142, v40
    v_add_f32 v143, v143, v40
    v_exp_f32 v48, v140
    v_mfma_f32_16x16x32_bf16 v[172:175], v[72:75], a[20:23], v[172:175]
    v_cvt_pk_bf16_f32 v98, v44, v45
    v_exp_f32 v49, v141
    v_cvt_pk_bf16_f32 v99, v46, v47
    v_mfma_f32_16x16x32_bf16 v[168:171], v[72:75], a[4:7], v[168:171]
    v_exp_f32 v50, v142
    v_exp_f32 v51, v143
    v_add_f32 v144, v144, v36
    s_waitcnt lgkmcnt(2)
    v_mfma_f32_16x16x32_bf16 v[176:179], v[76:79], a[4:7], v[176:179]
    ds_read_b128 v[60:63], v12 offset:24576
    v_add_f32 v145, v145, v36
    v_add_f32 v146, v146, v36
    v_add_f32 v147, v147, v36
    v_exp_f32 v44, v144
    v_mfma_f32_16x16x32_bf16 v[180:183], v[76:79], a[20:23], v[180:183]
    ds_read_b128 v[64:67], v12 offset:28672
    v_cvt_pk_bf16_f32 v102, v48, v49
    v_exp_f32 v45, v145
    v_cvt_pk_bf16_f32 v103, v50, v51
    v_mfma_f32_16x16x32_bf16 v[188:191], v[80:83], a[20:23], v[188:191]
    v_exp_f32 v46, v146
    v_exp_f32 v47, v147
    v_add_f32 v148, v148, v40
    v_mfma_f32_16x16x32_bf16 v[184:187], v[80:83], a[4:7], v[184:187]
    v_add_f32 v149, v149, v40
    v_add_f32 v150, v150, v40
    v_add_f32 v151, v151, v40
    s_waitcnt lgkmcnt(2)
    v_mfma_f32_16x16x32_bf16 v[160:163], v[52:55], a[8:11], v[160:163]
    ds_read_b128 v[68:71], v13 offset:16384
    v_exp_f32 v48, v148
    v_cvt_pk_bf16_f32 v104, v44, v45
    v_exp_f32 v49, v149
    v_cvt_pk_bf16_f32 v105, v46, v47
    v_mfma_f32_16x16x32_bf16 v[88:91], v[84:87], v[96:99], 0
    v_mfma_f32_16x16x32_bf16 v[164:167], v[52:55], a[24:27], v[164:167]
    ds_read_b128 v[72:75], v13 offset:20480
    v_exp_f32 v50, v150
    v_exp_f32 v51, v151
    v_add_f32 v152, v152, v36
    v_mfma_f32_16x16x32_bf16 v[92:95], v[84:87], v[100:103], 0
    v_mfma_f32_16x16x32_bf16 v[172:175], v[56:59], a[24:27], v[172:175]
    v_add_f32 v153, v153, v36
    v_add_f32 v154, v154, v36
    v_add_f32 v155, v155, v36
    v_mfma_f32_16x16x32_bf16 v[168:171], v[56:59], a[8:11], v[168:171]
    v_exp_f32 v44, v152
    v_cvt_pk_bf16_f32 v108, v48, v49
    v_exp_f32 v45, v153
    s_waitcnt lgkmcnt(2)
    v_mfma_f32_16x16x32_bf16 v[176:179], v[60:63], a[8:11], v[176:179]
    ds_read_b128 v[76:79], v13 offset:24576
    v_cvt_pk_bf16_f32 v109, v50, v51
    v_exp_f32 v46, v154
    v_exp_f32 v47, v155
    v_add_f32 v156, v156, v40
    v_mfma_f32_16x16x32_bf16 v[180:183], v[60:63], a[24:27], v[180:183]
    ds_read_b128 v[80:83], v13 offset:28672
    v_add_f32 v157, v157, v40
    v_add_f32 v158, v158, v40
    v_add_f32 v159, v159, v40
    v_mfma_f32_16x16x32_bf16 v[188:191], v[64:67], a[24:27], v[188:191]
    v_exp_f32 v48, v156
    v_cvt_pk_bf16_f32 v106, v44, v45
    v_exp_f32 v49, v157
    v_mfma_f32_16x16x32_bf16 v[184:187], v[64:67], a[8:11], v[184:187]
    v_cvt_pk_bf16_f32 v107, v46, v47
    v_exp_f32 v50, v158
    v_exp_f32 v51, v159
    s_waitcnt lgkmcnt(2)
    v_mfma_f32_16x16x32_bf16 v[160:163], v[68:71], a[12:15], v[160:163]
    s_nop 0
    v_cvt_pk_bf16_f32 v110, v48, v49
    v_cvt_pk_bf16_f32 v111, v50, v51
    v_mfma_f32_16x16x32_bf16 v[164:167], v[68:71], a[28:31], v[164:167]
    v_mfma_f32_16x16x32_bf16 v[88:91], v[84:87], v[104:107], v[88:91]
    v_mfma_f32_16x16x32_bf16 v[92:95], v[84:87], v[108:111], v[92:95]
    v_mfma_f32_16x16x32_bf16 v[172:175], v[72:75], a[28:31], v[172:175]
    s_waitcnt vmcnt(4) lgkmcnt(0)
    s_barrier
    ds_read_b64_tr_b16 v[52:53], v14 offset:0
    ds_read_b64_tr_b16 v[54:55], v14 offset:4096
    v_mfma_f32_16x16x32_bf16 v[168:171], v[72:75], a[12:15], v[168:171]
    ds_read_b64_tr_b16 v[56:57], v15 offset:0
    ds_read_b64_tr_b16 v[58:59], v15 offset:4096
    v_mfma_f32_16x16x32_bf16 v[176:179], v[76:79], a[12:15], v[176:179]
    ds_read_b64_tr_b16 v[60:61], v16 offset:0
    ds_read_b64_tr_b16 v[62:63], v16 offset:4096
    v_mfma_f32_16x16x32_bf16 v[180:183], v[76:79], a[28:31], v[180:183]
    ds_read_b64_tr_b16 v[64:65], v17 offset:0
    ds_read_b64_tr_b16 v[66:67], v17 offset:4096
    v_mfma_f32_16x16x32_bf16 v[188:191], v[80:83], a[28:31], v[188:191]
    v_max_f32 v32, v88, v92
    v_mfma_f32_16x16x32_bf16 v[184:187], v[80:83], a[12:15], v[184:187]
    v_cmp_lt_f32 vcc, 0x45800000, v32
    s_cbranch_vccnz L_trJ1b
L_H0b:
    s_waitcnt lgkmcnt(4)
    v_mfma_f32_16x16x32_bf16 v[192:195], v[52:55], v[96:99], v[192:195]
    s_add_u32 s44, s44, 1
    s_cmp_eq_u32 s44, s45
    ds_read_b64_tr_b16 v[68:69], v18 offset:0
    ds_read_b64_tr_b16 v[70:71], v18 offset:4096
    v_exp_f32 v44, v160
    v_mfma_f32_16x16x32_bf16 v[196:199], v[52:55], v[100:103], v[196:199]
    s_cselect_b32 s10, 0, 524288
    s_cselect_b32 s14, 0, 524288
    s_cselect_b32 s82, 0, 16384
    ds_read_b64_tr_b16 v[72:73], v19 offset:0
    ds_read_b64_tr_b16 v[74:75], v19 offset:4096
    v_exp_f32 v45, v161
    v_mfma_f32_16x16x32_bf16 v[204:207], v[56:59], v[100:103], v[204:207]
    v_exp_f32 v46, v162
    v_add_f32 v28, v28, v88
    v_mfma_f32_16x16x32_bf16 v[200:203], v[56:59], v[96:99], v[200:203]
    v_exp_f32 v47, v163
    v_add_f32 v29, v29, v92
    s_mov_b32 m0, s80
    s_waitcnt vmcnt(6) lgkmcnt(4)
    v_mfma_f32_16x16x32_bf16 v[208:211], v[60:63], v[96:99], v[208:211]
    ds_read_b64_tr_b16 v[76:77], v20 offset:0
    ds_read_b64_tr_b16 v[78:79], v20 offset:4096
    v_exp_f32 v48, v164
    buffer_load_dwordx4 v22, s[8:11], s40 offen offset:0 nt lds
    v_mfma_f32_16x16x32_bf16 v[212:215], v[60:63], v[100:103], v[212:215]
    ds_read_b64_tr_b16 v[80:81], v21 offset:0
    ds_read_b64_tr_b16 v[82:83], v21 offset:4096
    v_cvt_pk_bf16_f32 v112, v44, v45
    v_mfma_f32_16x16x32_bf16 v[220:223], v[64:67], v[100:103], v[220:223]
    v_mfma_f32_16x16x32_bf16 v[216:219], v[64:67], v[96:99], v[216:219]
    v_exp_f32 v49, v165
    s_waitcnt lgkmcnt(4)
    v_mfma_f32_16x16x32_bf16 v[224:227], v[68:71], v[96:99], v[224:227]
    ds_read_b64_tr_b16 v[52:53], v14 offset:8192
    ds_read_b64_tr_b16 v[54:55], v14 offset:12288
    v_cvt_pk_bf16_f32 v113, v46, v47
    v_mfma_f32_16x16x32_bf16 v[228:231], v[68:71], v[100:103], v[228:231]
    ds_read_b64_tr_b16 v[56:57], v15 offset:8192
    ds_read_b64_tr_b16 v[58:59], v15 offset:12288
    v_exp_f32 v50, v166
    v_mfma_f32_16x16x32_bf16 v[236:239], v[72:75], v[100:103], v[236:239]
    v_exp_f32 v51, v167
    v_mfma_f32_16x16x32_bf16 v[232:235], v[72:75], v[96:99], v[232:235]
    v_exp_f32 v44, v168
    s_waitcnt vmcnt(5) lgkmcnt(4)
    v_mfma_f32_16x16x32_bf16 v[240:243], v[76:79], v[96:99], v[240:243]
    ds_read_b64_tr_b16 v[60:61], v16 offset:8192
    ds_read_b64_tr_b16 v[62:63], v16 offset:12288
    buffer_load_dwordx4 v23, s[8:11], s40 offen offset:1024 nt lds
    s_add_u32 s80, s80, s82
    v_mfma_f32_16x16x32_bf16 v[244:247], v[76:79], v[100:103], v[244:247]
    ds_read_b64_tr_b16 v[64:65], v17 offset:8192
    ds_read_b64_tr_b16 v[66:67], v17 offset:12288
    v_cvt_pk_bf16_f32 v116, v48, v49
    v_mfma_f32_16x16x32_bf16 v[252:255], v[80:83], v[100:103], v[252:255]
    v_exp_f32 v45, v169
    v_mfma_f32_16x16x32_bf16 v[248:251], v[80:83], v[96:99], v[248:251]
    v_cvt_pk_bf16_f32 v117, v50, v51
    s_waitcnt lgkmcnt(4)
    v_mfma_f32_16x16x32_bf16 v[192:195], v[52:55], v[104:107], v[192:195]
    ds_read_b64_tr_b16 v[68:69], v18 offset:8192
    ds_read_b64_tr_b16 v[70:71], v18 offset:12288
    v_exp_f32 v46, v170
    v_mfma_f32_16x16x32_bf16 v[196:199], v[52:55], v[108:111], v[196:199]
    ds_read_b64_tr_b16 v[72:73], v19 offset:8192
    ds_read_b64_tr_b16 v[74:75], v19 offset:12288
    v_exp_f32 v47, v171
    v_mfma_f32_16x16x32_bf16 v[204:207], v[56:59], v[108:111], v[204:207]
    v_exp_f32 v48, v172
    v_mfma_f32_16x16x32_bf16 v[200:203], v[56:59], v[104:107], v[200:203]
    s_waitcnt vmcnt(5) lgkmcnt(4)
    v_mfma_f32_16x16x32_bf16 v[208:211], v[60:63], v[104:107], v[208:211]
    ds_read_b64_tr_b16 v[76:77], v20 offset:8192
    ds_read_b64_tr_b16 v[78:79], v20 offset:12288
    v_cvt_pk_bf16_f32 v114, v44, v45
    buffer_load_dwordx4 v24, s[8:11], s40 offen offset:2048 nt lds
    s_and_b32 s80, s80, 0xffff
    v_mfma_f32_16x16x32_bf16 v[212:215], v[60:63], v[108:111], v[212:215]
    ds_read_b64_tr_b16 v[80:81], v21 offset:8192
    ds_read_b64_tr_b16 v[82:83], v21 offset:12288
    v_exp_f32 v49, v173
    v_mfma_f32_16x16x32_bf16 v[220:223], v[64:67], v[108:111], v[220:223]
    v_cvt_pk_bf16_f32 v115, v46, v47
    v_mfma_f32_16x16x32_bf16 v[216:219], v[64:67], v[104:107], v[216:219]
    v_exp_f32 v50, v174
    s_waitcnt lgkmcnt(4)
    v_mfma_f32_16x16x32_bf16 v[224:227], v[68:71], v[104:107], v[224:227]
    ds_read_b128 v[52:55], v10 offset:32768
    v_exp_f32 v51, v175
    v_mfma_f32_16x16x32_bf16 v[228:231], v[68:71], v[108:111], v[228:231]
    ds_read_b128 v[56:59], v10 offset:36864
    v_mfma_f32_16x16x32_bf16 v[236:239], v[72:75], v[108:111], v[236:239]
    v_exp_f32 v44, v176
    v_mfma_f32_16x16x32_bf16 v[232:235], v[72:75], v[104:107], v[232:235]
    v_cvt_pk_bf16_f32 v118, v48, v49
    s_waitcnt vmcnt(5) lgkmcnt(2)
    v_mfma_f32_16x16x32_bf16 v[240:243], v[76:79], v[104:107], v[240:243]
    ds_read_b128 v[60:63], v10 offset:40960
    v_exp_f32 v45, v177
    buffer_load_dwordx4 v25, s[8:11], s40 offen offset:3072 nt lds
    s_add_u32 s40, s40, s82
    v_mfma_f32_16x16x32_bf16 v[244:247], v[76:79], v[108:111], v[244:247]
    ds_read_b128 v[64:67], v10 offset:45056
    v_cvt_pk_bf16_f32 v119, v50, v51
    v_mfma_f32_16x16x32_bf16 v[252:255], v[80:83], v[108:111], v[252:255]
    v_exp_f32 v46, v178
    v_mfma_f32_16x16x32_bf16 v[248:251], v[80:83], v[104:107], v[248:251]
    s_waitcnt lgkmcnt(2)
    v_mfma_f32_16x16x32_bf16 v[128:131], v[52:55], a[0:3], v[36:39]
    ds_read_b128 v[68:71], v11 offset:32768
    v_exp_f32 v47, v179
    v_mfma_f32_16x16x32_bf16 v[132:135], v[52:55], a[16:19], v[40:43]
    ds_read_b128 v[72:75], v11 offset:36864
    v_exp_f32 v48, v180
    v_mfma_f32_16x16x32_bf16 v[140:143], v[56:59], a[16:19], v[40:43]
    v_cvt_pk_bf16_f32 v120, v44, v45
    v_mfma_f32_16x16x32_bf16 v[136:139], v[56:59], a[0:3], v[36:39]
    v_exp_f32 v49, v181
    s_add_u32 m0, s81, 65536
    s_waitcnt vmcnt(6) lgkmcnt(2)
    v_mfma_f32_16x16x32_bf16 v[144:147], v[60:63], a[0:3], v[36:39]
    ds_read_b128 v[76:79], v11 offset:40960
    v_cvt_pk_bf16_f32 v121, v46, v47
    buffer_load_dwordx4 v26, s[12:15], s41 offen offset:0 nt lds
    v_mfma_f32_16x16x32_bf16 v[148:151], v[60:63], a[16:19], v[40:43]
    ds_read_b128 v[80:83], v11 offset:45056
    v_exp_f32 v50, v182
    v_mfma_f32_16x16x32_bf16 v[156:159], v[64:67], a[16:19], v[40:43]
    v_exp_f32 v51, v183
    v_mfma_f32_16x16x32_bf16 v[88:91], v[84:87], v[112:115], 0
    v_mfma_f32_16x16x32_bf16 v[152:155], v[64:67], a[0:3], v[36:39]
    v_exp_f32 v44, v184
    v_mfma_f32_16x16x32_bf16 v[92:95], v[84:87], v[116:119], 0
    s_waitcnt lgkmcnt(2)
    v_mfma_f32_16x16x32_bf16 v[128:131], v[68:71], a[4:7], v[128:131]
    ds_read_b128 v[52:55], v12 offset:32768
    v_cvt_pk_bf16_f32 v124, v48, v49
    v_mfma_f32_16x16x32_bf16 v[132:135], v[68:71], a[20:23], v[132:135]
    ds_read_b128 v[56:59], v12 offset:36864
    v_exp_f32 v45, v185
    v_mfma_f32_16x16x32_bf16 v[140:143], v[72:75], a[20:23], v[140:143]
    v_cvt_pk_bf16_f32 v125, v50, v51
    v_mfma_f32_16x16x32_bf16 v[136:139], v[72:75], a[4:7], v[136:139]
    v_exp_f32 v46, v186
    s_waitcnt vmcnt(5) lgkmcnt(2)
    v_mfma_f32_16x16x32_bf16 v[144:147], v[76:79], a[4:7], v[144:147]
    ds_read_b128 v[60:63], v12 offset:40960
    v_exp_f32 v47, v187
    buffer_load_dwordx4 v27, s[12:15], s41 offen offset:1024 nt lds
    s_add_u32 s81, s81, s82
    v_mfma_f32_16x16x32_bf16 v[148:151], v[76:79], a[20:23], v[148:151]
    ds_read_b128 v[64:67], v12 offset:45056
    v_exp_f32 v48, v188
    v_mfma_f32_16x16x32_bf16 v[156:159], v[80:83], a[20:23], v[156:159]
    v_cvt_pk_bf16_f32 v122, v44, v45
    v_mfma_f32_16x16x32_bf16 v[152:155], v[80:83], a[4:7], v[152:155]
    v_exp_f32 v49, v189
    s_waitcnt vmcnt(5) lgkmcnt(2)
    v_mfma_f32_16x16x32_bf16 v[128:131], v[52:55], a[8:11], v[128:131]
    ds_read_b128 v[68:71], v13 offset:32768
    v_cvt_pk_bf16_f32 v123, v46, v47
    buffer_load_dwordx4 v26, s[12:15], s41 offen offset:2048 nt lds
    s_and_b32 s81, s81, 0xffff
    v_mfma_f32_16x16x32_bf16 v[132:135], v[52:55], a[24:27], v[132:135]
    ds_read_b128 v[72:75], v13 offset:36864
    v_exp_f32 v50, v190
    v_mfma_f32_16x16x32_bf16 v[140:143], v[56:59], a[24:27], v[140:143]
    v_exp_f32 v51, v191
    v_mfma_f32_16x16x32_bf16 v[136:139], v[56:59], a[8:11], v[136:139]
    s_nop 0
    s_waitcnt lgkmcnt(2)
    v_mfma_f32_16x16x32_bf16 v[144:147], v[60:63], a[8:11], v[144:147]
    ds_read_b128 v[76:79], v13 offset:40960
    v_cvt_pk_bf16_f32 v126, v48, v49
    v_mfma_f32_16x16x32_bf16 v[148:151], v[60:63], a[24:27], v[148:151]
    ds_read_b128 v[80:83], v13 offset:45056
    v_cvt_pk_bf16_f32 v127, v50, v51
    v_mfma_f32_16x16x32_bf16 v[156:159], v[64:67], a[24:27], v[156:159]
    v_mfma_f32_16x16x32_bf16 v[152:155], v[64:67], a[8:11], v[152:155]
    s_waitcnt vmcnt(5) lgkmcnt(2)
    v_mfma_f32_16x16x32_bf16 v[128:131], v[68:71], a[12:15], v[128:131]
    buffer_load_dwordx4 v27, s[12:15], s41 offen offset:3072 nt lds
    s_add_u32 s41, s41, s82
    v_mfma_f32_16x16x32_bf16 v[88:91], v[84:87], v[120:123], v[88:91]
    v_mfma_f32_16x16x32_bf16 v[132:135], v[68:71], a[28:31], v[132:135]
    v_mfma_f32_16x16x32_bf16 v[92:95], v[84:87], v[124:127], v[92:95]
    v_mfma_f32_16x16x32_bf16 v[140:143], v[72:75], a[28:31], v[140:143]
    s_waitcnt vmcnt(8) lgkmcnt(0)
    s_barrier
    ds_read_b64_tr_b16 v[52:53], v14 offset:16384
    ds_read_b64_tr_b16 v[54:55], v14 offset:20480
    v_mfma_f32_16x16x32_bf16 v[136:139], v[72:75], a[12:15], v[136:139]
    ds_read_b64_tr_b16 v[56:57], v15 offset:16384
    ds_read_b64_tr_b16 v[58:59], v15 offset:20480
    v_mfma_f32_16x16x32_bf16 v[144:147], v[76:79], a[12:15], v[144:147]
    ds_read_b64_tr_b16 v[60:61], v16 offset:16384
    ds_read_b64_tr_b16 v[62:63], v16 offset:20480
    v_mfma_f32_16x16x32_bf16 v[148:151], v[76:79], a[28:31], v[148:151]
    ds_read_b64_tr_b16 v[64:65], v17 offset:16384
    ds_read_b64_tr_b16 v[66:67], v17 offset:20480
    v_mfma_f32_16x16x32_bf16 v[156:159], v[80:83], a[28:31], v[156:159]
    v_max_f32 v32, v88, v92
    v_mfma_f32_16x16x32_bf16 v[152:155], v[80:83], a[12:15], v[152:155]
    v_cmp_lt_f32 vcc, 0x45800000, v32
    s_cbranch_vccnz L_trH0b
L_Hret0b:
    s_waitcnt lgkmcnt(4)
    v_mfma_f32_16x16x32_bf16 v[192:195], v[52:55], v[112:115], v[192:195]
    s_add_u32 s44, s44, 1
    s_cmp_eq_u32 s44, s45
    ds_read_b64_tr_b16 v[68:69], v18 offset:16384
    ds_read_b64_tr_b16 v[70:71], v18 offset:20480
    v_exp_f32 v44, v128
    v_mfma_f32_16x16x32_bf16 v[196:199], v[52:55], v[116:119], v[196:199]
    s_cselect_b32 s10, 0, 524288
    s_cselect_b32 s14, 0, 524288
    s_cselect_b32 s82, 0, 16384
    ds_read_b64_tr_b16 v[72:73], v19 offset:16384
    ds_read_b64_tr_b16 v[74:75], v19 offset:20480
    v_exp_f32 v45, v129
    v_mfma_f32_16x16x32_bf16 v[204:207], v[56:59], v[116:119], v[204:207]
    v_exp_f32 v46, v130
    v_add_f32 v28, v28, v88
    v_mfma_f32_16x16x32_bf16 v[200:203], v[56:59], v[112:115], v[200:203]
    v_exp_f32 v47, v131
    v_add_f32 v29, v29, v92
    s_mov_b32 m0, s80
    s_waitcnt vmcnt(6) lgkmcnt(4)
    v_mfma_f32_16x16x32_bf16 v[208:211], v[60:63], v[112:115], v[208:211]
    ds_read_b64_tr_b16 v[76:77], v20 offset:16384
    ds_read_b64_tr_b16 v[78:79], v20 offset:20480
    v_exp_f32 v48, v132
    buffer_load_dwordx4 v22, s[8:11], s40 offen offset:0 nt lds
    v_mfma_f32_16x16x32_bf16 v[212:215], v[60:63], v[116:119], v[212:215]
    ds_read_b64_tr_b16 v[80:81], v21 offset:16384
    ds_read_b64_tr_b16 v[82:83], v21 offset:20480
    v_cvt_pk_bf16_f32 v96, v44, v45
    v_mfma_f32_16x16x32_bf16 v[220:223], v[64:67], v[116:119], v[220:223]
    v_mfma_f32_16x16x32_bf16 v[216:219], v[64:67], v[112:115], v[216:219]
    v_exp_f32 v49, v133
    s_waitcnt lgkmcnt(4)
    v_mfma_f32_16x16x32_bf16 v[224:227], v[68:71], v[112:115], v[224:227]
    ds_read_b64_tr_b16 v[52:53], v14 offset:24576
    ds_read_b64_tr_b16 v[54:55], v14 offset:28672
    v_cvt_pk_bf16_f32 v97, v46, v47
    v_mfma_f32_16x16x32_bf16 v[228:231], v[68:71], v[116:119], v[228:231]
    ds_read_b64_tr_b16 v[56:57], v15 offset:24576
    ds_read_b64_tr_b16 v[58:59], v15 offset:28672
    v_exp_f32 v50, v134
    v_mfma_f32_16x16x32_bf16 v[236:239], v[72:75], v[116:119], v[236:239]
    v_exp_f32 v51, v135
    v_mfma_f32_16x16x32_bf16 v[232:235], v[72:75], v[112:115], v[232:235]
    v_exp_f32 v44, v136
    s_waitcnt vmcnt(5) lgkmcnt(4)
    v_mfma_f32_16x16x32_bf16 v[240:243], v[76:79], v[112:115], v[240:243]
    ds_read_b64_tr_b16 v[60:61], v16 offset:24576
    ds_read_b64_tr_b16 v[62:63], v16 offset:28672
    buffer_load_dwordx4 v23, s[8:11], s40 offen offset:1024 nt lds
    s_add_u32 s80, s80, s82
    v_mfma_f32_16x16x32_bf16 v[244:247], v[76:79], v[116:119], v[244:247]
    ds_read_b64_tr_b16 v[64:65], v17 offset:24576
    ds_read_b64_tr_b16 v[66:67], v17 offset:28672
    v_cvt_pk_bf16_f32 v100, v48, v49
    v_mfma_f32_16x16x32_bf16 v[252:255], v[80:83], v[116:119], v[252:255]
    v_exp_f32 v45, v137
    v_mfma_f32_16x16x32_bf16 v[248:251], v[80:83], v[112:115], v[248:251]
    v_cvt_pk_bf16_f32 v101, v50, v51
    s_waitcnt lgkmcnt(4)
    v_mfma_f32_16x16x32_bf16 v[192:195], v[52:55], v[120:123], v[192:195]
    ds_read_b64_tr_b16 v[68:69], v18 offset:24576
    ds_read_b64_tr_b16 v[70:71], v18 offset:28672
    v_exp_f32 v46, v138
    v_mfma_f32_16x16x32_bf16 v[196:199], v[52:55], v[124:127], v[196:199]
    ds_read_b64_tr_b16 v[72:73], v19 offset:24576
    ds_read_b64_tr_b16 v[74:75], v19 offset:28672
    v_exp_f32 v47, v139
    v_mfma_f32_16x16x32_bf16 v[204:207], v[56:59], v[124:127], v[204:207]
    v_exp_f32 v48, v140
    v_mfma_f32_16x16x32_bf16 v[200:203], v[56:59], v[120:123], v[200:203]
    s_waitcnt vmcnt(5) lgkmcnt(4)
    v_mfma_f32_16x16x32_bf16 v[208:211], v[60:63], v[120:123], v[208:211]
    ds_read_b64_tr_b16 v[76:77], v20 offset:24576
    ds_read_b64_tr_b16 v[78:79], v20 offset:28672
    v_cvt_pk_bf16_f32 v98, v44, v45
    buffer_load_dwordx4 v24, s[8:11], s40 offen offset:2048 nt lds
    s_and_b32 s80, s80, 0xffff
    v_mfma_f32_16x16x32_bf16 v[212:215], v[60:63], v[124:127], v[212:215]
    ds_read_b64_tr_b16 v[80:81], v21 offset:24576
    ds_read_b64_tr_b16 v[82:83], v21 offset:28672
    v_exp_f32 v49, v141
    v_mfma_f32_16x16x32_bf16 v[220:223], v[64:67], v[124:127], v[220:223]
    v_cvt_pk_bf16_f32 v99, v46, v47
    v_mfma_f32_16x16x32_bf16 v[216:219], v[64:67], v[120:123], v[216:219]
    v_exp_f32 v50, v142
    s_waitcnt lgkmcnt(4)
    v_mfma_f32_16x16x32_bf16 v[224:227], v[68:71], v[120:123], v[224:227]
    ds_read_b128 v[52:55], v10 offset:49152
    v_exp_f32 v51, v143
    v_mfma_f32_16x16x32_bf16 v[228:231], v[68:71], v[124:127], v[228:231]
    ds_read_b128 v[56:59], v10 offset:53248
    v_mfma_f32_16x16x32_bf16 v[236:239], v[72:75], v[124:127], v[236:239]
    v_exp_f32 v44, v144
    v_mfma_f32_16x16x32_bf16 v[232:235], v[72:75], v[120:123], v[232:235]
    v_cvt_pk_bf16_f32 v102, v48, v49
    s_waitcnt vmcnt(5) lgkmcnt(2)
    v_mfma_f32_16x16x32_bf16 v[240:243], v[76:79], v[120:123], v[240:243]
    ds_read_b128 v[60:63], v10 offset:57344
    v_exp_f32 v45, v145
    buffer_load_dwordx4 v25, s[8:11], s40 offen offset:3072 nt lds
    s_add_u32 s40, s40, s82
    v_mfma_f32_16x16x32_bf16 v[244:247], v[76:79], v[124:127], v[244:247]
    ds_read_b128 v[64:67], v10 offset:61440
    v_cvt_pk_bf16_f32 v103, v50, v51
    v_mfma_f32_16x16x32_bf16 v[252:255], v[80:83], v[124:127], v[252:255]
    v_exp_f32 v46, v146
    v_mfma_f32_16x16x32_bf16 v[248:251], v[80:83], v[120:123], v[248:251]
    s_waitcnt lgkmcnt(2)
    v_mfma_f32_16x16x32_bf16 v[160:163], v[52:55], a[0:3], v[36:39]
    ds_read_b128 v[68:71], v11 offset:49152
    v_exp_f32 v47, v147
    v_mfma_f32_16x16x32_bf16 v[164:167], v[52:55], a[16:19], v[40:43]
    ds_read_b128 v[72:75], v11 offset:53248
    v_exp_f32 v48, v148
    v_mfma_f32_16x16x32_bf16 v[172:175], v[56:59], a[16:19], v[40:43]
    v_cvt_pk_bf16_f32 v104, v44, v45
    v_mfma_f32_16x16x32_bf16 v[168:171], v[56:59], a[0:3], v[36:39]
    v_exp_f32 v49, v149
    s_add_u32 m0, s81, 65536
    s_waitcnt vmcnt(6) lgkmcnt(2)
    v_mfma_f32_16x16x32_bf16 v[176:179], v[60:63], a[0:3], v[36:39]
    ds_read_b128 v[76:79], v11 offset:57344
    v_cvt_pk_bf16_f32 v105, v46, v47
    buffer_load_dwordx4 v26, s[12:15], s41 offen offset:0 nt lds
    v_mfma_f32_16x16x32_bf16 v[180:183], v[60:63], a[16:19], v[40:43]
    ds_read_b128 v[80:83], v11 offset:61440
    v_exp_f32 v50, v150
    v_mfma_f32_16x16x32_bf16 v[188:191], v[64:67], a[16:19], v[40:43]
    v_exp_f32 v51, v151
    v_mfma_f32_16x16x32_bf16 v[88:91], v[84:87], v[96:99], 0
    v_mfma_f32_16x16x32_bf16 v[184:187], v[64:67], a[0:3], v[36:39]
    v_exp_f32 v44, v152
    v_mfma_f32_16x16x32_bf16 v[92:95], v[84:87], v[100:103], 0
    s_waitcnt lgkmcnt(2)
    v_mfma_f32_16x16x32_bf16 v[160:163], v[68:71], a[4:7], v[160:163]
    ds_read_b128 v[52:55], v12 offset:49152
    v_cvt_pk_bf16_f32 v108, v48, v49
    v_mfma_f32_16x16x32_bf16 v[164:167], v[68:71], a[20:23], v[164:167]
    ds_read_b128 v[56:59], v12 offset:53248
    v_exp_f32 v45, v153
    v_mfma_f32_16x16x32_bf16 v[172:175], v[72:75], a[20:23], v[172:175]
    v_cvt_pk_bf16_f32 v109, v50, v51
    v_mfma_f32_16x16x32_bf16 v[168:171], v[72:75], a[4:7], v[168:171]
    v_exp_f32 v46, v154
    s_waitcnt vmcnt(5) lgkmcnt(2)
    v_mfma_f32_16x16x32_bf16 v[176:179], v[76:79], a[4:7], v[176:179]
    ds_read_b128 v[60:63], v12 offset:57344
    v_exp_f32 v47, v155
    buffer_load_dwordx4 v27, s[12:15], s41 offen offset:1024 nt lds
    s_add_u32 s81, s81, s82
    v_mfma_f32_16x16x32_bf16 v[180:183], v[76:79], a[20:23], v[180:183]
    ds_read_b128 v[64:67], v12 offset:61440
    v_exp_f32 v48, v156
    v_mfma_f32_16x16x32_bf16 v[188:191], v[80:83], a[20:23], v[188:191]
    v_cvt_pk_bf16_f32 v106, v44, v45
    v_mfma_f32_16x16x32_bf16 v[184:187], v[80:83], a[4:7], v[184:187]
    v_exp_f32 v49, v157
    s_waitcnt vmcnt(5) lgkmcnt(2)
    v_mfma_f32_16x16x32_bf16 v[160:163], v[52:55], a[8:11], v[160:163]
    ds_read_b128 v[68:71], v13 offset:49152
    v_cvt_pk_bf16_f32 v107, v46, v47
    buffer_load_dwordx4 v26, s[12:15], s41 offen offset:2048 nt lds
    s_and_b32 s81, s81, 0xffff
    v_mfma_f32_16x16x32_bf16 v[164:167], v[52:55], a[24:27], v[164:167]
    ds_read_b128 v[72:75], v13 offset:53248
    v_exp_f32 v50, v158
    v_mfma_f32_16x16x32_bf16 v[172:175], v[56:59], a[24:27], v[172:175]
    v_exp_f32 v51, v159
    v_mfma_f32_16x16x32_bf16 v[168:171], v[56:59], a[8:11], v[168:171]
    s_nop 0
    s_waitcnt lgkmcnt(2)
    v_mfma_f32_16x16x32_bf16 v[176:179], v[60:63], a[8:11], v[176:179]
    ds_read_b128 v[76:79], v13 offset:57344
    v_cvt_pk_bf16_f32 v110, v48, v49
    v_mfma_f32_16x16x32_bf16 v[180:183], v[60:63], a[24:27], v[180:183]
    ds_read_b128 v[80:83], v13 offset:61440
    v_cvt_pk_bf16_f32 v111, v50, v51
    v_mfma_f32_16x16x32_bf16 v[188:191], v[64:67], a[24:27], v[188:191]
    v_mfma_f32_16x16x32_bf16 v[184:187], v[64:67], a[8:11], v[184:187]
    s_waitcnt vmcnt(5) lgkmcnt(2)
    v_mfma_f32_16x16x32_bf16 v[160:163], v[68:71], a[12:15], v[160:163]
    buffer_load_dwordx4 v27, s[12:15], s41 offen offset:3072 nt lds
    s_add_u32 s41, s41, s82
    v_mfma_f32_16x16x32_bf16 v[88:91], v[84:87], v[104:107], v[88:91]
    v_mfma_f32_16x16x32_bf16 v[164:167], v[68:71], a[28:31], v[164:167]
    v_mfma_f32_16x16x32_bf16 v[92:95], v[84:87], v[108:111], v[92:95]
    v_mfma_f32_16x16x32_bf16 v[172:175], v[72:75], a[28:31], v[172:175]
    s_waitcnt vmcnt(8) lgkmcnt(0)
    s_barrier
    ds_read_b64_tr_b16 v[52:53], v14 offset:32768
    ds_read_b64_tr_b16 v[54:55], v14 offset:36864
    v_mfma_f32_16x16x32_bf16 v[168:171], v[72:75], a[12:15], v[168:171]
    ds_read_b64_tr_b16 v[56:57], v15 offset:32768
    ds_read_b64_tr_b16 v[58:59], v15 offset:36864
    v_mfma_f32_16x16x32_bf16 v[176:179], v[76:79], a[12:15], v[176:179]
    ds_read_b64_tr_b16 v[60:61], v16 offset:32768
    ds_read_b64_tr_b16 v[62:63], v16 offset:36864
    v_mfma_f32_16x16x32_bf16 v[180:183], v[76:79], a[28:31], v[180:183]
    ds_read_b64_tr_b16 v[64:65], v17 offset:32768
    ds_read_b64_tr_b16 v[66:67], v17 offset:36864
    v_mfma_f32_16x16x32_bf16 v[188:191], v[80:83], a[28:31], v[188:191]
    v_max_f32 v32, v88, v92
    v_mfma_f32_16x16x32_bf16 v[184:187], v[80:83], a[12:15], v[184:187]
    v_cmp_lt_f32 vcc, 0x45800000, v32
    s_cbranch_vccnz L_trH1b
L_Hret1b:
    s_waitcnt lgkmcnt(4)
    v_mfma_f32_16x16x32_bf16 v[192:195], v[52:55], v[96:99], v[192:195]
    s_add_u32 s44, s44, 1
    s_cmp_eq_u32 s44, s45
    ds_read_b64_tr_b16 v[68:69], v18 offset:32768
    ds_read_b64_tr_b16 v[70:71], v18 offset:36864
    v_exp_f32 v44, v160
    v_mfma_f32_16x16x32_bf16 v[196:199], v[52:55], v[100:103], v[196:199]
    s_cselect_b32 s10, 0, 524288
    s_cselect_b32 s14, 0, 524288
    s_cselect_b32 s82, 0, 16384
    ds_read_b64_tr_b16 v[72:73], v19 offset:32768
    ds_read_b64_tr_b16 v[74:75], v19 offset:36864
    v_exp_f32 v45, v161
    v_mfma_f32_16x16x32_bf16 v[204:207], v[56:59], v[100:103], v[204:207]
    v_exp_f32 v46, v162
    v_add_f32 v28, v28, v88
    v_mfma_f32_16x16x32_bf16 v[200:203], v[56:59], v[96:99], v[200:203]
    v_exp_f32 v47, v163
    v_add_f32 v29, v29, v92
    s_mov_b32 m0, s80
    s_waitcnt vmcnt(6) lgkmcnt(4)
    v_mfma_f32_16x16x32_bf16 v[208:211], v[60:63], v[96:99], v[208:211]
    ds_read_b64_tr_b16 v[76:77], v20 offset:32768
    ds_read_b64_tr_b16 v[78:79], v20 offset:36864
    v_exp_f32 v48, v164
    buffer_load_dwordx4 v22, s[8:11], s40 offen offset:0 nt lds
    v_mfma_f32_16x16x32_bf16 v[212:215], v[60:63], v[100:103], v[212:215]
    ds_read_b64_tr_b16 v[80:81], v21 offset:32768
    ds_read_b64_tr_b16 v[82:83], v21 offset:36864
    v_cvt_pk_bf16_f32 v112, v44, v45
    v_mfma_f32_16x16x32_bf16 v[220:223], v[64:67], v[100:103], v[220:223]
    v_mfma_f32_16x16x32_bf16 v[216:219], v[64:67], v[96:99], v[216:219]
    v_exp_f32 v49, v165
    s_waitcnt lgkmcnt(4)
    v_mfma_f32_16x16x32_bf16 v[224:227], v[68:71], v[96:99], v[224:227]
    ds_read_b64_tr_b16 v[52:53], v14 offset:40960
    ds_read_b64_tr_b16 v[54:55], v14 offset:45056
    v_cvt_pk_bf16_f32 v113, v46, v47
    v_mfma_f32_16x16x32_bf16 v[228:231], v[68:71], v[100:103], v[228:231]
    ds_read_b64_tr_b16 v[56:57], v15 offset:40960
    ds_read_b64_tr_b16 v[58:59], v15 offset:45056
    v_exp_f32 v50, v166
    v_mfma_f32_16x16x32_bf16 v[236:239], v[72:75], v[100:103], v[236:239]
    v_exp_f32 v51, v167
    v_mfma_f32_16x16x32_bf16 v[232:235], v[72:75], v[96:99], v[232:235]
    v_exp_f32 v44, v168
    s_waitcnt vmcnt(5) lgkmcnt(4)
    v_mfma_f32_16x16x32_bf16 v[240:243], v[76:79], v[96:99], v[240:243]
    ds_read_b64_tr_b16 v[60:61], v16 offset:40960
    ds_read_b64_tr_b16 v[62:63], v16 offset:45056
    buffer_load_dwordx4 v23, s[8:11], s40 offen offset:1024 nt lds
    s_add_u32 s80, s80, s82
    v_mfma_f32_16x16x32_bf16 v[244:247], v[76:79], v[100:103], v[244:247]
    ds_read_b64_tr_b16 v[64:65], v17 offset:40960
    ds_read_b64_tr_b16 v[66:67], v17 offset:45056
    v_cvt_pk_bf16_f32 v116, v48, v49
    v_mfma_f32_16x16x32_bf16 v[252:255], v[80:83], v[100:103], v[252:255]
    v_exp_f32 v45, v169
    v_mfma_f32_16x16x32_bf16 v[248:251], v[80:83], v[96:99], v[248:251]
    v_cvt_pk_bf16_f32 v117, v50, v51
    s_waitcnt lgkmcnt(4)
    v_mfma_f32_16x16x32_bf16 v[192:195], v[52:55], v[104:107], v[192:195]
    ds_read_b64_tr_b16 v[68:69], v18 offset:40960
    ds_read_b64_tr_b16 v[70:71], v18 offset:45056
    v_exp_f32 v46, v170
    v_mfma_f32_16x16x32_bf16 v[196:199], v[52:55], v[108:111], v[196:199]
    ds_read_b64_tr_b16 v[72:73], v19 offset:40960
    ds_read_b64_tr_b16 v[74:75], v19 offset:45056
    v_exp_f32 v47, v171
    v_mfma_f32_16x16x32_bf16 v[204:207], v[56:59], v[108:111], v[204:207]
    v_exp_f32 v48, v172
    v_mfma_f32_16x16x32_bf16 v[200:203], v[56:59], v[104:107], v[200:203]
    s_waitcnt vmcnt(5) lgkmcnt(4)
    v_mfma_f32_16x16x32_bf16 v[208:211], v[60:63], v[104:107], v[208:211]
    ds_read_b64_tr_b16 v[76:77], v20 offset:40960
    ds_read_b64_tr_b16 v[78:79], v20 offset:45056
    v_cvt_pk_bf16_f32 v114, v44, v45
    buffer_load_dwordx4 v24, s[8:11], s40 offen offset:2048 nt lds
    s_and_b32 s80, s80, 0xffff
    v_mfma_f32_16x16x32_bf16 v[212:215], v[60:63], v[108:111], v[212:215]
    ds_read_b64_tr_b16 v[80:81], v21 offset:40960
    ds_read_b64_tr_b16 v[82:83], v21 offset:45056
    v_exp_f32 v49, v173
    v_mfma_f32_16x16x32_bf16 v[220:223], v[64:67], v[108:111], v[220:223]
    v_cvt_pk_bf16_f32 v115, v46, v47
    v_mfma_f32_16x16x32_bf16 v[216:219], v[64:67], v[104:107], v[216:219]
    v_exp_f32 v50, v174
    s_waitcnt lgkmcnt(4)
    v_mfma_f32_16x16x32_bf16 v[224:227], v[68:71], v[104:107], v[224:227]
    ds_read_b128 v[52:55], v10 offset:0
    v_exp_f32 v51, v175
    v_mfma_f32_16x16x32_bf16 v[228:231], v[68:71], v[108:111], v[228:231]
    ds_read_b128 v[56:59], v10 offset:4096
    v_mfma_f32_16x16x32_bf16 v[236:239], v[72:75], v[108:111], v[236:239]
    v_exp_f32 v44, v176
    v_mfma_f32_16x16x32_bf16 v[232:235], v[72:75], v[104:107], v[232:235]
    v_cvt_pk_bf16_f32 v118, v48, v49
    s_waitcnt vmcnt(5) lgkmcnt(2)
    v_mfma_f32_16x16x32_bf16 v[240:243], v[76:79], v[104:107], v[240:243]
    ds_read_b128 v[60:63], v10 offset:8192
    v_exp_f32 v45, v177
    buffer_load_dwordx4 v25, s[8:11], s40 offen offset:3072 nt lds
    s_add_u32 s40, s40, s82
    v_mfma_f32_16x16x32_bf16 v[244:247], v[76:79], v[108:111], v[244:247]
    ds_read_b128 v[64:67], v10 offset:12288
    v_cvt_pk_bf16_f32 v119, v50, v51
    v_mfma_f32_16x16x32_bf16 v[252:255], v[80:83], v[108:111], v[252:255]
    v_exp_f32 v46, v178
    v_mfma_f32_16x16x32_bf16 v[248:251], v[80:83], v[104:107], v[248:251]
    s_waitcnt lgkmcnt(2)
    v_mfma_f32_16x16x32_bf16 v[128:131], v[52:55], a[0:3], v[36:39]
    ds_read_b128 v[68:71], v11 offset:0
    v_exp_f32 v47, v179
    v_mfma_f32_16x16x32_bf16 v[132:135], v[52:55], a[16:19], v[40:43]
    ds_read_b128 v[72:75], v11 offset:4096
    v_exp_f32 v48, v180
    v_mfma_f32_16x16x32_bf16 v[140:143], v[56:59], a[16:19], v[40:43]
    v_cvt_pk_bf16_f32 v120, v44, v45
    v_mfma_f32_16x16x32_bf16 v[136:139], v[56:59], a[0:3], v[36:39]
    v_exp_f32 v49, v181
    s_add_u32 m0, s81, 65536
    s_waitcnt vmcnt(6) lgkmcnt(2)
    v_mfma_f32_16x16x32_bf16 v[144:147], v[60:63], a[0:3], v[36:39]
    ds_read_b128 v[76:79], v11 offset:8192
    v_cvt_pk_bf16_f32 v121, v46, v47
    buffer_load_dwordx4 v26, s[12:15], s41 offen offset:0 nt lds
    v_mfma_f32_16x16x32_bf16 v[148:151], v[60:63], a[16:19], v[40:43]
    ds_read_b128 v[80:83], v11 offset:12288
    v_exp_f32 v50, v182
    v_mfma_f32_16x16x32_bf16 v[156:159], v[64:67], a[16:19], v[40:43]
    v_exp_f32 v51, v183
    v_mfma_f32_16x16x32_bf16 v[88:91], v[84:87], v[112:115], 0
    v_mfma_f32_16x16x32_bf16 v[152:155], v[64:67], a[0:3], v[36:39]
    v_exp_f32 v44, v184
    v_mfma_f32_16x16x32_bf16 v[92:95], v[84:87], v[116:119], 0
    s_waitcnt lgkmcnt(2)
    v_mfma_f32_16x16x32_bf16 v[128:131], v[68:71], a[4:7], v[128:131]
    ds_read_b128 v[52:55], v12 offset:0
    v_cvt_pk_bf16_f32 v124, v48, v49
    v_mfma_f32_16x16x32_bf16 v[132:135], v[68:71], a[20:23], v[132:135]
    ds_read_b128 v[56:59], v12 offset:4096
    v_exp_f32 v45, v185
    v_mfma_f32_16x16x32_bf16 v[140:143], v[72:75], a[20:23], v[140:143]
    v_cvt_pk_bf16_f32 v125, v50, v51
    v_mfma_f32_16x16x32_bf16 v[136:139], v[72:75], a[4:7], v[136:139]
    v_exp_f32 v46, v186
    s_waitcnt vmcnt(5) lgkmcnt(2)
    v_mfma_f32_16x16x32_bf16 v[144:147], v[76:79], a[4:7], v[144:147]
    ds_read_b128 v[60:63], v12 offset:8192
    v_exp_f32 v47, v187
    buffer_load_dwordx4 v27, s[12:15], s41 offen offset:1024 nt lds
    s_add_u32 s81, s81, s82
    v_mfma_f32_16x16x32_bf16 v[148:151], v[76:79], a[20:23], v[148:151]
    ds_read_b128 v[64:67], v12 offset:12288
    v_exp_f32 v48, v188
    v_mfma_f32_16x16x32_bf16 v[156:159], v[80:83], a[20:23], v[156:159]
    v_cvt_pk_bf16_f32 v122, v44, v45
    v_mfma_f32_16x16x32_bf16 v[152:155], v[80:83], a[4:7], v[152:155]
    v_exp_f32 v49, v189
    s_waitcnt vmcnt(5) lgkmcnt(2)
    v_mfma_f32_16x16x32_bf16 v[128:131], v[52:55], a[8:11], v[128:131]
    ds_read_b128 v[68:71], v13 offset:0
    v_cvt_pk_bf16_f32 v123, v46, v47
    buffer_load_dwordx4 v26, s[12:15], s41 offen offset:2048 nt lds
    s_and_b32 s81, s81, 0xffff
    v_mfma_f32_16x16x32_bf16 v[132:135], v[52:55], a[24:27], v[132:135]
    ds_read_b128 v[72:75], v13 offset:4096
    v_exp_f32 v50, v190
    v_mfma_f32_16x16x32_bf16 v[140:143], v[56:59], a[24:27], v[140:143]
    v_exp_f32 v51, v191
    v_mfma_f32_16x16x32_bf16 v[136:139], v[56:59], a[8:11], v[136:139]
    s_nop 0
    s_waitcnt lgkmcnt(2)
    v_mfma_f32_16x16x32_bf16 v[144:147], v[60:63], a[8:11], v[144:147]
    ds_read_b128 v[76:79], v13 offset:8192
    v_cvt_pk_bf16_f32 v126, v48, v49
    v_mfma_f32_16x16x32_bf16 v[148:151], v[60:63], a[24:27], v[148:151]
    ds_read_b128 v[80:83], v13 offset:12288
    v_cvt_pk_bf16_f32 v127, v50, v51
    v_mfma_f32_16x16x32_bf16 v[156:159], v[64:67], a[24:27], v[156:159]
    v_mfma_f32_16x16x32_bf16 v[152:155], v[64:67], a[8:11], v[152:155]
    s_waitcnt vmcnt(5) lgkmcnt(2)
    v_mfma_f32_16x16x32_bf16 v[128:131], v[68:71], a[12:15], v[128:131]
    buffer_load_dwordx4 v27, s[12:15], s41 offen offset:3072 nt lds
    s_add_u32 s41, s41, s82
    v_mfma_f32_16x16x32_bf16 v[88:91], v[84:87], v[120:123], v[88:91]
    v_mfma_f32_16x16x32_bf16 v[132:135], v[68:71], a[28:31], v[132:135]
    v_mfma_f32_16x16x32_bf16 v[92:95], v[84:87], v[124:127], v[92:95]
    v_mfma_f32_16x16x32_bf16 v[140:143], v[72:75], a[28:31], v[140:143]
    s_waitcnt vmcnt(8) lgkmcnt(0)
    s_barrier
    ds_read_b64_tr_b16 v[52:53], v14 offset:49152
    ds_read_b64_tr_b16 v[54:55], v14 offset:53248
    v_mfma_f32_16x16x32_bf16 v[136:139], v[72:75], a[12:15], v[136:139]
    ds_read_b64_tr_b16 v[56:57], v15 offset:49152
    ds_read_b64_tr_b16 v[58:59], v15 offset:53248
    v_mfma_f32_16x16x32_bf16 v[144:147], v[76:79], a[12:15], v[144:147]
    ds_read_b64_tr_b16 v[60:61], v16 offset:49152
    ds_read_b64_tr_b16 v[62:63], v16 offset:53248
    v_mfma_f32_16x16x32_bf16 v[148:151], v[76:79], a[28:31], v[148:151]
    ds_read_b64_tr_b16 v[64:65], v17 offset:49152
    ds_read_b64_tr_b16 v[66:67], v17 offset:53248
    v_mfma_f32_16x16x32_bf16 v[156:159], v[80:83], a[28:31], v[156:159]
    v_max_f32 v32, v88, v92
    v_mfma_f32_16x16x32_bf16 v[152:155], v[80:83], a[12:15], v[152:155]
    v_cmp_lt_f32 vcc, 0x45800000, v32
    s_cbranch_vccnz L_trH2b
L_Hret2b:
    s_waitcnt lgkmcnt(4)
    v_mfma_f32_16x16x32_bf16 v[192:195], v[52:55], v[112:115], v[192:195]
    s_add_u32 s44, s44, 1
    s_cmp_eq_u32 s44, s45
    ds_read_b64_tr_b16 v[68:69], v18 offset:49152
    ds_read_b64_tr_b16 v[70:71], v18 offset:53248
    v_exp_f32 v44, v128
    v_mfma_f32_16x16x32_bf16 v[196:199], v[52:55], v[116:119], v[196:199]
    s_cselect_b32 s10, 0, 524288
    s_cselect_b32 s14, 0, 524288
    s_cselect_b32 s82, 0, 16384
    ds_read_b64_tr_b16 v[72:73], v19 offset:49152
    ds_read_b64_tr_b16 v[74:75], v19 offset:53248
    v_exp_f32 v45, v129
    v_mfma_f32_16x16x32_bf16 v[204:207], v[56:59], v[116:119], v[204:207]
    v_exp_f32 v46, v130
    v_add_f32 v28, v28, v88
    v_mfma_f32_16x16x32_bf16 v[200:203], v[56:59], v[112:115], v[200:203]
    v_exp_f32 v47, v131
    v_add_f32 v29, v29, v92
    s_mov_b32 m0, s80
    s_waitcnt vmcnt(6) lgkmcnt(4)
    v_mfma_f32_16x16x32_bf16 v[208:211], v[60:63], v[112:115], v[208:211]
    ds_read_b64_tr_b16 v[76:77], v20 offset:49152
    ds_read_b64_tr_b16 v[78:79], v20 offset:53248
    v_exp_f32 v48, v132
    buffer_load_dwordx4 v22, s[8:11], s40 offen offset:0 nt lds
    v_mfma_f32_16x16x32_bf16 v[212:215], v[60:63], v[116:119], v[212:215]
    ds_read_b64_tr_b16 v[80:81], v21 offset:49152
    ds_read_b64_tr_b16 v[82:83], v21 offset:53248
    v_cvt_pk_bf16_f32 v96, v44, v45
    v_mfma_f32_16x16x32_bf16 v[220:223], v[64:67], v[116:119], v[220:223]
    v_mfma_f32_16x16x32_bf16 v[216:219], v[64:67], v[112:115], v[216:219]
    v_exp_f32 v49, v133
    s_waitcnt lgkmcnt(4)
    v_mfma_f32_16x16x32_bf16 v[224:227], v[68:71], v[112:115], v[224:227]
    ds_read_b64_tr_b16 v[52:53], v14 offset:57344
    ds_read_b64_tr_b16 v[54:55], v14 offset:61440
    v_cvt_pk_bf16_f32 v97, v46, v47
    v_mfma_f32_16x16x32_bf16 v[228:231], v[68:71], v[116:119], v[228:231]
    ds_read_b64_tr_b16 v[56:57], v15 offset:57344
    ds_read_b64_tr_b16 v[58:59], v15 offset:61440
    v_exp_f32 v50, v134
    v_mfma_f32_16x16x32_bf16 v[236:239], v[72:75], v[116:119], v[236:239]
    v_exp_f32 v51, v135
    v_mfma_f32_16x16x32_bf16 v[232:235], v[72:75], v[112:115], v[232:235]
    v_exp_f32 v44, v136
    s_waitcnt vmcnt(5) lgkmcnt(4)
    v_mfma_f32_16x16x32_bf16 v[240:243], v[76:79], v[112:115], v[240:243]
    ds_read_b64_tr_b16 v[60:61], v16 offset:57344
    ds_read_b64_tr_b16 v[62:63], v16 offset:61440
    buffer_load_dwordx4 v23, s[8:11], s40 offen offset:1024 nt lds
    s_add_u32 s80, s80, s82
    v_mfma_f32_16x16x32_bf16 v[244:247], v[76:79], v[116:119], v[244:247]
    ds_read_b64_tr_b16 v[64:65], v17 offset:57344
    ds_read_b64_tr_b16 v[66:67], v17 offset:61440
    v_cvt_pk_bf16_f32 v100, v48, v49
    v_mfma_f32_16x16x32_bf16 v[252:255], v[80:83], v[116:119], v[252:255]
    v_exp_f32 v45, v137
    v_mfma_f32_16x16x32_bf16 v[248:251], v[80:83], v[112:115], v[248:251]
    v_cvt_pk_bf16_f32 v101, v50, v51
    s_waitcnt lgkmcnt(4)
    v_mfma_f32_16x16x32_bf16 v[192:195], v[52:55], v[120:123], v[192:195]
    ds_read_b64_tr_b16 v[68:69], v18 offset:57344
    ds_read_b64_tr_b16 v[70:71], v18 offset:61440
    v_exp_f32 v46, v138
    v_mfma_f32_16x16x32_bf16 v[196:199], v[52:55], v[124:127], v[196:199]
    ds_read_b64_tr_b16 v[72:73], v19 offset:57344
    ds_read_b64_tr_b16 v[74:75], v19 offset:61440
    v_exp_f32 v47, v139
    v_mfma_f32_16x16x32_bf16 v[204:207], v[56:59], v[124:127], v[204:207]
    v_exp_f32 v48, v140
    v_mfma_f32_16x16x32_bf16 v[200:203], v[56:59], v[120:123], v[200:203]
    s_waitcnt vmcnt(5) lgkmcnt(4)
    v_mfma_f32_16x16x32_bf16 v[208:211], v[60:63], v[120:123], v[208:211]
    ds_read_b64_tr_b16 v[76:77], v20 offset:57344
    ds_read_b64_tr_b16 v[78:79], v20 offset:61440
    v_cvt_pk_bf16_f32 v98, v44, v45
    buffer_load_dwordx4 v24, s[8:11], s40 offen offset:2048 nt lds
    s_and_b32 s80, s80, 0xffff
    v_mfma_f32_16x16x32_bf16 v[212:215], v[60:63], v[124:127], v[212:215]
    ds_read_b64_tr_b16 v[80:81], v21 offset:57344
    ds_read_b64_tr_b16 v[82:83], v21 offset:61440
    v_exp_f32 v49, v141
    v_mfma_f32_16x16x32_bf16 v[220:223], v[64:67], v[124:127], v[220:223]
    v_cvt_pk_bf16_f32 v99, v46, v47
    v_mfma_f32_16x16x32_bf16 v[216:219], v[64:67], v[120:123], v[216:219]
    v_exp_f32 v50, v142
    s_waitcnt lgkmcnt(4)
    v_mfma_f32_16x16x32_bf16 v[224:227], v[68:71], v[120:123], v[224:227]
    ds_read_b128 v[52:55], v10 offset:16384
    v_exp_f32 v51, v143
    v_mfma_f32_16x16x32_bf16 v[228:231], v[68:71], v[124:127], v[228:231]
    ds_read_b128 v[56:59], v10 offset:20480
    v_mfma_f32_16x16x32_bf16 v[236:239], v[72:75], v[124:127], v[236:239]
    v_exp_f32 v44, v144
    v_mfma_f32_16x16x32_bf16 v[232:235], v[72:75], v[120:123], v[232:235]
    v_cvt_pk_bf16_f32 v102, v48, v49
    s_waitcnt vmcnt(5) lgkmcnt(2)
    v_mfma_f32_16x16x32_bf16 v[240:243], v[76:79], v[120:123], v[240:243]
    ds_read_b128 v[60:63], v10 offset:24576
    v_exp_f32 v45, v145
    buffer_load_dwordx4 v25, s[8:11], s40 offen offset:3072 nt lds
    s_add_u32 s40, s40, s82
    v_mfma_f32_16x16x32_bf16 v[244:247], v[76:79], v[124:127], v[244:247]
    ds_read_b128 v[64:67], v10 offset:28672
    v_cvt_pk_bf16_f32 v103, v50, v51
    v_mfma_f32_16x16x32_bf16 v[252:255], v[80:83], v[124:127], v[252:255]
    v_exp_f32 v46, v146
    v_mfma_f32_16x16x32_bf16 v[248:251], v[80:83], v[120:123], v[248:251]
    s_waitcnt lgkmcnt(2)
    v_mfma_f32_16x16x32_bf16 v[160:163], v[52:55], a[0:3], v[36:39]
    ds_read_b128 v[68:71], v11 offset:16384
    v_exp_f32 v47, v147
    v_mfma_f32_16x16x32_bf16 v[164:167], v[52:55], a[16:19], v[40:43]
    ds_read_b128 v[72:75], v11 offset:20480
    v_exp_f32 v48, v148
    v_mfma_f32_16x16x32_bf16 v[172:175], v[56:59], a[16:19], v[40:43]
    v_cvt_pk_bf16_f32 v104, v44, v45
    v_mfma_f32_16x16x32_bf16 v[168:171], v[56:59], a[0:3], v[36:39]
    v_exp_f32 v49, v149
    s_add_u32 m0, s81, 65536
    s_waitcnt vmcnt(6) lgkmcnt(2)
    v_mfma_f32_16x16x32_bf16 v[176:179], v[60:63], a[0:3], v[36:39]
    ds_read_b128 v[76:79], v11 offset:24576
    v_cvt_pk_bf16_f32 v105, v46, v47
    buffer_load_dwordx4 v26, s[12:15], s41 offen offset:0 nt lds
    v_mfma_f32_16x16x32_bf16 v[180:183], v[60:63], a[16:19], v[40:43]
    ds_read_b128 v[80:83], v11 offset:28672
    v_exp_f32 v50, v150
    v_mfma_f32_16x16x32_bf16 v[188:191], v[64:67], a[16:19], v[40:43]
    v_exp_f32 v51, v151
    v_mfma_f32_16x16x32_bf16 v[88:91], v[84:87], v[96:99], 0
    v_mfma_f32_16x16x32_bf16 v[184:187], v[64:67], a[0:3], v[36:39]
    v_exp_f32 v44, v152
    v_mfma_f32_16x16x32_bf16 v[92:95], v[84:87], v[100:103], 0
    s_waitcnt lgkmcnt(2)
    v_mfma_f32_16x16x32_bf16 v[160:163], v[68:71], a[4:7], v[160:163]
    ds_read_b128 v[52:55], v12 offset:16384
    v_cvt_pk_bf16_f32 v108, v48, v49
    v_mfma_f32_16x16x32_bf16 v[164:167], v[68:71], a[20:23], v[164:167]
    ds_read_b128 v[56:59], v12 offset:20480
    v_exp_f32 v45, v153
    v_mfma_f32_16x16x32_bf16 v[172:175], v[72:75], a[20:23], v[172:175]
    v_cvt_pk_bf16_f32 v109, v50, v51
    v_mfma_f32_16x16x32_bf16 v[168:171], v[72:75], a[4:7], v[168:171]
    v_exp_f32 v46, v154
    s_waitcnt vmcnt(5) lgkmcnt(2)
    v_mfma_f32_16x16x32_bf16 v[176:179], v[76:79], a[4:7], v[176:179]
    ds_read_b128 v[60:63], v12 offset:24576
    v_exp_f32 v47, v155
    buffer_load_dwordx4 v27, s[12:15], s41 offen offset:1024 nt lds
    s_add_u32 s81, s81, s82
    v_mfma_f32_16x16x32_bf16 v[180:183], v[76:79], a[20:23], v[180:183]
    ds_read_b128 v[64:67], v12 offset:28672
    v_exp_f32 v48, v156
    v_mfma_f32_16x16x32_bf16 v[188:191], v[80:83], a[20:23], v[188:191]
    v_cvt_pk_bf16_f32 v106, v44, v45
    v_mfma_f32_16x16x32_bf16 v[184:187], v[80:83], a[4:7], v[184:187]
    v_exp_f32 v49, v157
    s_waitcnt vmcnt(5) lgkmcnt(2)
    v_mfma_f32_16x16x32_bf16 v[160:163], v[52:55], a[8:11], v[160:163]
    ds_read_b128 v[68:71], v13 offset:16384
    v_cvt_pk_bf16_f32 v107, v46, v47
    buffer_load_dwordx4 v26, s[12:15], s41 offen offset:2048 nt lds
    s_and_b32 s81, s81, 0xffff
    v_mfma_f32_16x16x32_bf16 v[164:167], v[52:55], a[24:27], v[164:167]
    ds_read_b128 v[72:75], v13 offset:20480
    v_exp_f32 v50, v158
    v_mfma_f32_16x16x32_bf16 v[172:175], v[56:59], a[24:27], v[172:175]
    v_exp_f32 v51, v159
    v_mfma_f32_16x16x32_bf16 v[168:171], v[56:59], a[8:11], v[168:171]
    s_nop 0
    s_waitcnt lgkmcnt(2)
    v_mfma_f32_16x16x32_bf16 v[176:179], v[60:63], a[8:11], v[176:179]
    ds_read_b128 v[76:79], v13 offset:24576
    v_cvt_pk_bf16_f32 v110, v48, v49
    v_mfma_f32_16x16x32_bf16 v[180:183], v[60:63], a[24:27], v[180:183]
    ds_read_b128 v[80:83], v13 offset:28672
    v_cvt_pk_bf16_f32 v111, v50, v51
    v_mfma_f32_16x16x32_bf16 v[188:191], v[64:67], a[24:27], v[188:191]
    v_mfma_f32_16x16x32_bf16 v[184:187], v[64:67], a[8:11], v[184:187]
    s_waitcnt vmcnt(5) lgkmcnt(2)
    v_mfma_f32_16x16x32_bf16 v[160:163], v[68:71], a[12:15], v[160:163]
    buffer_load_dwordx4 v27, s[12:15], s41 offen offset:3072 nt lds
    s_add_u32 s41, s41, s82
    v_mfma_f32_16x16x32_bf16 v[88:91], v[84:87], v[104:107], v[88:91]
    v_mfma_f32_16x16x32_bf16 v[164:167], v[68:71], a[28:31], v[164:167]
    v_mfma_f32_16x16x32_bf16 v[92:95], v[84:87], v[108:111], v[92:95]
    v_mfma_f32_16x16x32_bf16 v[172:175], v[72:75], a[28:31], v[172:175]
    s_waitcnt vmcnt(8) lgkmcnt(0)
    s_barrier
    ds_read_b64_tr_b16 v[52:53], v14 offset:0
    ds_read_b64_tr_b16 v[54:55], v14 offset:4096
    v_mfma_f32_16x16x32_bf16 v[168:171], v[72:75], a[12:15], v[168:171]
    ds_read_b64_tr_b16 v[56:57], v15 offset:0
    ds_read_b64_tr_b16 v[58:59], v15 offset:4096
    v_mfma_f32_16x16x32_bf16 v[176:179], v[76:79], a[12:15], v[176:179]
    ds_read_b64_tr_b16 v[60:61], v16 offset:0
    ds_read_b64_tr_b16 v[62:63], v16 offset:4096
    v_mfma_f32_16x16x32_bf16 v[180:183], v[76:79], a[28:31], v[180:183]
    ds_read_b64_tr_b16 v[64:65], v17 offset:0
    ds_read_b64_tr_b16 v[66:67], v17 offset:4096
    v_mfma_f32_16x16x32_bf16 v[188:191], v[80:83], a[28:31], v[188:191]
    v_max_f32 v32, v88, v92
    v_mfma_f32_16x16x32_bf16 v[184:187], v[80:83], a[12:15], v[184:187]
    v_cmp_lt_f32 vcc, 0x45800000, v32
    s_cbranch_vccnz L_trH3b
L_Hret3b:
    s_cmp_eq_u32 s44, 12
    s_cbranch_scc0 L_H0b
    s_branch L_L0b
L_L0:
L_L0b:
    s_waitcnt lgkmcnt(12)
    v_mfma_f32_16x16x32_bf16 v[192:195], v[52:55], v[96:99], v[192:195]
    s_add_u32 s44, s44, 4
    ds_read_b64_tr_b16 v[68:69], v18 offset:0
    ds_read_b64_tr_b16 v[70:71], v18 offset:4096
    v_exp_f32 v44, v160
    v_mfma_f32_16x16x32_bf16 v[196:199], v[52:55], v[100:103], v[196:199]
    ds_read_b64_tr_b16 v[72:73], v19 offset:0
    ds_read_b64_tr_b16 v[74:75], v19 offset:4096
    v_exp_f32 v45, v161
    v_mfma_f32_16x16x32_bf16 v[204:207], v[56:59], v[100:103], v[204:207]
    v_exp_f32 v46, v162
    v_add_f32 v28, v28, v88
    v_mfma_f32_16x16x32_bf16 v[200:203], v[56:59], v[96:99], v[200:203]
    v_exp_f32 v47, v163
    v_add_f32 v29, v29, v92
    s_add_u32 m0, s42, 0
    s_waitcnt vmcnt(10) lgkmcnt(12)
    v_mfma_f32_16x16x32_bf16 v[208:211], v[60:63], v[96:99], v[208:211]
    ds_read_b64_tr_b16 v[76:77], v20 offset:0
    ds_read_b64_tr_b16 v[78:79], v20 offset:4096
    v_exp_f32 v48, v164
    buffer_load_dwordx4 v22, s[8:11], s40 offen offset:0 nt lds
    v_mfma_f32_16x16x32_bf16 v[212:215], v[60:63], v[100:103], v[212:215]
    ds_read_b64_tr_b16 v[80:81], v21 offset:0
    ds_read_b64_tr_b16 v[82:83], v21 offset:4096
    v_cvt_pk_bf16_f32 v112, v44, v45
    v_mfma_f32_16x16x32_bf16 v[220:223], v[64:67], v[100:103], v[220:223]
    v_mfma_f32_16x16x32_bf16 v[216:219], v[64:67], v[96:99], v[216:219]
    v_exp_f32 v49, v165
    s_waitcnt lgkmcnt(4)
    v_mfma_f32_16x16x32_bf16 v[224:227], v[68:71], v[96:99], v[224:227]
    ds_read_b64_tr_b16 v[52:53], v14 offset:8192
    ds_read_b64_tr_b16 v[54:55], v14 offset:12288
    v_cvt_pk_bf16_f32 v113, v46, v47
    v_mfma_f32_16x16x32_bf16 v[228:231], v[68:71], v[100:103], v[228:231]
    ds_read_b64_tr_b16 v[56:57], v15 offset:8192
    ds_read_b64_tr_b16 v[58:59], v15 offset:12288
    v_exp_f32 v50, v166
    v_mfma_f32_16x16x32_bf16 v[236:239], v[72:75], v[100:103], v[236:239]
    v_exp_f32 v51, v167
    v_mfma_f32_16x16x32_bf16 v[232:235], v[72:75], v[96:99], v[232:235]
    v_exp_f32 v44, v168
    s_waitcnt vmcnt(9) lgkmcnt(4)
    v_mfma_f32_16x16x32_bf16 v[240:243], v[76:79], v[96:99], v[240:243]
    ds_read_b64_tr_b16 v[60:61], v16 offset:8192
    ds_read_b64_tr_b16 v[62:63], v16 offset:12288
    buffer_load_dwordx4 v23, s[8:11], s40 offen offset:1024 nt lds
    v_mfma_f32_16x16x32_bf16 v[244:247], v[76:79], v[100:103], v[244:247]
    ds_read_b64_tr_b16 v[64:65], v17 offset:8192
    ds_read_b64_tr_b16 v[66:67], v17 offset:12288
    v_cvt_pk_bf16_f32 v116, v48, v49
    v_mfma_f32_16x16x32_bf16 v[252:255], v[80:83], v[100:103], v[252:255]
    v_exp_f32 v45, v169
    v_mfma_f32_16x16x32_bf16 v[248:251], v[80:83], v[96:99], v[248:251]
    v_cvt_pk_bf16_f32 v117, v50, v51
    s_waitcnt lgkmcnt(4)
    v_mfma_f32_16x16x32_bf16 v[192:195], v[52:55], v[104:107], v[192:195]
    ds_read_b64_tr_b16 v[68:69], v18 offset:8192
    ds_read_b64_tr_b16 v[70:71], v18 offset:12288
    v_exp_f32 v46, v170
    v_mfma_f32_16x16x32_bf16 v[196:199], v[52:55], v[108:111], v[196:199]
    ds_read_b64_tr_b16 v[72:73], v19 offset:8192
    ds_read_b64_tr_b16 v[74:75], v19 offset:12288
    v_exp_f32 v47, v171
    v_mfma_f32_16x16x32_bf16 v[204:207], v[56:59], v[108:111], v[204:207]
    v_exp_f32 v48, v172
    v_mfma_f32_16x16x32_bf16 v[200:203], v[56:59], v[104:107], v[200:203]
    s_waitcnt vmcnt(10) lgkmcnt(4)
    v_mfma_f32_16x16x32_bf16 v[208:211], v[60:63], v[104:107], v[208:211]
    ds_read_b64_tr_b16 v[76:77], v20 offset:8192
    ds_read_b64_tr_b16 v[78:79], v20 offset:12288
    v_cvt_pk_bf16_f32 v114, v44, v45
    buffer_load_dwordx4 v24, s[8:11], s40 offen offset:2048 nt lds
    v_mfma_f32_16x16x32_bf16 v[212:215], v[60:63], v[108:111], v[212:215]
    ds_read_b64_tr_b16 v[80:81], v21 offset:8192
    ds_read_b64_tr_b16 v[82:83], v21 offset:12288
    v_exp_f32 v49, v173
    v_mfma_f32_16x16x32_bf16 v[220:223], v[64:67], v[108:111], v[220:223]
    v_cvt_pk_bf16_f32 v115, v46, v47
    v_mfma_f32_16x16x32_bf16 v[216:219], v[64:67], v[104:107], v[216:219]
    v_exp_f32 v50, v174
    s_waitcnt lgkmcnt(4)
    v_mfma_f32_16x16x32_bf16 v[224:227], v[68:71], v[104:107], v[224:227]
    ds_read_b128 v[52:55], v10 offset:32768
    v_exp_f32 v51, v175
    v_mfma_f32_16x16x32_bf16 v[228:231], v[68:71], v[108:111], v[228:231]
    ds_read_b128 v[56:59], v10 offset:36864
    v_mfma_f32_16x16x32_bf16 v[236:239], v[72:75], v[108:111], v[236:239]
    v_exp_f32 v44, v176
    v_mfma_f32_16x16x32_bf16 v[232:235], v[72:75], v[104:107], v[232:235]
    v_cvt_pk_bf16_f32 v118, v48, v49
    s_waitcnt vmcnt(9) lgkmcnt(2)
    v_mfma_f32_16x16x32_bf16 v[240:243], v[76:79], v[104:107], v[240:243]
    ds_read_b128 v[60:63], v10 offset:40960
    v_exp_f32 v45, v177
    buffer_load_dwordx4 v25, s[8:11], s40 offen offset:3072 nt lds
    s_add_u32 s40, s40, 16384
    v_mfma_f32_16x16x32_bf16 v[244:247], v[76:79], v[108:111], v[244:247]
    ds_read_b128 v[64:67], v10 offset:45056
    v_cvt_pk_bf16_f32 v119, v50, v51
    v_mfma_f32_16x16x32_bf16 v[252:255], v[80:83], v[108:111], v[252:255]
    v_exp_f32 v46, v178
    v_mfma_f32_16x16x32_bf16 v[248:251], v[80:83], v[104:107], v[248:251]
    s_waitcnt lgkmcnt(2)
    v_mfma_f32_16x16x32_bf16 v[128:131], v[52:55], a[0:3], v[36:39]
    ds_read_b128 v[68:71], v11 offset:32768
    v_exp_f32 v47, v179
    v_mfma_f32_16x16x32_bf16 v[132:135], v[52:55], a[16:19], v[40:43]
    ds_read_b128 v[72:75], v11 offset:36864
    v_exp_f32 v48, v180
    v_mfma_f32_16x16x32_bf16 v[140:143], v[56:59], a[16:19], v[40:43]
    v_cvt_pk_bf16_f32 v120, v44, v45
    v_mfma_f32_16x16x32_bf16 v[136:139], v[56:59], a[0:3], v[36:39]
    v_exp_f32 v49, v181
    s_add_u32 m0, s43, 32768
    s_waitcnt vmcnt(10) lgkmcnt(2)
    v_mfma_f32_16x16x32_bf16 v[144:147], v[60:63], a[0:3], v[36:39]
    ds_read_b128 v[76:79], v11 offset:40960
    v_cvt_pk_bf16_f32 v121, v46, v47
    buffer_load_dwordx4 v26, s[12:15], s41 offen offset:0 nt lds
    v_mfma_f32_16x16x32_bf16 v[148:151], v[60:63], a[16:19], v[40:43]
    ds_read_b128 v[80:83], v11 offset:45056
    v_exp_f32 v50, v182
    v_mfma_f32_16x16x32_bf16 v[156:159], v[64:67], a[16:19], v[40:43]
    v_exp_f32 v51, v183
    v_mfma_f32_16x16x32_bf16 v[88:91], v[84:87], v[112:115], 0
    v_mfma_f32_16x16x32_bf16 v[152:155], v[64:67], a[0:3], v[36:39]
    v_exp_f32 v44, v184
    v_mfma_f32_16x16x32_bf16 v[92:95], v[84:87], v[116:119], 0
    s_waitcnt lgkmcnt(2)
    v_mfma_f32_16x16x32_bf16 v[128:131], v[68:71], a[4:7], v[128:131]
    ds_read_b128 v[52:55], v12 offset:32768
    v_cvt_pk_bf16_f32 v124, v48, v49
    v_mfma_f32_16x16x32_bf16 v[132:135], v[68:71], a[20:23], v[132:135]
    ds_read_b128 v[56:59], v12 offset:36864
    v_exp_f32 v45, v185
    v_mfma_f32_16x16x32_bf16 v[140:143], v[72:75], a[20:23], v[140:143]
    v_cvt_pk_bf16_f32 v125, v50, v51
    v_mfma_f32_16x16x32_bf16 v[136:139], v[72:75], a[4:7], v[136:139]
    v_exp_f32 v46, v186
    s_waitcnt vmcnt(9) lgkmcnt(2)
    v_mfma_f32_16x16x32_bf16 v[144:147], v[76:79], a[4:7], v[144:147]
    ds_read_b128 v[60:63], v12 offset:40960
    v_exp_f32 v47, v187
    buffer_load_dwordx4 v27, s[12:15], s41 offen offset:1024 nt lds
    v_mfma_f32_16x16x32_bf16 v[148:151], v[76:79], a[20:23], v[148:151]
    ds_read_b128 v[64:67], v12 offset:45056
    v_exp_f32 v48, v188
    v_mfma_f32_16x16x32_bf16 v[156:159], v[80:83], a[20:23], v[156:159]
    v_cvt_pk_bf16_f32 v122, v44, v45
    v_mfma_f32_16x16x32_bf16 v[152:155], v[80:83], a[4:7], v[152:155]
    v_exp_f32 v49, v189
    s_waitcnt vmcnt(10) lgkmcnt(2)
    v_mfma_f32_16x16x32_bf16 v[128:131], v[52:55], a[8:11], v[128:131]
    ds_read_b128 v[68:71], v13 offset:32768
    v_cvt_pk_bf16_f32 v123, v46, v47
    buffer_load_dwordx4 v26, s[12:15], s41 offen offset:2048 nt lds
    v_mfma_f32_16x16x32_bf16 v[132:135], v[52:55], a[24:27], v[132:135]
    ds_read_b128 v[72:75], v13 offset:36864
    v_exp_f32 v50, v190
    v_mfma_f32_16x16x32_bf16 v[140:143], v[56:59], a[24:27], v[140:143]
    v_exp_f32 v51, v191
    v_mfma_f32_16x16x32_bf16 v[136:139], v[56:59], a[8:11], v[136:139]
    s_nop 0
    s_waitcnt lgkmcnt(2)
    v_mfma_f32_16x16x32_bf16 v[144:147], v[60:63], a[8:11], v[144:147]
    ds_read_b128 v[76:79], v13 offset:40960
    v_cvt_pk_bf16_f32 v126, v48, v49
    v_mfma_f32_16x16x32_bf16 v[148:151], v[60:63], a[24:27], v[148:151]
    ds_read_b128 v[80:83], v13 offset:45056
    v_cvt_pk_bf16_f32 v127, v50, v51
    v_mfma_f32_16x16x32_bf16 v[156:159], v[64:67], a[24:27], v[156:159]
    v_mfma_f32_16x16x32_bf16 v[152:155], v[64:67], a[8:11], v[152:155]
    s_waitcnt vmcnt(5) lgkmcnt(2)
    v_mfma_f32_16x16x32_bf16 v[128:131], v[68:71], a[12:15], v[128:131]
    buffer_load_dwordx4 v27, s[12:15], s41 offen offset:3072 nt lds
    s_add_u32 s41, s41, 16384
    v_mfma_f32_16x16x32_bf16 v[88:91], v[84:87], v[120:123], v[88:91]
    v_mfma_f32_16x16x32_bf16 v[132:135], v[68:71], a[28:31], v[132:135]
    v_mfma_f32_16x16x32_bf16 v[92:95], v[84:87], v[124:127], v[92:95]
    v_mfma_f32_16x16x32_bf16 v[140:143], v[72:75], a[28:31], v[140:143]
    s_waitcnt vmcnt(8) lgkmcnt(0)
    s_barrier
    ds_read_b64_tr_b16 v[52:53], v14 offset:16384
    ds_read_b64_tr_b16 v[54:55], v14 offset:20480
    v_mfma_f32_16x16x32_bf16 v[136:139], v[72:75], a[12:15], v[136:139]
    s_add_u32 m0, s84, 4096
    ds_read_b64_tr_b16 v[56:57], v15 offset:16384
    ds_read_b64_tr_b16 v[58:59], v15 offset:20480
    v_mfma_f32_16x16x32_bf16 v[144:147], v[76:79], a[12:15], v[144:147]
    ds_read_b64_tr_b16 v[60:61], v16 offset:16384
    ds_read_b64_tr_b16 v[62:63], v16 offset:20480
    buffer_load_dwordx4 v30, s[28:31], s94 offen offset:0 lds
    v_mfma_f32_16x16x32_bf16 v[148:151], v[76:79], a[28:31], v[148:151]
    ds_read_b64_tr_b16 v[64:65], v17 offset:16384
    ds_read_b64_tr_b16 v[66:67], v17 offset:20480
    buffer_load_dwordx4 v31, s[28:31], s94 offen offset:1024 lds
    v_mfma_f32_16x16x32_bf16 v[156:159], v[80:83], a[28:31], v[156:159]
    buffer_load_dwordx4 v30, s[28:31], s95 offen offset:2048 lds
    v_max_f32 v32, v88, v92
    v_mfma_f32_16x16x32_bf16 v[152:155], v[80:83], a[12:15], v[152:155]
    buffer_load_dwordx4 v31, s[28:31], s95 offen offset:3072 lds
    v_cmp_lt_f32 vcc, 0x45800000, v32
    s_swappc_b64 s[90:91], s[88:89]
    s_cbranch_vccnz L_trL0b
L_Lret0b:
    s_waitcnt lgkmcnt(12)
    v_mfma_f32_16x16x32_bf16 v[192:195], v[52:55], v[112:115], v[192:195]
    ds_read_b64_tr_b16 v[68:69], v18 offset:16384
    ds_read_b64_tr_b16 v[70:71], v18 offset:20480
    v_exp_f32 v44, v128
    v_mfma_f32_16x16x32_bf16 v[196:199], v[52:55], v[116:119], v[196:199]
    ds_read_b64_tr_b16 v[72:73], v19 offset:16384
    ds_read_b64_tr_b16 v[74:75], v19 offset:20480
    v_exp_f32 v45, v129
    v_mfma_f32_16x16x32_bf16 v[204:207], v[56:59], v[116:119], v[204:207]
    v_exp_f32 v46, v130
    v_add_f32 v28, v28, v88
    v_mfma_f32_16x16x32_bf16 v[200:203], v[56:59], v[112:115], v[200:203]
    v_exp_f32 v47, v131
    v_add_f32 v29, v29, v92
    s_add_u32 m0, s42, 16384
    s_waitcnt vmcnt(10) lgkmcnt(12)
    v_mfma_f32_16x16x32_bf16 v[208:211], v[60:63], v[112:115], v[208:211]
    ds_read_b64_tr_b16 v[76:77], v20 offset:16384
    ds_read_b64_tr_b16 v[78:79], v20 offset:20480
    v_exp_f32 v48, v132
    buffer_load_dwordx4 v22, s[8:11], s40 offen offset:0 nt lds
    v_mfma_f32_16x16x32_bf16 v[212:215], v[60:63], v[116:119], v[212:215]
    ds_read_b64_tr_b16 v[80:81], v21 offset:16384
    ds_read_b64_tr_b16 v[82:83], v21 offset:20480
    v_cvt_pk_bf16_f32 v96, v44, v45
    v_mfma_f32_16x16x32_bf16 v[220:223], v[64:67], v[116:119], v[220:223]
    v_mfma_f32_16x16x32_bf16 v[216:219], v[64:67], v[112:115], v[216:219]
    v_exp_f32 v49, v133
    s_waitcnt lgkmcnt(4)
    v_mfma_f32_16x16x32_bf16 v[224:227], v[68:71], v[112:115], v[224:227]
    ds_read_b64_tr_b16 v[52:53], v14 offset:24576
    ds_read_b64_tr_b16 v[54:55], v14 offset:28672
    v_cvt_pk_bf16_f32 v97, v46, v47
    v_mfma_f32_16x16x32_bf16 v[228:231], v[68:71], v[116:119], v[228:231]
    ds_read_b64_tr_b16 v[56:57], v15 offset:24576
    ds_read_b64_tr_b16 v[58:59], v15 offset:28672
    v_exp_f32 v50, v134
    v_mfma_f32_16x16x32_bf16 v[236:239], v[72:75], v[116:119], v[236:239]
    v_exp_f32 v51, v135
    v_mfma_f32_16x16x32_bf16 v[232:235], v[72:75], v[112:115], v[232:235]
    v_exp_f32 v44, v136
    s_waitcnt vmcnt(9) lgkmcnt(4)
    v_mfma_f32_16x16x32_bf16 v[240:243], v[76:79], v[112:115], v[240:243]
    ds_read_b64_tr_b16 v[60:61], v16 offset:24576
    ds_read_b64_tr_b16 v[62:63], v16 offset:28672
    buffer_load_dwordx4 v23, s[8:11], s40 offen offset:1024 nt lds
    v_mfma_f32_16x16x32_bf16 v[244:247], v[76:79], v[116:119], v[244:247]
    ds_read_b64_tr_b16 v[64:65], v17 offset:24576
    ds_read_b64_tr_b16 v[66:67], v17 offset:28672
    v_cvt_pk_bf16_f32 v100, v48, v49
    v_mfma_f32_16x16x32_bf16 v[252:255], v[80:83], v[116:119], v[252:255]
    v_exp_f32 v45, v137
    v_mfma_f32_16x16x32_bf16 v[248:251], v[80:83], v[112:115], v[248:251]
    v_cvt_pk_bf16_f32 v101, v50, v51
    s_waitcnt lgkmcnt(4)
    v_mfma_f32_16x16x32_bf16 v[192:195], v[52:55], v[120:123], v[192:195]
    ds_read_b64_tr_b16 v[68:69], v18 offset:24576
    ds_read_b64_tr_b16 v[70:71], v18 offset:28672
    v_exp_f32 v46, v138
    v_mfma_f32_16x16x32_bf16 v[196:199], v[52:55], v[124:127], v[196:199]
    ds_read_b64_tr_b16 v[72:73], v19 offset:24576
    ds_read_b64_tr_b16 v[74:75], v19 offset:28672
    v_exp_f32 v47, v139
    v_mfma_f32_16x16x32_bf16 v[204:207], v[56:59], v[124:127], v[204:207]
    v_exp_f32 v48, v140
    v_mfma_f32_16x16x32_bf16 v[200:203], v[56:59], v[120:123], v[200:203]
    s_waitcnt vmcnt(10) lgkmcnt(4)
    v_mfma_f32_16x16x32_bf16 v[208:211], v[60:63], v[120:123], v[208:211]
    ds_read_b64_tr_b16 v[76:77], v20 offset:24576
    ds_read_b64_tr_b16 v[78:79], v20 offset:28672
    v_cvt_pk_bf16_f32 v98, v44, v45
    buffer_load_dwordx4 v24, s[8:11], s40 offen offset:2048 nt lds
    v_mfma_f32_16x16x32_bf16 v[212:215], v[60:63], v[124:127], v[212:215]
    ds_read_b64_tr_b16 v[80:81], v21 offset:24576
    ds_read_b64_tr_b16 v[82:83], v21 offset:28672
    v_exp_f32 v49, v141
    v_mfma_f32_16x16x32_bf16 v[220:223], v[64:67], v[124:127], v[220:223]
    v_cvt_pk_bf16_f32 v99, v46, v47
    v_mfma_f32_16x16x32_bf16 v[216:219], v[64:67], v[120:123], v[216:219]
    v_exp_f32 v50, v142
    s_waitcnt lgkmcnt(4)
    v_mfma_f32_16x16x32_bf16 v[224:227], v[68:71], v[120:123], v[224:227]
    ds_read_b128 v[52:55], v10 offset:49152
    v_exp_f32 v51, v143
    v_mfma_f32_16x16x32_bf16 v[228:231], v[68:71], v[124:127], v[228:231]
    ds_read_b128 v[56:59], v10 offset:53248
    v_mfma_f32_16x16x32_bf16 v[236:239], v[72:75], v[124:127], v[236:239]
    v_exp_f32 v44, v144
    v_mfma_f32_16x16x32_bf16 v[232:235], v[72:75], v[120:123], v[232:235]
    v_cvt_pk_bf16_f32 v102, v48, v49
    s_waitcnt vmcnt(9) lgkmcnt(2)
    v_mfma_f32_16x16x32_bf16 v[240:243], v[76:79], v[120:123], v[240:243]
    ds_read_b128 v[60:63], v10 offset:57344
    v_exp_f32 v45, v145
    buffer_load_dwordx4 v25, s[8:11], s40 offen offset:3072 nt lds
    s_add_u32 s40, s40, 16384
    v_mfma_f32_16x16x32_bf16 v[244:247], v[76:79], v[124:127], v[244:247]
    ds_read_b128 v[64:67], v10 offset:61440
    v_cvt_pk_bf16_f32 v103, v50, v51
    v_mfma_f32_16x16x32_bf16 v[252:255], v[80:83], v[124:127], v[252:255]
    v_exp_f32 v46, v146
    v_mfma_f32_16x16x32_bf16 v[248:251], v[80:83], v[120:123], v[248:251]
    s_waitcnt lgkmcnt(2)
    v_mfma_f32_16x16x32_bf16 v[160:163], v[52:55], a[0:3], v[36:39]
    ds_read_b128 v[68:71], v11 offset:49152
    v_exp_f32 v47, v147
    v_mfma_f32_16x16x32_bf16 v[164:167], v[52:55], a[16:19], v[40:43]
    ds_read_b128 v[72:75], v11 offset:53248
    v_exp_f32 v48, v148
    v_mfma_f32_16x16x32_bf16 v[172:175], v[56:59], a[16:19], v[40:43]
    v_cvt_pk_bf16_f32 v104, v44, v45
    v_mfma_f32_16x16x32_bf16 v[168:171], v[56:59], a[0:3], v[36:39]
    v_exp_f32 v49, v149
    s_add_u32 m0, s43, 49152
    s_waitcnt vmcnt(10) lgkmcnt(2)
    v_mfma_f32_16x16x32_bf16 v[176:179], v[60:63], a[0:3], v[36:39]
    ds_read_b128 v[76:79], v11 offset:57344
    v_cvt_pk_bf16_f32 v105, v46, v47
    buffer_load_dwordx4 v26, s[12:15], s41 offen offset:0 nt lds
    v_mfma_f32_16x16x32_bf16 v[180:183], v[60:63], a[16:19], v[40:43]
    ds_read_b128 v[80:83], v11 offset:61440
    v_exp_f32 v50, v150
    v_mfma_f32_16x16x32_bf16 v[188:191], v[64:67], a[16:19], v[40:43]
    v_exp_f32 v51, v151
    v_mfma_f32_16x16x32_bf16 v[88:91], v[84:87], v[96:99], 0
    v_mfma_f32_16x16x32_bf16 v[184:187], v[64:67], a[0:3], v[36:39]
    v_exp_f32 v44, v152
    v_mfma_f32_16x16x32_bf16 v[92:95], v[84:87], v[100:103], 0
    s_waitcnt lgkmcnt(2)
    v_mfma_f32_16x16x32_bf16 v[160:163], v[68:71], a[4:7], v[160:163]
    ds_read_b128 v[52:55], v12 offset:49152
    v_cvt_pk_bf16_f32 v108, v48, v49
    v_mfma_f32_16x16x32_bf16 v[164:167], v[68:71], a[20:23], v[164:167]
    ds_read_b128 v[56:59], v12 offset:53248
    v_exp_f32 v45, v153
    v_mfma_f32_16x16x32_bf16 v[172:175], v[72:75], a[20:23], v[172:175]
    v_cvt_pk_bf16_f32 v109, v50, v51
    v_mfma_f32_16x16x32_bf16 v[168:171], v[72:75], a[4:7], v[168:171]
    v_exp_f32 v46, v154
    s_waitcnt vmcnt(9) lgkmcnt(2)
    v_mfma_f32_16x16x32_bf16 v[176:179], v[76:79], a[4:7], v[176:179]
    ds_read_b128 v[60:63], v12 offset:57344
    v_exp_f32 v47, v155
    buffer_load_dwordx4 v27, s[12:15], s41 offen offset:1024 nt lds
    v_mfma_f32_16x16x32_bf16 v[180:183], v[76:79], a[20:23], v[180:183]
    ds_read_b128 v[64:67], v12 offset:61440
    v_exp_f32 v48, v156
    v_mfma_f32_16x16x32_bf16 v[188:191], v[80:83], a[20:23], v[188:191]
    v_cvt_pk_bf16_f32 v106, v44, v45
    v_mfma_f32_16x16x32_bf16 v[184:187], v[80:83], a[4:7], v[184:187]
    v_exp_f32 v49, v157
    s_waitcnt vmcnt(10) lgkmcnt(2)
    v_mfma_f32_16x16x32_bf16 v[160:163], v[52:55], a[8:11], v[160:163]
    ds_read_b128 v[68:71], v13 offset:49152
    v_cvt_pk_bf16_f32 v107, v46, v47
    buffer_load_dwordx4 v26, s[12:15], s41 offen offset:2048 nt lds
    v_mfma_f32_16x16x32_bf16 v[164:167], v[52:55], a[24:27], v[164:167]
    ds_read_b128 v[72:75], v13 offset:53248
    v_exp_f32 v50, v158
    v_mfma_f32_16x16x32_bf16 v[172:175], v[56:59], a[24:27], v[172:175]
    v_exp_f32 v51, v159
    v_mfma_f32_16x16x32_bf16 v[168:171], v[56:59], a[8:11], v[168:171]
    s_nop 0
    s_waitcnt lgkmcnt(2)
    v_mfma_f32_16x16x32_bf16 v[176:179], v[60:63], a[8:11], v[176:179]
    ds_read_b128 v[76:79], v13 offset:57344
    v_cvt_pk_bf16_f32 v110, v48, v49
    v_mfma_f32_16x16x32_bf16 v[180:183], v[60:63], a[24:27], v[180:183]
    ds_read_b128 v[80:83], v13 offset:61440
    v_cvt_pk_bf16_f32 v111, v50, v51
    v_mfma_f32_16x16x32_bf16 v[188:191], v[64:67], a[24:27], v[188:191]
    v_mfma_f32_16x16x32_bf16 v[184:187], v[64:67], a[8:11], v[184:187]
    s_waitcnt vmcnt(5) lgkmcnt(2)
    v_mfma_f32_16x16x32_bf16 v[160:163], v[68:71], a[12:15], v[160:163]
    buffer_load_dwordx4 v27, s[12:15], s41 offen offset:3072 nt lds
    s_add_u32 s41, s41, 16384
    v_mfma_f32_16x16x32_bf16 v[88:91], v[84:87], v[104:107], v[88:91]
    v_mfma_f32_16x16x32_bf16 v[164:167], v[68:71], a[28:31], v[164:167]
    v_mfma_f32_16x16x32_bf16 v[92:95], v[84:87], v[108:111], v[92:95]
    v_mfma_f32_16x16x32_bf16 v[172:175], v[72:75], a[28:31], v[172:175]
    s_waitcnt vmcnt(8) lgkmcnt(0)
    s_barrier
    ds_read_b64_tr_b16 v[52:53], v14 offset:32768
    ds_read_b64_tr_b16 v[54:55], v14 offset:36864
    v_mfma_f32_16x16x32_bf16 v[168:171], v[72:75], a[12:15], v[168:171]
    s_add_u32 m0, s84, 0
    ds_read_b64_tr_b16 v[56:57], v15 offset:32768
    ds_read_b64_tr_b16 v[58:59], v15 offset:36864
    v_mfma_f32_16x16x32_bf16 v[176:179], v[76:79], a[12:15], v[176:179]
    ds_read_b64_tr_b16 v[60:61], v16 offset:32768
    ds_read_b64_tr_b16 v[62:63], v16 offset:36864
    buffer_load_dwordx4 v30, s[28:31], s94 offen offset:0 lds
    v_mfma_f32_16x16x32_bf16 v[180:183], v[76:79], a[28:31], v[180:183]
    ds_read_b64_tr_b16 v[64:65], v17 offset:32768
    ds_read_b64_tr_b16 v[66:67], v17 offset:36864
    buffer_load_dwordx4 v31, s[28:31], s94 offen offset:1024 lds
    v_mfma_f32_16x16x32_bf16 v[188:191], v[80:83], a[28:31], v[188:191]
    buffer_load_dwordx4 v30, s[28:31], s95 offen offset:2048 lds
    v_max_f32 v32, v88, v92
    v_mfma_f32_16x16x32_bf16 v[184:187], v[80:83], a[12:15], v[184:187]
    buffer_load_dwordx4 v31, s[28:31], s95 offen offset:3072 lds
    v_cmp_lt_f32 vcc, 0x45800000, v32
    s_swappc_b64 s[90:91], s[88:89]
    s_cbranch_vccnz L_trL1b
L_Lret1b:
    s_waitcnt lgkmcnt(12)
    v_mfma_f32_16x16x32_bf16 v[192:195], v[52:55], v[96:99], v[192:195]
    ds_read_b64_tr_b16 v[68:69], v18 offset:32768
    ds_read_b64_tr_b16 v[70:71], v18 offset:36864
    v_exp_f32 v44, v160
    v_mfma_f32_16x16x32_bf16 v[196:199], v[52:55], v[100:103], v[196:199]
    ds_read_b64_tr_b16 v[72:73], v19 offset:32768
    ds_read_b64_tr_b16 v[74:75], v19 offset:36864
    v_exp_f32 v45, v161
    v_mfma_f32_16x16x32_bf16 v[204:207], v[56:59], v[100:103], v[204:207]
    v_exp_f32 v46, v162
    v_add_f32 v28, v28, v88
    v_mfma_f32_16x16x32_bf16 v[200:203], v[56:59], v[96:99], v[200:203]
    v_exp_f32 v47, v163
    v_add_f32 v29, v29, v92
    s_add_u32 m0, s42, 32768
    s_waitcnt vmcnt(10) lgkmcnt(12)
    v_mfma_f32_16x16x32_bf16 v[208:211], v[60:63], v[96:99], v[208:211]
    ds_read_b64_tr_b16 v[76:77], v20 offset:32768
    ds_read_b64_tr_b16 v[78:79], v20 offset:36864
    v_exp_f32 v48, v164
    buffer_load_dwordx4 v22, s[8:11], s40 offen offset:0 nt lds
    v_mfma_f32_16x16x32_bf16 v[212:215], v[60:63], v[100:103], v[212:215]
    ds_read_b64_tr_b16 v[80:81], v21 offset:32768
    ds_read_b64_tr_b16 v[82:83], v21 offset:36864
    v_cvt_pk_bf16_f32 v112, v44, v45
    v_mfma_f32_16x16x32_bf16 v[220:223], v[64:67], v[100:103], v[220:223]
    v_mfma_f32_16x16x32_bf16 v[216:219], v[64:67], v[96:99], v[216:219]
    v_exp_f32 v49, v165
    s_waitcnt lgkmcnt(4)
    v_mfma_f32_16x16x32_bf16 v[224:227], v[68:71], v[96:99], v[224:227]
    ds_read_b64_tr_b16 v[52:53], v14 offset:40960
    ds_read_b64_tr_b16 v[54:55], v14 offset:45056
    v_cvt_pk_bf16_f32 v113, v46, v47
    v_mfma_f32_16x16x32_bf16 v[228:231], v[68:71], v[100:103], v[228:231]
    ds_read_b64_tr_b16 v[56:57], v15 offset:40960
    ds_read_b64_tr_b16 v[58:59], v15 offset:45056
    v_exp_f32 v50, v166
    v_mfma_f32_16x16x32_bf16 v[236:239], v[72:75], v[100:103], v[236:239]
    v_exp_f32 v51, v167
    v_mfma_f32_16x16x32_bf16 v[232:235], v[72:75], v[96:99], v[232:235]
    v_exp_f32 v44, v168
    s_waitcnt vmcnt(9) lgkmcnt(4)
    v_mfma_f32_16x16x32_bf16 v[240:243], v[76:79], v[96:99], v[240:243]
    ds_read_b64_tr_b16 v[60:61], v16 offset:40960
    ds_read_b64_tr_b16 v[62:63], v16 offset:45056
    buffer_load_dwordx4 v23, s[8:11], s40 offen offset:1024 nt lds
    v_mfma_f32_16x16x32_bf16 v[244:247], v[76:79], v[100:103], v[244:247]
    ds_read_b64_tr_b16 v[64:65], v17 offset:40960
    ds_read_b64_tr_b16 v[66:67], v17 offset:45056
    v_cvt_pk_bf16_f32 v116, v48, v49
    v_mfma_f32_16x16x32_bf16 v[252:255], v[80:83], v[100:103], v[252:255]
    v_exp_f32 v45, v169
    v_mfma_f32_16x16x32_bf16 v[248:251], v[80:83], v[96:99], v[248:251]
    v_cvt_pk_bf16_f32 v117, v50, v51
    s_waitcnt lgkmcnt(4)
    v_mfma_f32_16x16x32_bf16 v[192:195], v[52:55], v[104:107], v[192:195]
    ds_read_b64_tr_b16 v[68:69], v18 offset:40960
    ds_read_b64_tr_b16 v[70:71], v18 offset:45056
    v_exp_f32 v46, v170
    v_mfma_f32_16x16x32_bf16 v[196:199], v[52:55], v[108:111], v[196:199]
    ds_read_b64_tr_b16 v[72:73], v19 offset:40960
    ds_read_b64_tr_b16 v[74:75], v19 offset:45056
    v_exp_f32 v47, v171
    v_mfma_f32_16x16x32_bf16 v[204:207], v[56:59], v[108:111], v[204:207]
    v_exp_f32 v48, v172
    v_mfma_f32_16x16x32_bf16 v[200:203], v[56:59], v[104:107], v[200:203]
    s_waitcnt vmcnt(10) lgkmcnt(4)
    v_mfma_f32_16x16x32_bf16 v[208:211], v[60:63], v[104:107], v[208:211]
    ds_read_b64_tr_b16 v[76:77], v20 offset:40960
    ds_read_b64_tr_b16 v[78:79], v20 offset:45056
    v_cvt_pk_bf16_f32 v114, v44, v45
    buffer_load_dwordx4 v24, s[8:11], s40 offen offset:2048 nt lds
    v_mfma_f32_16x16x32_bf16 v[212:215], v[60:63], v[108:111], v[212:215]
    ds_read_b64_tr_b16 v[80:81], v21 offset:40960
    ds_read_b64_tr_b16 v[82:83], v21 offset:45056
    v_exp_f32 v49, v173
    v_mfma_f32_16x16x32_bf16 v[220:223], v[64:67], v[108:111], v[220:223]
    v_cvt_pk_bf16_f32 v115, v46, v47
    v_mfma_f32_16x16x32_bf16 v[216:219], v[64:67], v[104:107], v[216:219]
    v_exp_f32 v50, v174
    s_waitcnt lgkmcnt(4)
    v_mfma_f32_16x16x32_bf16 v[224:227], v[68:71], v[104:107], v[224:227]
    ds_read_b128 v[52:55], v10 offset:0
    v_exp_f32 v51, v175
    v_mfma_f32_16x16x32_bf16 v[228:231], v[68:71], v[108:111], v[228:231]
    ds_read_b128 v[56:59], v10 offset:4096
    v_mfma_f32_16x16x32_bf16 v[236:239], v[72:75], v[108:111], v[236:239]
    v_exp_f32 v44, v176
    v_mfma_f32_16x16x32_bf16 v[232:235], v[72:75], v[104:107], v[232:235]
    v_cvt_pk_bf16_f32 v118, v48, v49
    s_waitcnt vmcnt(9) lgkmcnt(2)
    v_mfma_f32_16x16x32_bf16 v[240:243], v[76:79], v[104:107], v[240:243]
    ds_read_b128 v[60:63], v10 offset:8192
    v_exp_f32 v45, v177
    buffer_load_dwordx4 v25, s[8:11], s40 offen offset:3072 nt lds
    s_add_u32 s40, s40, 16384
    v_mfma_f32_16x16x32_bf16 v[244:247], v[76:79], v[108:111], v[244:247]
    ds_read_b128 v[64:67], v10 offset:12288
    v_cvt_pk_bf16_f32 v119, v50, v51
    v_mfma_f32_16x16x32_bf16 v[252:255], v[80:83], v[108:111], v[252:255]
    v_exp_f32 v46, v178
    v_mfma_f32_16x16x32_bf16 v[248:251], v[80:83], v[104:107], v[248:251]
    s_waitcnt lgkmcnt(2)
    v_mfma_f32_16x16x32_bf16 v[128:131], v[52:55], a[0:3], v[36:39]
    ds_read_b128 v[68:71], v11 offset:0
    v_exp_f32 v47, v179
    v_mfma_f32_16x16x32_bf16 v[132:135], v[52:55], a[16:19], v[40:43]
    ds_read_b128 v[72:75], v11 offset:4096
    v_exp_f32 v48, v180
    v_mfma_f32_16x16x32_bf16 v[140:143], v[56:59], a[16:19], v[40:43]
    v_cvt_pk_bf16_f32 v120, v44, v45
    v_mfma_f32_16x16x32_bf16 v[136:139], v[56:59], a[0:3], v[36:39]
    v_exp_f32 v49, v181
    s_add_u32 m0, s43, 0
    s_waitcnt vmcnt(10) lgkmcnt(2)
    v_mfma_f32_16x16x32_bf16 v[144:147], v[60:63], a[0:3], v[36:39]
    ds_read_b128 v[76:79], v11 offset:8192
    v_cvt_pk_bf16_f32 v121, v46, v47
    buffer_load_dwordx4 v26, s[12:15], s41 offen offset:0 nt lds
    v_mfma_f32_16x16x32_bf16 v[148:151], v[60:63], a[16:19], v[40:43]
    ds_read_b128 v[80:83], v11 offset:12288
    v_exp_f32 v50, v182
    v_mfma_f32_16x16x32_bf16 v[156:159], v[64:67], a[16:19], v[40:43]
    v_exp_f32 v51, v183
    v_mfma_f32_16x16x32_bf16 v[88:91], v[84:87], v[112:115], 0
    v_mfma_f32_16x16x32_bf16 v[152:155], v[64:67], a[0:3], v[36:39]
    v_exp_f32 v44, v184
    v_mfma_f32_16x16x32_bf16 v[92:95], v[84:87], v[116:119], 0
    s_waitcnt lgkmcnt(2)
    v_mfma_f32_16x16x32_bf16 v[128:131], v[68:71], a[4:7], v[128:131]
    ds_read_b128 v[52:55], v12 offset:0
    v_cvt_pk_bf16_f32 v124, v48, v49
    v_mfma_f32_16x16x32_bf16 v[132:135], v[68:71], a[20:23], v[132:135]
    ds_read_b128 v[56:59], v12 offset:4096
    v_exp_f32 v45, v185
    v_mfma_f32_16x16x32_bf16 v[140:143], v[72:75], a[20:23], v[140:143]
    v_cvt_pk_bf16_f32 v125, v50, v51
    v_mfma_f32_16x16x32_bf16 v[136:139], v[72:75], a[4:7], v[136:139]
    v_exp_f32 v46, v186
    s_waitcnt vmcnt(9) lgkmcnt(2)
    v_mfma_f32_16x16x32_bf16 v[144:147], v[76:79], a[4:7], v[144:147]
    ds_read_b128 v[60:63], v12 offset:8192
    v_exp_f32 v47, v187
    buffer_load_dwordx4 v27, s[12:15], s41 offen offset:1024 nt lds
    v_mfma_f32_16x16x32_bf16 v[148:151], v[76:79], a[20:23], v[148:151]
    ds_read_b128 v[64:67], v12 offset:12288
    v_exp_f32 v48, v188
    v_mfma_f32_16x16x32_bf16 v[156:159], v[80:83], a[20:23], v[156:159]
    v_cvt_pk_bf16_f32 v122, v44, v45
    v_mfma_f32_16x16x32_bf16 v[152:155], v[80:83], a[4:7], v[152:155]
    v_exp_f32 v49, v189
    s_waitcnt vmcnt(10) lgkmcnt(2)
    v_mfma_f32_16x16x32_bf16 v[128:131], v[52:55], a[8:11], v[128:131]
    ds_read_b128 v[68:71], v13 offset:0
    v_cvt_pk_bf16_f32 v123, v46, v47
    buffer_load_dwordx4 v26, s[12:15], s41 offen offset:2048 nt lds
    v_mfma_f32_16x16x32_bf16 v[132:135], v[52:55], a[24:27], v[132:135]
    ds_read_b128 v[72:75], v13 offset:4096
    v_exp_f32 v50, v190
    v_mfma_f32_16x16x32_bf16 v[140:143], v[56:59], a[24:27], v[140:143]
    v_exp_f32 v51, v191
    v_mfma_f32_16x16x32_bf16 v[136:139], v[56:59], a[8:11], v[136:139]
    s_nop 0
    s_waitcnt lgkmcnt(2)
    v_mfma_f32_16x16x32_bf16 v[144:147], v[60:63], a[8:11], v[144:147]
    ds_read_b128 v[76:79], v13 offset:8192
    v_cvt_pk_bf16_f32 v126, v48, v49
    v_mfma_f32_16x16x32_bf16 v[148:151], v[60:63], a[24:27], v[148:151]
    ds_read_b128 v[80:83], v13 offset:12288
    v_cvt_pk_bf16_f32 v127, v50, v51
    v_mfma_f32_16x16x32_bf16 v[156:159], v[64:67], a[24:27], v[156:159]
    v_mfma_f32_16x16x32_bf16 v[152:155], v[64:67], a[8:11], v[152:155]
    s_waitcnt vmcnt(5) lgkmcnt(2)
    v_mfma_f32_16x16x32_bf16 v[128:131], v[68:71], a[12:15], v[128:131]
    buffer_load_dwordx4 v27, s[12:15], s41 offen offset:3072 nt lds
    s_add_u32 s41, s41, 16384
    v_mfma_f32_16x16x32_bf16 v[88:91], v[84:87], v[120:123], v[88:91]
    v_mfma_f32_16x16x32_bf16 v[132:135], v[68:71], a[28:31], v[132:135]
    v_mfma_f32_16x16x32_bf16 v[92:95], v[84:87], v[124:127], v[92:95]
    v_mfma_f32_16x16x32_bf16 v[140:143], v[72:75], a[28:31], v[140:143]
    s_waitcnt vmcnt(8) lgkmcnt(0)
    s_barrier
    ds_read_b64_tr_b16 v[52:53], v14 offset:49152
    ds_read_b64_tr_b16 v[54:55], v14 offset:53248
    v_mfma_f32_16x16x32_bf16 v[136:139], v[72:75], a[12:15], v[136:139]
    s_add_u32 m0, s84, 4096
    ds_read_b64_tr_b16 v[56:57], v15 offset:49152
    ds_read_b64_tr_b16 v[58:59], v15 offset:53248
    v_mfma_f32_16x16x32_bf16 v[144:147], v[76:79], a[12:15], v[144:147]
    ds_read_b64_tr_b16 v[60:61], v16 offset:49152
    ds_read_b64_tr_b16 v[62:63], v16 offset:53248
    buffer_load_dwordx4 v30, s[28:31], s94 offen offset:0 lds
    v_mfma_f32_16x16x32_bf16 v[148:151], v[76:79], a[28:31], v[148:151]
    ds_read_b64_tr_b16 v[64:65], v17 offset:49152
    ds_read_b64_tr_b16 v[66:67], v17 offset:53248
    buffer_load_dwordx4 v31, s[28:31], s94 offen offset:1024 lds
    v_mfma_f32_16x16x32_bf16 v[156:159], v[80:83], a[28:31], v[156:159]
    buffer_load_dwordx4 v30, s[28:31], s95 offen offset:2048 lds
    v_max_f32 v32, v88, v92
    v_mfma_f32_16x16x32_bf16 v[152:155], v[80:83], a[12:15], v[152:155]
    buffer_load_dwordx4 v31, s[28:31], s95 offen offset:3072 lds
    v_cmp_lt_f32 vcc, 0x45800000, v32
    s_swappc_b64 s[90:91], s[88:89]
    s_cbranch_vccnz L_trL2b
L_Lret2b:
    s_waitcnt lgkmcnt(12)
    v_mfma_f32_16x16x32_bf16 v[192:195], v[52:55], v[112:115], v[192:195]
    ds_read_b64_tr_b16 v[68:69], v18 offset:49152
    ds_read_b64_tr_b16 v[70:71], v18 offset:53248
    v_exp_f32 v44, v128
    v_mfma_f32_16x16x32_bf16 v[196:199], v[52:55], v[116:119], v[196:199]
    ds_read_b64_tr_b16 v[72:73], v19 offset:49152
    ds_read_b64_tr_b16 v[74:75], v19 offset:53248
    v_exp_f32 v45, v129
    v_mfma_f32_16x16x32_bf16 v[204:207], v[56:59], v[116:119], v[204:207]
    v_exp_f32 v46, v130
    v_add_f32 v28, v28, v88
    v_mfma_f32_16x16x32_bf16 v[200:203], v[56:59], v[112:115], v[200:203]
    v_exp_f32 v47, v131
    v_add_f32 v29, v29, v92
    s_add_u32 m0, s42, 49152
    s_waitcnt vmcnt(10) lgkmcnt(12)
    v_mfma_f32_16x16x32_bf16 v[208:211], v[60:63], v[112:115], v[208:211]
    ds_read_b64_tr_b16 v[76:77], v20 offset:49152
    ds_read_b64_tr_b16 v[78:79], v20 offset:53248
    v_exp_f32 v48, v132
    buffer_load_dwordx4 v22, s[8:11], s40 offen offset:0 nt lds
    v_mfma_f32_16x16x32_bf16 v[212:215], v[60:63], v[116:119], v[212:215]
    ds_read_b64_tr_b16 v[80:81], v21 offset:49152
    ds_read_b64_tr_b16 v[82:83], v21 offset:53248
    v_cvt_pk_bf16_f32 v96, v44, v45
    v_mfma_f32_16x16x32_bf16 v[220:223], v[64:67], v[116:119], v[220:223]
    v_mfma_f32_16x16x32_bf16 v[216:219], v[64:67], v[112:115], v[216:219]
    v_exp_f32 v49, v133
    s_waitcnt lgkmcnt(4)
    v_mfma_f32_16x16x32_bf16 v[224:227], v[68:71], v[112:115], v[224:227]
    ds_read_b64_tr_b16 v[52:53], v14 offset:57344
    ds_read_b64_tr_b16 v[54:55], v14 offset:61440
    v_cvt_pk_bf16_f32 v97, v46, v47
    v_mfma_f32_16x16x32_bf16 v[228:231], v[68:71], v[116:119], v[228:231]
    ds_read_b64_tr_b16 v[56:57], v15 offset:57344
    ds_read_b64_tr_b16 v[58:59], v15 offset:61440
    v_exp_f32 v50, v134
    v_mfma_f32_16x16x32_bf16 v[236:239], v[72:75], v[116:119], v[236:239]
    v_exp_f32 v51, v135
    v_mfma_f32_16x16x32_bf16 v[232:235], v[72:75], v[112:115], v[232:235]
    v_exp_f32 v44, v136
    s_waitcnt vmcnt(9) lgkmcnt(4)
    v_mfma_f32_16x16x32_bf16 v[240:243], v[76:79], v[112:115], v[240:243]
    ds_read_b64_tr_b16 v[60:61], v16 offset:57344
    ds_read_b64_tr_b16 v[62:63], v16 offset:61440
    buffer_load_dwordx4 v23, s[8:11], s40 offen offset:1024 nt lds
    v_mfma_f32_16x16x32_bf16 v[244:247], v[76:79], v[116:119], v[244:247]
    ds_read_b64_tr_b16 v[64:65], v17 offset:57344
    ds_read_b64_tr_b16 v[66:67], v17 offset:61440
    v_cvt_pk_bf16_f32 v100, v48, v49
    v_mfma_f32_16x16x32_bf16 v[252:255], v[80:83], v[116:119], v[252:255]
    v_exp_f32 v45, v137
    v_mfma_f32_16x16x32_bf16 v[248:251], v[80:83], v[112:115], v[248:251]
    v_cvt_pk_bf16_f32 v101, v50, v51
    s_waitcnt lgkmcnt(4)
    v_mfma_f32_16x16x32_bf16 v[192:195], v[52:55], v[120:123], v[192:195]
    ds_read_b64_tr_b16 v[68:69], v18 offset:57344
    ds_read_b64_tr_b16 v[70:71], v18 offset:61440
    v_exp_f32 v46, v138
    v_mfma_f32_16x16x32_bf16 v[196:199], v[52:55], v[124:127], v[196:199]
    ds_read_b64_tr_b16 v[72:73], v19 offset:57344
    ds_read_b64_tr_b16 v[74:75], v19 offset:61440
    v_exp_f32 v47, v139
    v_mfma_f32_16x16x32_bf16 v[204:207], v[56:59], v[124:127], v[204:207]
    v_exp_f32 v48, v140
    v_mfma_f32_16x16x32_bf16 v[200:203], v[56:59], v[120:123], v[200:203]
    s_waitcnt vmcnt(10) lgkmcnt(4)
    v_mfma_f32_16x16x32_bf16 v[208:211], v[60:63], v[120:123], v[208:211]
    ds_read_b64_tr_b16 v[76:77], v20 offset:57344
    ds_read_b64_tr_b16 v[78:79], v20 offset:61440
    v_cvt_pk_bf16_f32 v98, v44, v45
    buffer_load_dwordx4 v24, s[8:11], s40 offen offset:2048 nt lds
    v_mfma_f32_16x16x32_bf16 v[212:215], v[60:63], v[124:127], v[212:215]
    ds_read_b64_tr_b16 v[80:81], v21 offset:57344
    ds_read_b64_tr_b16 v[82:83], v21 offset:61440
    v_exp_f32 v49, v141
    v_mfma_f32_16x16x32_bf16 v[220:223], v[64:67], v[124:127], v[220:223]
    v_cvt_pk_bf16_f32 v99, v46, v47
    v_mfma_f32_16x16x32_bf16 v[216:219], v[64:67], v[120:123], v[216:219]
    v_exp_f32 v50, v142
    s_waitcnt lgkmcnt(4)
    v_mfma_f32_16x16x32_bf16 v[224:227], v[68:71], v[120:123], v[224:227]
    ds_read_b128 v[52:55], v10 offset:16384
    v_exp_f32 v51, v143
    v_mfma_f32_16x16x32_bf16 v[228:231], v[68:71], v[124:127], v[228:231]
    ds_read_b128 v[56:59], v10 offset:20480
    v_mfma_f32_16x16x32_bf16 v[236:239], v[72:75], v[124:127], v[236:239]
    v_exp_f32 v44, v144
    v_mfma_f32_16x16x32_bf16 v[232:235], v[72:75], v[120:123], v[232:235]
    v_cvt_pk_bf16_f32 v102, v48, v49
    s_waitcnt vmcnt(9) lgkmcnt(2)
    v_mfma_f32_16x16x32_bf16 v[240:243], v[76:79], v[120:123], v[240:243]
    ds_read_b128 v[60:63], v10 offset:24576
    v_exp_f32 v45, v145
    buffer_load_dwordx4 v25, s[8:11], s40 offen offset:3072 nt lds
    s_add_u32 s40, s40, 16384
    v_mfma_f32_16x16x32_bf16 v[244:247], v[76:79], v[124:127], v[244:247]
    ds_read_b128 v[64:67], v10 offset:28672
    v_cvt_pk_bf16_f32 v103, v50, v51
    v_mfma_f32_16x16x32_bf16 v[252:255], v[80:83], v[124:127], v[252:255]
    v_exp_f32 v46, v146
    v_mfma_f32_16x16x32_bf16 v[248:251], v[80:83], v[120:123], v[248:251]
    s_waitcnt lgkmcnt(2)
    v_mfma_f32_16x16x32_bf16 v[160:163], v[52:55], a[0:3], v[36:39]
    ds_read_b128 v[68:71], v11 offset:16384
    v_exp_f32 v47, v147
    v_mfma_f32_16x16x32_bf16 v[164:167], v[52:55], a[16:19], v[40:43]
    ds_read_b128 v[72:75], v11 offset:20480
    v_exp_f32 v48, v148
    v_mfma_f32_16x16x32_bf16 v[172:175], v[56:59], a[16:19], v[40:43]
    v_cvt_pk_bf16_f32 v104, v44, v45
    v_mfma_f32_16x16x32_bf16 v[168:171], v[56:59], a[0:3], v[36:39]
    v_exp_f32 v49, v149
    s_add_u32 m0, s43, 16384
    s_waitcnt vmcnt(10) lgkmcnt(2)
    v_mfma_f32_16x16x32_bf16 v[176:179], v[60:63], a[0:3], v[36:39]
    ds_read_b128 v[76:79], v11 offset:24576
    v_cvt_pk_bf16_f32 v105, v46, v47
    buffer_load_dwordx4 v26, s[12:15], s41 offen offset:0 nt lds
    v_mfma_f32_16x16x32_bf16 v[180:183], v[60:63], a[16:19], v[40:43]
    ds_read_b128 v[80:83], v11 offset:28672
    v_exp_f32 v50, v150
    v_mfma_f32_16x16x32_bf16 v[188:191], v[64:67], a[16:19], v[40:43]
    v_exp_f32 v51, v151
    v_mfma_f32_16x16x32_bf16 v[88:91], v[84:87], v[96:99], 0
    v_mfma_f32_16x16x32_bf16 v[184:187], v[64:67], a[0:3], v[36:39]
    v_exp_f32 v44, v152
    v_mfma_f32_16x16x32_bf16 v[92:95], v[84:87], v[100:103], 0
    s_waitcnt lgkmcnt(2)
    v_mfma_f32_16x16x32_bf16 v[160:163], v[68:71], a[4:7], v[160:163]
    ds_read_b128 v[52:55], v12 offset:16384
    v_cvt_pk_bf16_f32 v108, v48, v49
    v_mfma_f32_16x16x32_bf16 v[164:167], v[68:71], a[20:23], v[164:167]
    ds_read_b128 v[56:59], v12 offset:20480
    v_exp_f32 v45, v153
    v_mfma_f32_16x16x32_bf16 v[172:175], v[72:75], a[20:23], v[172:175]
    v_cvt_pk_bf16_f32 v109, v50, v51
    v_mfma_f32_16x16x32_bf16 v[168:171], v[72:75], a[4:7], v[168:171]
    v_exp_f32 v46, v154
    s_waitcnt vmcnt(9) lgkmcnt(2)
    v_mfma_f32_16x16x32_bf16 v[176:179], v[76:79], a[4:7], v[176:179]
    ds_read_b128 v[60:63], v12 offset:24576
    v_exp_f32 v47, v155
    buffer_load_dwordx4 v27, s[12:15], s41 offen offset:1024 nt lds
    v_mfma_f32_16x16x32_bf16 v[180:183], v[76:79], a[20:23], v[180:183]
    ds_read_b128 v[64:67], v12 offset:28672
    v_exp_f32 v48, v156
    v_mfma_f32_16x16x32_bf16 v[188:191], v[80:83], a[20:23], v[188:191]
    v_cvt_pk_bf16_f32 v106, v44, v45
    v_mfma_f32_16x16x32_bf16 v[184:187], v[80:83], a[4:7], v[184:187]
    v_exp_f32 v49, v157
    s_waitcnt vmcnt(10) lgkmcnt(2)
    v_mfma_f32_16x16x32_bf16 v[160:163], v[52:55], a[8:11], v[160:163]
    ds_read_b128 v[68:71], v13 offset:16384
    v_cvt_pk_bf16_f32 v107, v46, v47
    buffer_load_dwordx4 v26, s[12:15], s41 offen offset:2048 nt lds
    v_mfma_f32_16x16x32_bf16 v[164:167], v[52:55], a[24:27], v[164:167]
    ds_read_b128 v[72:75], v13 offset:20480
    v_exp_f32 v50, v158
    v_mfma_f32_16x16x32_bf16 v[172:175], v[56:59], a[24:27], v[172:175]
    v_exp_f32 v51, v159
    v_mfma_f32_16x16x32_bf16 v[168:171], v[56:59], a[8:11], v[168:171]
    s_nop 0
    s_waitcnt lgkmcnt(2)
    v_mfma_f32_16x16x32_bf16 v[176:179], v[60:63], a[8:11], v[176:179]
    ds_read_b128 v[76:79], v13 offset:24576
    v_cvt_pk_bf16_f32 v110, v48, v49
    v_mfma_f32_16x16x32_bf16 v[180:183], v[60:63], a[24:27], v[180:183]
    ds_read_b128 v[80:83], v13 offset:28672
    v_cvt_pk_bf16_f32 v111, v50, v51
    v_mfma_f32_16x16x32_bf16 v[188:191], v[64:67], a[24:27], v[188:191]
    v_mfma_f32_16x16x32_bf16 v[184:187], v[64:67], a[8:11], v[184:187]
    s_waitcnt vmcnt(5) lgkmcnt(2)
    v_mfma_f32_16x16x32_bf16 v[160:163], v[68:71], a[12:15], v[160:163]
    buffer_load_dwordx4 v27, s[12:15], s41 offen offset:3072 nt lds
    s_add_u32 s41, s41, 16384
    v_mfma_f32_16x16x32_bf16 v[88:91], v[84:87], v[104:107], v[88:91]
    v_mfma_f32_16x16x32_bf16 v[164:167], v[68:71], a[28:31], v[164:167]
    v_mfma_f32_16x16x32_bf16 v[92:95], v[84:87], v[108:111], v[92:95]
    v_mfma_f32_16x16x32_bf16 v[172:175], v[72:75], a[28:31], v[172:175]
    s_waitcnt vmcnt(8) lgkmcnt(0)
    s_barrier
    ds_read_b64_tr_b16 v[52:53], v14 offset:0
    ds_read_b64_tr_b16 v[54:55], v14 offset:4096
    v_mfma_f32_16x16x32_bf16 v[168:171], v[72:75], a[12:15], v[168:171]
    s_add_u32 m0, s84, 0
    ds_read_b64_tr_b16 v[56:57], v15 offset:0
    ds_read_b64_tr_b16 v[58:59], v15 offset:4096
    v_mfma_f32_16x16x32_bf16 v[176:179], v[76:79], a[12:15], v[176:179]
    ds_read_b64_tr_b16 v[60:61], v16 offset:0
    ds_read_b64_tr_b16 v[62:63], v16 offset:4096
    buffer_load_dwordx4 v30, s[28:31], s94 offen offset:0 lds
    v_mfma_f32_16x16x32_bf16 v[180:183], v[76:79], a[28:31], v[180:183]
    ds_read_b64_tr_b16 v[64:65], v17 offset:0
    ds_read_b64_tr_b16 v[66:67], v17 offset:4096
    buffer_load_dwordx4 v31, s[28:31], s94 offen offset:1024 lds
    v_mfma_f32_16x16x32_bf16 v[188:191], v[80:83], a[28:31], v[188:191]
    buffer_load_dwordx4 v30, s[28:31], s95 offen offset:2048 lds
    v_max_f32 v32, v88, v92
    v_mfma_f32_16x16x32_bf16 v[184:187], v[80:83], a[12:15], v[184:187]
    buffer_load_dwordx4 v31, s[28:31], s95 offen offset:3072 lds
    v_cmp_lt_f32 vcc, 0x45800000, v32
    s_swappc_b64 s[90:91], s[88:89]
    s_cbranch_vccnz L_trL3b
L_Lret3b:
    s_cmp_eq_u32 s44, 28
    s_cbranch_scc0 L_L0b
    s_branch L_E0
L_L0i:
    s_add_u32 s80, s42, 16384
    s_add_u32 s81, s42, 49152
    s_add_u32 s45, s45, 14
L_L0a:
    s_waitcnt lgkmcnt(4)
    v_mfma_f32_16x16x32_bf16 v[192:195], v[52:55], v[96:99], v[192:195]
    s_add_u32 s44, s44, 1
    s_cmp_eq_u32 s44, s45
    ds_read_b64_tr_b16 v[68:69], v18 offset:0
    ds_read_b64_tr_b16 v[70:71], v18 offset:4096
    v_exp_f32 v44, v160
    v_mfma_f32_16x16x32_bf16 v[196:199], v[52:55], v[100:103], v[196:199]
    s_cselect_b32 s10, 0, 524288
    s_cselect_b32 s14, 0, 524288
    s_cselect_b32 s82, 0, 16384
    ds_read_b64_tr_b16 v[72:73], v19 offset:0
    ds_read_b64_tr_b16 v[74:75], v19 offset:4096
    v_exp_f32 v45, v161
    v_mfma_f32_16x16x32_bf16 v[204:207], v[56:59], v[100:103], v[204:207]
    v_exp_f32 v46, v162
    v_add_f32 v28, v28, v88
    v_mfma_f32_16x16x32_bf16 v[200:203], v[56:59], v[96:99], v[200:203]
    v_exp_f32 v47, v163
    v_add_f32 v29, v29, v92
    s_mov_b32 m0, s80
    s_waitcnt vmcnt(6) lgkmcnt(4)
    v_mfma_f32_16x16x32_bf16 v[208:211], v[60:63], v[96:99], v[208:211]
    ds_read_b64_tr_b16 v[76:77], v20 offset:0
    ds_read_b64_tr_b16 v[78:79], v20 offset:4096
    v_exp_f32 v48, v164
    buffer_load_dwordx4 v22, s[8:11], s40 offen offset:0 nt lds
    v_mfma_f32_16x16x32_bf16 v[212:215], v[60:63], v[100:103], v[212:215]
    ds_read_b64_tr_b16 v[80:81], v21 offset:0
    ds_read_b64_tr_b16 v[82:83], v21 offset:4096
    v_cvt_pk_bf16_f32 v112, v44, v45
    v_mfma_f32_16x16x32_bf16 v[220:223], v[64:67], v[100:103], v[220:223]
    v_mfma_f32_16x16x32_bf16 v[216:219], v[64:67], v[96:99], v[216:219]
    v_exp_f32 v49, v165
    s_waitcnt lgkmcnt(4)
    v_mfma_f32_16x16x32_bf16 v[224:227], v[68:71], v[96:99], v[224:227]
    ds_read_b64_tr_b16 v[52:53], v14 offset:8192
    ds_read_b64_tr_b16 v[54:55], v14 offset:12288
    v_cvt_pk_bf16_f32 v113, v46, v47
    v_mfma_f32_16x16x32_bf16 v[228:231], v[68:71], v[100:103], v[228:231]
    ds_read_b64_tr_b16 v[56:57], v15 offset:8192
    ds_read_b64_tr_b16 v[58:59], v15 offset:12288
    v_exp_f32 v50, v166
    v_mfma_f32_16x16x32_bf16 v[236:239], v[72:75], v[100:103], v[236:239]
    v_exp_f32 v51, v167
    v_mfma_f32_16x16x32_bf16 v[232:235], v[72:75], v[96:99], v[232:235]
    v_exp_f32 v44, v168
    s_waitcnt vmcnt(5) lgkmcnt(4)
    v_mfma_f32_16x16x32_bf16 v[240:243], v[76:79], v[96:99], v[240:243]
    ds_read_b64_tr_b16 v[60:61], v16 offset:8192
    ds_read_b64_tr_b16 v[62:63], v16 offset:12288
    buffer_load_dwordx4 v23, s[8:11], s40 offen offset:1024 nt lds
    s_add_u32 s80, s80, s82
    v_mfma_f32_16x16x32_bf16 v[244:247], v[76:79], v[100:103], v[244:247]
    ds_read_b64_tr_b16 v[64:65], v17 offset:8192
    ds_read_b64_tr_b16 v[66:67], v17 offset:12288
    v_cvt_pk_bf16_f32 v116, v48, v49
    v_mfma_f32_16x16x32_bf16 v[252:255], v[80:83], v[100:103], v[252:255]
    v_exp_f32 v45, v169
    v_mfma_f32_16x16x32_bf16 v[248:251], v[80:83], v[96:99], v[248:251]
    v_cvt_pk_bf16_f32 v117, v50, v51
    s_waitcnt lgkmcnt(4)
    v_mfma_f32_16x16x32_bf16 v[192:195], v[52:55], v[104:107], v[192:195]
    ds_read_b64_tr_b16 v[68:69], v18 offset:8192
    ds_read_b64_tr_b16 v[70:71], v18 offset:12288
    v_exp_f32 v46, v170
    v_mfma_f32_16x16x32_bf16 v[196:199], v[52:55], v[108:111], v[196:199]
    ds_read_b64_tr_b16 v[72:73], v19 offset:8192
    ds_read_b64_tr_b16 v[74:75], v19 offset:12288
    v_exp_f32 v47, v171
    v_mfma_f32_16x16x32_bf16 v[204:207], v[56:59], v[108:111], v[204:207]
    v_exp_f32 v48, v172
    v_mfma_f32_16x16x32_bf16 v[200:203], v[56:59], v[104:107], v[200:203]
    s_waitcnt vmcnt(6) lgkmcnt(4)
    v_mfma_f32_16x16x32_bf16 v[208:211], v[60:63], v[104:107], v[208:211]
    ds_read_b64_tr_b16 v[76:77], v20 offset:8192
    ds_read_b64_tr_b16 v[78:79], v20 offset:12288
    v_cvt_pk_bf16_f32 v114, v44, v45
    buffer_load_dwordx4 v24, s[8:11], s40 offen offset:2048 nt lds
    s_and_b32 s80, s80, 0xffff
    v_mfma_f32_16x16x32_bf16 v[212:215], v[60:63], v[108:111], v[212:215]
    ds_read_b64_tr_b16 v[80:81], v21 offset:8192
    ds_read_b64_tr_b16 v[82:83], v21 offset:12288
    v_exp_f32 v49, v173
    v_mfma_f32_16x16x32_bf16 v[220:223], v[64:67], v[108:111], v[220:223]
    v_cvt_pk_bf16_f32 v115, v46, v47
    v_mfma_f32_16x16x32_bf16 v[216:219], v[64:67], v[104:107], v[216:219]
    v_exp_f32 v50, v174
    s_waitcnt lgkmcnt(4)
    v_mfma_f32_16x16x32_bf16 v[224:227], v[68:71], v[104:107], v[224:227]
    ds_read_b128 v[52:55], v10 offset:32768
    v_exp_f32 v51, v175
    v_mfma_f32_16x16x32_bf16 v[228:231], v[68:71], v[108:111], v[228:231]
    ds_read_b128 v[56:59], v10 offset:36864
    v_mfma_f32_16x16x32_bf16 v[236:239], v[72:75], v[108:111], v[236:239]
    v_exp_f32 v44, v176
    v_mfma_f32_16x16x32_bf16 v[232:235], v[72:75], v[104:107], v[232:235]
    v_cvt_pk_bf16_f32 v118, v48, v49
    s_waitcnt vmcnt(5) lgkmcnt(2)
    v_mfma_f32_16x16x32_bf16 v[240:243], v[76:79], v[104:107], v[240:243]
    ds_read_b128 v[60:63], v10 offset:40960
    v_exp_f32 v45, v177
    buffer_load_dwordx4 v25, s[8:11], s40 offen offset:3072 nt lds
    s_add_u32 s40, s40, s82
    v_mfma_f32_16x16x32_bf16 v[244:247], v[76:79], v[108:111], v[244:247]
    ds_read_b128 v[64:67], v10 offset:45056
    v_cvt_pk_bf16_f32 v119, v50, v51
    v_mfma_f32_16x16x32_bf16 v[252:255], v[80:83], v[108:111], v[252:255]
    v_exp_f32 v46, v178
    v_mfma_f32_16x16x32_bf16 v[248:251], v[80:83], v[104:107], v[248:251]
    s_waitcnt lgkmcnt(2)
    v_mfma_f32_16x16x32_bf16 v[128:131], v[52:55], a[0:3], v[36:39]
    ds_read_b128 v[68:71], v11 offset:32768
    v_exp_f32 v47, v179
    v_mfma_f32_16x16x32_bf16 v[132:135], v[52:55], a[16:19], v[40:43]
    ds_read_b128 v[72:75], v11 offset:36864
    v_exp_f32 v48, v180
    v_mfma_f32_16x16x32_bf16 v[140:143], v[56:59], a[16:19], v[40:43]
    v_cvt_pk_bf16_f32 v120, v44, v45
    v_mfma_f32_16x16x32_bf16 v[136:139], v[56:59], a[0:3], v[36:39]
    v_exp_f32 v49, v181
    s_add_u32 m0, s81, 65536
    s_waitcnt vmcnt(6) lgkmcnt(2)
    v_mfma_f32_16x16x32_bf16 v[144:147], v[60:63], a[0:3], v[36:39]
    ds_read_b128 v[76:79], v11 offset:40960
    v_cvt_pk_bf16_f32 v121, v46, v47
    buffer_load_dwordx4 v26, s[12:15], s41 offen offset:0 nt lds
    v_mfma_f32_16x16x32_bf16 v[148:151], v[60:63], a[16:19], v[40:43]
    ds_read_b128 v[80:83], v11 offset:45056
    v_exp_f32 v50, v182
    v_mfma_f32_16x16x32_bf16 v[156:159], v[64:67], a[16:19], v[40:43]
    v_exp_f32 v51, v183
    v_mfma_f32_16x16x32_bf16 v[88:91], v[84:87], v[112:115], 0
    v_mfma_f32_16x16x32_bf16 v[152:155], v[64:67], a[0:3], v[36:39]
    v_exp_f32 v44, v184
    v_mfma_f32_16x16x32_bf16 v[92:95], v[84:87], v[116:119], 0
    s_waitcnt lgkmcnt(2)
    v_mfma_f32_16x16x32_bf16 v[128:131], v[68:71], a[4:7], v[128:131]
    ds_read_b128 v[52:55], v12 offset:32768
    v_cvt_pk_bf16_f32 v124, v48, v49
    v_mfma_f32_16x16x32_bf16 v[132:135], v[68:71], a[20:23], v[132:135]
    ds_read_b128 v[56:59], v12 offset:36864
    v_exp_f32 v45, v185
    v_mfma_f32_16x16x32_bf16 v[140:143], v[72:75], a[20:23], v[140:143]
    v_cvt_pk_bf16_f32 v125, v50, v51
    v_mfma_f32_16x16x32_bf16 v[136:139], v[72:75], a[4:7], v[136:139]
    v_exp_f32 v46, v186
    s_waitcnt vmcnt(5) lgkmcnt(2)
    v_mfma_f32_16x16x32_bf16 v[144:147], v[76:79], a[4:7], v[144:147]
    ds_read_b128 v[60:63], v12 offset:40960
    v_exp_f32 v47, v187
    buffer_load_dwordx4 v27, s[12:15], s41 offen offset:1024 nt lds
    s_add_u32 s81, s81, s82
    v_mfma_f32_16x16x32_bf16 v[148:151], v[76:79], a[20:23], v[148:151]
    ds_read_b128 v[64:67], v12 offset:45056
    v_exp_f32 v48, v188
    v_mfma_f32_16x16x32_bf16 v[156:159], v[80:83], a[20:23], v[156:159]
    v_cvt_pk_bf16_f32 v122, v44, v45
    v_mfma_f32_16x16x32_bf16 v[152:155], v[80:83], a[4:7], v[152:155]
    v_exp_f32 v49, v189
    s_waitcnt vmcnt(6) lgkmcnt(2)
    v_mfma_f32_16x16x32_bf16 v[128:131], v[52:55], a[8:11], v[128:131]
    ds_read_b128 v[68:71], v13 offset:32768
    v_cvt_pk_bf16_f32 v123, v46, v47
    buffer_load_dwordx4 v26, s[12:15], s41 offen offset:2048 nt lds
    s_and_b32 s81, s81, 0xffff
    v_mfma_f32_16x16x32_bf16 v[132:135], v[52:55], a[24:27], v[132:135]
    ds_read_b128 v[72:75], v13 offset:36864
    v_exp_f32 v50, v190
    v_mfma_f32_16x16x32_bf16 v[140:143], v[56:59], a[24:27], v[140:143]
    v_exp_f32 v51, v191
    v_mfma_f32_16x16x32_bf16 v[136:139], v[56:59], a[8:11], v[136:139]
    s_nop 0
    s_waitcnt lgkmcnt(2)
    v_mfma_f32_16x16x32_bf16 v[144:147], v[60:63], a[8:11], v[144:147]
    ds_read_b128 v[76:79], v13 offset:40960
    v_cvt_pk_bf16_f32 v126, v48, v49
    v_mfma_f32_16x16x32_bf16 v[148:151], v[60:63], a[24:27], v[148:151]
    ds_read_b128 v[80:83], v13 offset:45056
    v_cvt_pk_bf16_f32 v127, v50, v51
    v_mfma_f32_16x16x32_bf16 v[156:159], v[64:67], a[24:27], v[156:159]
    v_mfma_f32_16x16x32_bf16 v[152:155], v[64:67], a[8:11], v[152:155]
    s_waitcnt vmcnt(5) lgkmcnt(2)
    v_mfma_f32_16x16x32_bf16 v[128:131], v[68:71], a[12:15], v[128:131]
    buffer_load_dwordx4 v27, s[12:15], s41 offen offset:3072 nt lds
    s_add_u32 s41, s41, s82
    v_mfma_f32_16x16x32_bf16 v[88:91], v[84:87], v[120:123], v[88:91]
    v_mfma_f32_16x16x32_bf16 v[132:135], v[68:71], a[28:31], v[132:135]
    v_mfma_f32_16x16x32_bf16 v[92:95], v[84:87], v[124:127], v[92:95]
    v_mfma_f32_16x16x32_bf16 v[140:143], v[72:75], a[28:31], v[140:143]
    s_waitcnt vmcnt(8) lgkmcnt(0)
    s_barrier
    ds_read_b64_tr_b16 v[52:53], v14 offset:16384
    ds_read_b64_tr_b16 v[54:55], v14 offset:20480
    v_mfma_f32_16x16x32_bf16 v[136:139], v[72:75], a[12:15], v[136:139]
    ds_read_b64_tr_b16 v[56:57], v15 offset:16384
    ds_read_b64_tr_b16 v[58:59], v15 offset:20480
    v_mfma_f32_16x16x32_bf16 v[144:147], v[76:79], a[12:15], v[144:147]
    ds_read_b64_tr_b16 v[60:61], v16 offset:16384
    ds_read_b64_tr_b16 v[62:63], v16 offset:20480
    v_mfma_f32_16x16x32_bf16 v[148:151], v[76:79], a[28:31], v[148:151]
    ds_read_b64_tr_b16 v[64:65], v17 offset:16384
    ds_read_b64_tr_b16 v[66:67], v17 offset:20480
    v_mfma_f32_16x16x32_bf16 v[156:159], v[80:83], a[28:31], v[156:159]
    v_max_f32 v32, v88, v92
    v_mfma_f32_16x16x32_bf16 v[152:155], v[80:83], a[12:15], v[152:155]
    v_cmp_lt_f32 vcc, 0x45800000, v32
    s_cbranch_vccnz L_trL0a
L_Lret0a:
    s_waitcnt lgkmcnt(4)
    v_mfma_f32_16x16x32_bf16 v[192:195], v[52:55], v[112:115], v[192:195]
    s_add_u32 s44, s44, 1
    s_cmp_eq_u32 s44, s45
    ds_read_b64_tr_b16 v[68:69], v18 offset:16384
    ds_read_b64_tr_b16 v[70:71], v18 offset:20480
    v_exp_f32 v44, v128
    v_mfma_f32_16x16x32_bf16 v[196:199], v[52:55], v[116:119], v[196:199]
    s_cselect_b32 s10, 0, 524288
    s_cselect_b32 s14, 0, 524288
    s_cselect_b32 s82, 0, 16384
    ds_read_b64_tr_b16 v[72:73], v19 offset:16384
    ds_read_b64_tr_b16 v[74:75], v19 offset:20480
    v_exp_f32 v45, v129
    v_mfma_f32_16x16x32_bf16 v[204:207], v[56:59], v[116:119], v[204:207]
    v_exp_f32 v46, v130
    v_add_f32 v28, v28, v88
    v_mfma_f32_16x16x32_bf16 v[200:203], v[56:59], v[112:115], v[200:203]
    v_exp_f32 v47, v131
    v_add_f32 v29, v29, v92
    s_mov_b32 m0, s80
    s_waitcnt vmcnt(6) lgkmcnt(4)
    v_mfma_f32_16x16x32_bf16 v[208:211], v[60:63], v[112:115], v[208:211]
    ds_read_b64_tr_b16 v[76:77], v20 offset:16384
    ds_read_b64_tr_b16 v[78:79], v20 offset:20480
    v_exp_f32 v48, v132
    buffer_load_dwordx4 v22, s[8:11], s40 offen offset:0 nt lds
    v_mfma_f32_16x16x32_bf16 v[212:215], v[60:63], v[116:119], v[212:215]
    ds_read_b64_tr_b16 v[80:81], v21 offset:16384
    ds_read_b64_tr_b16 v[82:83], v21 offset:20480
    v_cvt_pk_bf16_f32 v96, v44, v45
    v_mfma_f32_16x16x32_bf16 v[220:223], v[64:67], v[116:119], v[220:223]
    v_mfma_f32_16x16x32_bf16 v[216:219], v[64:67], v[112:115], v[216:219]
    v_exp_f32 v49, v133
    s_waitcnt lgkmcnt(4)
    v_mfma_f32_16x16x32_bf16 v[224:227], v[68:71], v[112:115], v[224:227]
    ds_read_b64_tr_b16 v[52:53], v14 offset:24576
    ds_read_b64_tr_b16 v[54:55], v14 offset:28672
    v_cvt_pk_bf16_f32 v97, v46, v47
    v_mfma_f32_16x16x32_bf16 v[228:231], v[68:71], v[116:119], v[228:231]
    ds_read_b64_tr_b16 v[56:57], v15 offset:24576
    ds_read_b64_tr_b16 v[58:59], v15 offset:28672
    v_exp_f32 v50, v134
    v_mfma_f32_16x16x32_bf16 v[236:239], v[72:75], v[116:119], v[236:239]
    v_exp_f32 v51, v135
    v_mfma_f32_16x16x32_bf16 v[232:235], v[72:75], v[112:115], v[232:235]
    v_exp_f32 v44, v136
    s_waitcnt vmcnt(5) lgkmcnt(4)
    v_mfma_f32_16x16x32_bf16 v[240:243], v[76:79], v[112:115], v[240:243]
    ds_read_b64_tr_b16 v[60:61], v16 offset:24576
    ds_read_b64_tr_b16 v[62:63], v16 offset:28672
    buffer_load_dwordx4 v23, s[8:11], s40 offen offset:1024 nt lds
    s_add_u32 s80, s80, s82
    v_mfma_f32_16x16x32_bf16 v[244:247], v[76:79], v[116:119], v[244:247]
    ds_read_b64_tr_b16 v[64:65], v17 offset:24576
    ds_read_b64_tr_b16 v[66:67], v17 offset:28672
    v_cvt_pk_bf16_f32 v100, v48, v49
    v_mfma_f32_16x16x32_bf16 v[252:255], v[80:83], v[116:119], v[252:255]
    v_exp_f32 v45, v137
    v_mfma_f32_16x16x32_bf16 v[248:251], v[80:83], v[112:115], v[248:251]
    v_cvt_pk_bf16_f32 v101, v50, v51
    s_waitcnt lgkmcnt(4)
    v_mfma_f32_16x16x32_bf16 v[192:195], v[52:55], v[120:123], v[192:195]
    ds_read_b64_tr_b16 v[68:69], v18 offset:24576
    ds_read_b64_tr_b16 v[70:71], v18 offset:28672
    v_exp_f32 v46, v138
    v_mfma_f32_16x16x32_bf16 v[196:199], v[52:55], v[124:127], v[196:199]
    ds_read_b64_tr_b16 v[72:73], v19 offset:24576
    ds_read_b64_tr_b16 v[74:75], v19 offset:28672
    v_exp_f32 v47, v139
    v_mfma_f32_16x16x32_bf16 v[204:207], v[56:59], v[124:127], v[204:207]
    v_exp_f32 v48, v140
    v_mfma_f32_16x16x32_bf16 v[200:203], v[56:59], v[120:123], v[200:203]
    s_waitcnt vmcnt(6) lgkmcnt(4)
    v_mfma_f32_16x16x32_bf16 v[208:211], v[60:63], v[120:123], v[208:211]
    ds_read_b64_tr_b16 v[76:77], v20 offset:24576
    ds_read_b64_tr_b16 v[78:79], v20 offset:28672
    v_cvt_pk_bf16_f32 v98, v44, v45
    buffer_load_dwordx4 v24, s[8:11], s40 offen offset:2048 nt lds
    s_and_b32 s80, s80, 0xffff
    v_mfma_f32_16x16x32_bf16 v[212:215], v[60:63], v[124:127], v[212:215]
    ds_read_b64_tr_b16 v[80:81], v21 offset:24576
    ds_read_b64_tr_b16 v[82:83], v21 offset:28672
    v_exp_f32 v49, v141
    v_mfma_f32_16x16x32_bf16 v[220:223], v[64:67], v[124:127], v[220:223]
    v_cvt_pk_bf16_f32 v99, v46, v47
    v_mfma_f32_16x16x32_bf16 v[216:219], v[64:67], v[120:123], v[216:219]
    v_exp_f32 v50, v142
    s_waitcnt lgkmcnt(4)
    v_mfma_f32_16x16x32_bf16 v[224:227], v[68:71], v[120:123], v[224:227]
    ds_read_b128 v[52:55], v10 offset:49152
    v_exp_f32 v51, v143
    v_mfma_f32_16x16x32_bf16 v[228:231], v[68:71], v[124:127], v[228:231]
    ds_read_b128 v[56:59], v10 offset:53248
    v_mfma_f32_16x16x32_bf16 v[236:239], v[72:75], v[124:127], v[236:239]
    v_exp_f32 v44, v144
    v_mfma_f32_16x16x32_bf16 v[232:235], v[72:75], v[120:123], v[232:235]
    v_cvt_pk_bf16_f32 v102, v48, v49
    s_waitcnt vmcnt(5) lgkmcnt(2)
    v_mfma_f32_16x16x32_bf16 v[240:243], v[76:79], v[120:123], v[240:243]
    ds_read_b128 v[60:63], v10 offset:57344
    v_exp_f32 v45, v145
    buffer_load_dwordx4 v25, s[8:11], s40 offen offset:3072 nt lds
    s_add_u32 s40, s40, s82
    v_mfma_f32_16x16x32_bf16 v[244:247], v[76:79], v[124:127], v[244:247]
    ds_read_b128 v[64:67], v10 offset:61440
    v_cvt_pk_bf16_f32 v103, v50, v51
    v_mfma_f32_16x16x32_bf16 v[252:255], v[80:83], v[124:127], v[252:255]
    v_exp_f32 v46, v146
    v_mfma_f32_16x16x32_bf16 v[248:251], v[80:83], v[120:123], v[248:251]
    s_waitcnt lgkmcnt(2)
    v_mfma_f32_16x16x32_bf16 v[160:163], v[52:55], a[0:3], v[36:39]
    ds_read_b128 v[68:71], v11 offset:49152
    v_exp_f32 v47, v147
    v_mfma_f32_16x16x32_bf16 v[164:167], v[52:55], a[16:19], v[40:43]
    ds_read_b128 v[72:75], v11 offset:53248
    v_exp_f32 v48, v148
    v_mfma_f32_16x16x32_bf16 v[172:175], v[56:59], a[16:19], v[40:43]
    v_cvt_pk_bf16_f32 v104, v44, v45
    v_mfma_f32_16x16x32_bf16 v[168:171], v[56:59], a[0:3], v[36:39]
    v_exp_f32 v49, v149
    s_add_u32 m0, s81, 65536
    s_waitcnt vmcnt(6) lgkmcnt(2)
    v_mfma_f32_16x16x32_bf16 v[176:179], v[60:63], a[0:3], v[36:39]
    ds_read_b128 v[76:79], v11 offset:57344
    v_cvt_pk_bf16_f32 v105, v46, v47
    buffer_load_dwordx4 v26, s[12:15], s41 offen offset:0 nt lds
    v_mfma_f32_16x16x32_bf16 v[180:183], v[60:63], a[16:19], v[40:43]
    ds_read_b128 v[80:83], v11 offset:61440
    v_exp_f32 v50, v150
    v_mfma_f32_16x16x32_bf16 v[188:191], v[64:67], a[16:19], v[40:43]
    v_exp_f32 v51, v151
    v_mfma_f32_16x16x32_bf16 v[88:91], v[84:87], v[96:99], 0
    v_mfma_f32_16x16x32_bf16 v[184:187], v[64:67], a[0:3], v[36:39]
    v_exp_f32 v44, v152
    v_mfma_f32_16x16x32_bf16 v[92:95], v[84:87], v[100:103], 0
    s_waitcnt lgkmcnt(2)
    v_mfma_f32_16x16x32_bf16 v[160:163], v[68:71], a[4:7], v[160:163]
    ds_read_b128 v[52:55], v12 offset:49152
    v_cvt_pk_bf16_f32 v108, v48, v49
    v_mfma_f32_16x16x32_bf16 v[164:167], v[68:71], a[20:23], v[164:167]
    ds_read_b128 v[56:59], v12 offset:53248
    v_exp_f32 v45, v153
    v_mfma_f32_16x16x32_bf16 v[172:175], v[72:75], a[20:23], v[172:175]
    v_cvt_pk_bf16_f32 v109, v50, v51
    v_mfma_f32_16x16x32_bf16 v[168:171], v[72:75], a[4:7], v[168:171]
    v_exp_f32 v46, v154
    s_waitcnt vmcnt(5) lgkmcnt(2)
    v_mfma_f32_16x16x32_bf16 v[176:179], v[76:79], a[4:7], v[176:179]
    ds_read_b128 v[60:63], v12 offset:57344
    v_exp_f32 v47, v155
    buffer_load_dwordx4 v27, s[12:15], s41 offen offset:1024 nt lds
    s_add_u32 s81, s81, s82
    v_mfma_f32_16x16x32_bf16 v[180:183], v[76:79], a[20:23], v[180:183]
    ds_read_b128 v[64:67], v12 offset:61440
    v_exp_f32 v48, v156
    v_mfma_f32_16x16x32_bf16 v[188:191], v[80:83], a[20:23], v[188:191]
    v_cvt_pk_bf16_f32 v106, v44, v45
    v_mfma_f32_16x16x32_bf16 v[184:187], v[80:83], a[4:7], v[184:187]
    v_exp_f32 v49, v157
    s_waitcnt vmcnt(6) lgkmcnt(2)
    v_mfma_f32_16x16x32_bf16 v[160:163], v[52:55], a[8:11], v[160:163]
    ds_read_b128 v[68:71], v13 offset:49152
    v_cvt_pk_bf16_f32 v107, v46, v47
    buffer_load_dwordx4 v26, s[12:15], s41 offen offset:2048 nt lds
    s_and_b32 s81, s81, 0xffff
    v_mfma_f32_16x16x32_bf16 v[164:167], v[52:55], a[24:27], v[164:167]
    ds_read_b128 v[72:75], v13 offset:53248
    v_exp_f32 v50, v158
    v_mfma_f32_16x16x32_bf16 v[172:175], v[56:59], a[24:27], v[172:175]
    v_exp_f32 v51, v159
    v_mfma_f32_16x16x32_bf16 v[168:171], v[56:59], a[8:11], v[168:171]
    s_nop 0
    s_waitcnt lgkmcnt(2)
    v_mfma_f32_16x16x32_bf16 v[176:179], v[60:63], a[8:11], v[176:179]
    ds_read_b128 v[76:79], v13 offset:57344
    v_cvt_pk_bf16_f32 v110, v48, v49
    v_mfma_f32_16x16x32_bf16 v[180:183], v[60:63], a[24:27], v[180:183]
    ds_read_b128 v[80:83], v13 offset:61440
    v_cvt_pk_bf16_f32 v111, v50, v51
    v_mfma_f32_16x16x32_bf16 v[188:191], v[64:67], a[24:27], v[188:191]
    v_mfma_f32_16x16x32_bf16 v[184:187], v[64:67], a[8:11], v[184:187]
    s_waitcnt vmcnt(5) lgkmcnt(2)
    v_mfma_f32_16x16x32_bf16 v[160:163], v[68:71], a[12:15], v[160:163]
    buffer_load_dwordx4 v27, s[12:15], s41 offen offset:3072 nt lds
    s_add_u32 s41, s41, s82
    v_mfma_f32_16x16x32_bf16 v[88:91], v[84:87], v[104:107], v[88:91]
    v_mfma_f32_16x16x32_bf16 v[164:167], v[68:71], a[28:31], v[164:167]
    v_mfma_f32_16x16x32_bf16 v[92:95], v[84:87], v[108:111], v[92:95]
    v_mfma_f32_16x16x32_bf16 v[172:175], v[72:75], a[28:31], v[172:175]
    s_waitcnt vmcnt(8) lgkmcnt(0)
    s_barrier
    ds_read_b64_tr_b16 v[52:53], v14 offset:32768
    ds_read_b64_tr_b16 v[54:55], v14 offset:36864
    v_mfma_f32_16x16x32_bf16 v[168:171], v[72:75], a[12:15], v[168:171]
    ds_read_b64_tr_b16 v[56:57], v15 offset:32768
    ds_read_b64_tr_b16 v[58:59], v15 offset:36864
    v_mfma_f32_16x16x32_bf16 v[176:179], v[76:79], a[12:15], v[176:179]
    ds_read_b64_tr_b16 v[60:61], v16 offset:32768
    ds_read_b64_tr_b16 v[62:63], v16 offset:36864
    v_mfma_f32_16x16x32_bf16 v[180:183], v[76:79], a[28:31], v[180:183]
    ds_read_b64_tr_b16 v[64:65], v17 offset:32768
    ds_read_b64_tr_b16 v[66:67], v17 offset:36864
    v_mfma_f32_16x16x32_bf16 v[188:191], v[80:83], a[28:31], v[188:191]
    v_max_f32 v32, v88, v92
    v_mfma_f32_16x16x32_bf16 v[184:187], v[80:83], a[12:15], v[184:187]
    v_cmp_lt_f32 vcc, 0x45800000, v32
    s_cbranch_vccnz L_trL1a
L_Lret1a:
    s_waitcnt lgkmcnt(4)
    v_mfma_f32_16x16x32_bf16 v[192:195], v[52:55], v[96:99], v[192:195]
    s_add_u32 s44, s44, 1
    s_cmp_eq_u32 s44, s45
    ds_read_b64_tr_b16 v[68:69], v18 offset:32768
    ds_read_b64_tr_b16 v[70:71], v18 offset:36864
    v_exp_f32 v44, v160
    v_mfma_f32_16x16x32_bf16 v[196:199], v[52:55], v[100:103], v[196:199]
    s_cselect_b32 s10, 0, 524288
    s_cselect_b32 s14, 0, 524288
    s_cselect_b32 s82, 0, 16384
    ds_read_b64_tr_b16 v[72:73], v19 offset:32768
    ds_read_b64_tr_b16 v[74:75], v19 offset:36864
    v_exp_f32 v45, v161
    v_mfma_f32_16x16x32_bf16 v[204:207], v[56:59], v[100:103], v[204:207]
    v_exp_f32 v46, v162
    v_add_f32 v28, v28, v88
    v_mfma_f32_16x16x32_bf16 v[200:203], v[56:59], v[96:99], v[200:203]
    v_exp_f32 v47, v163
    v_add_f32 v29, v29, v92
    s_mov_b32 m0, s80
    s_waitcnt vmcnt(6) lgkmcnt(4)
    v_mfma_f32_16x16x32_bf16 v[208:211], v[60:63], v[96:99], v[208:211]
    ds_read_b64_tr_b16 v[76:77], v20 offset:32768
    ds_read_b64_tr_b16 v[78:79], v20 offset:36864
    v_exp_f32 v48, v164
    buffer_load_dwordx4 v22, s[8:11], s40 offen offset:0 nt lds
    v_mfma_f32_16x16x32_bf16 v[212:215], v[60:63], v[100:103], v[212:215]
    ds_read_b64_tr_b16 v[80:81], v21 offset:32768
    ds_read_b64_tr_b16 v[82:83], v21 offset:36864
    v_cvt_pk_bf16_f32 v112, v44, v45
    v_mfma_f32_16x16x32_bf16 v[220:223], v[64:67], v[100:103], v[220:223]
    v_mfma_f32_16x16x32_bf16 v[216:219], v[64:67], v[96:99], v[216:219]
    v_exp_f32 v49, v165
    s_waitcnt lgkmcnt(4)
    v_mfma_f32_16x16x32_bf16 v[224:227], v[68:71], v[96:99], v[224:227]
    ds_read_b64_tr_b16 v[52:53], v14 offset:40960
    ds_read_b64_tr_b16 v[54:55], v14 offset:45056
    v_cvt_pk_bf16_f32 v113, v46, v47
    v_mfma_f32_16x16x32_bf16 v[228:231], v[68:71], v[100:103], v[228:231]
    ds_read_b64_tr_b16 v[56:57], v15 offset:40960
    ds_read_b64_tr_b16 v[58:59], v15 offset:45056
    v_exp_f32 v50, v166
    v_mfma_f32_16x16x32_bf16 v[236:239], v[72:75], v[100:103], v[236:239]
    v_exp_f32 v51, v167
    v_mfma_f32_16x16x32_bf16 v[232:235], v[72:75], v[96:99], v[232:235]
    v_exp_f32 v44, v168
    s_waitcnt vmcnt(5) lgkmcnt(4)
    v_mfma_f32_16x16x32_bf16 v[240:243], v[76:79], v[96:99], v[240:243]
    ds_read_b64_tr_b16 v[60:61], v16 offset:40960
    ds_read_b64_tr_b16 v[62:63], v16 offset:45056
    buffer_load_dwordx4 v23, s[8:11], s40 offen offset:1024 nt lds
    s_add_u32 s80, s80, s82
    v_mfma_f32_16x16x32_bf16 v[244:247], v[76:79], v[100:103], v[244:247]
    ds_read_b64_tr_b16 v[64:65], v17 offset:40960
    ds_read_b64_tr_b16 v[66:67], v17 offset:45056
    v_cvt_pk_bf16_f32 v116, v48, v49
    v_mfma_f32_16x16x32_bf16 v[252:255], v[80:83], v[100:103], v[252:255]
    v_exp_f32 v45, v169
    v_mfma_f32_16x16x32_bf16 v[248:251], v[80:83], v[96:99], v[248:251]
    v_cvt_pk_bf16_f32 v117, v50, v51
    s_waitcnt lgkmcnt(4)
    v_mfma_f32_16x16x32_bf16 v[192:195], v[52:55], v[104:107], v[192:195]
    ds_read_b64_tr_b16 v[68:69], v18 offset:40960
    ds_read_b64_tr_b16 v[70:71], v18 offset:45056
    v_exp_f32 v46, v170
    v_mfma_f32_16x16x32_bf16 v[196:199], v[52:55], v[108:111], v[196:199]
    ds_read_b64_tr_b16 v[72:73], v19 offset:40960
    ds_read_b64_tr_b16 v[74:75], v19 offset:45056
    v_exp_f32 v47, v171
    v_mfma_f32_16x16x32_bf16 v[204:207], v[56:59], v[108:111], v[204:207]
    v_exp_f32 v48, v172
    v_mfma_f32_16x16x32_bf16 v[200:203], v[56:59], v[104:107], v[200:203]
    s_waitcnt vmcnt(6) lgkmcnt(4)
    v_mfma_f32_16x16x32_bf16 v[208:211], v[60:63], v[104:107], v[208:211]
    ds_read_b64_tr_b16 v[76:77], v20 offset:40960
    ds_read_b64_tr_b16 v[78:79], v20 offset:45056
    v_cvt_pk_bf16_f32 v114, v44, v45
    buffer_load_dwordx4 v24, s[8:11], s40 offen offset:2048 nt lds
    s_and_b32 s80, s80, 0xffff
    v_mfma_f32_16x16x32_bf16 v[212:215], v[60:63], v[108:111], v[212:215]
    ds_read_b64_tr_b16 v[80:81], v21 offset:40960
    ds_read_b64_tr_b16 v[82:83], v21 offset:45056
    v_exp_f32 v49, v173
    v_mfma_f32_16x16x32_bf16 v[220:223], v[64:67], v[108:111], v[220:223]
    v_cvt_pk_bf16_f32 v115, v46, v47
    v_mfma_f32_16x16x32_bf16 v[216:219], v[64:67], v[104:107], v[216:219]
    v_exp_f32 v50, v174
    s_waitcnt lgkmcnt(4)
    v_mfma_f32_16x16x32_bf16 v[224:227], v[68:71], v[104:107], v[224:227]
    ds_read_b128 v[52:55], v10 offset:0
    v_exp_f32 v51, v175
    v_mfma_f32_16x16x32_bf16 v[228:231], v[68:71], v[108:111], v[228:231]
    ds_read_b128 v[56:59], v10 offset:4096
    v_mfma_f32_16x16x32_bf16 v[236:239], v[72:75], v[108:111], v[236:239]
    v_exp_f32 v44, v176
    v_mfma_f32_16x16x32_bf16 v[232:235], v[72:75], v[104:107], v[232:235]
    v_cvt_pk_bf16_f32 v118, v48, v49
    s_waitcnt vmcnt(5) lgkmcnt(2)
    v_mfma_f32_16x16x32_bf16 v[240:243], v[76:79], v[104:107], v[240:243]
    ds_read_b128 v[60:63], v10 offset:8192
    v_exp_f32 v45, v177
    buffer_load_dwordx4 v25, s[8:11], s40 offen offset:3072 nt lds
    s_add_u32 s40, s40, s82
    v_mfma_f32_16x16x32_bf16 v[244:247], v[76:79], v[108:111], v[244:247]
    ds_read_b128 v[64:67], v10 offset:12288
    v_cvt_pk_bf16_f32 v119, v50, v51
    v_mfma_f32_16x16x32_bf16 v[252:255], v[80:83], v[108:111], v[252:255]
    v_exp_f32 v46, v178
    v_mfma_f32_16x16x32_bf16 v[248:251], v[80:83], v[104:107], v[248:251]
    s_waitcnt lgkmcnt(2)
    v_mfma_f32_16x16x32_bf16 v[128:131], v[52:55], a[0:3], v[36:39]
    ds_read_b128 v[68:71], v11 offset:0
    v_exp_f32 v47, v179
    v_mfma_f32_16x16x32_bf16 v[132:135], v[52:55], a[16:19], v[40:43]
    ds_read_b128 v[72:75], v11 offset:4096
    v_exp_f32 v48, v180
    v_mfma_f32_16x16x32_bf16 v[140:143], v[56:59], a[16:19], v[40:43]
    v_cvt_pk_bf16_f32 v120, v44, v45
    v_mfma_f32_16x16x32_bf16 v[136:139], v[56:59], a[0:3], v[36:39]
    v_exp_f32 v49, v181
    s_add_u32 m0, s81, 65536
    s_waitcnt vmcnt(6) lgkmcnt(2)
    v_mfma_f32_16x16x32_bf16 v[144:147], v[60:63], a[0:3], v[36:39]
    ds_read_b128 v[76:79], v11 offset:8192
    v_cvt_pk_bf16_f32 v121, v46, v47
    buffer_load_dwordx4 v26, s[12:15], s41 offen offset:0 nt lds
    v_mfma_f32_16x16x32_bf16 v[148:151], v[60:63], a[16:19], v[40:43]
    ds_read_b128 v[80:83], v11 offset:12288
    v_exp_f32 v50, v182
    v_mfma_f32_16x16x32_bf16 v[156:159], v[64:67], a[16:19], v[40:43]
    v_exp_f32 v51, v183
    v_mfma_f32_16x16x32_bf16 v[88:91], v[84:87], v[112:115], 0
    v_mfma_f32_16x16x32_bf16 v[152:155], v[64:67], a[0:3], v[36:39]
    v_exp_f32 v44, v184
    v_mfma_f32_16x16x32_bf16 v[92:95], v[84:87], v[116:119], 0
    s_waitcnt lgkmcnt(2)
    v_mfma_f32_16x16x32_bf16 v[128:131], v[68:71], a[4:7], v[128:131]
    ds_read_b128 v[52:55], v12 offset:0
    v_cvt_pk_bf16_f32 v124, v48, v49
    v_mfma_f32_16x16x32_bf16 v[132:135], v[68:71], a[20:23], v[132:135]
    ds_read_b128 v[56:59], v12 offset:4096
    v_exp_f32 v45, v185
    v_mfma_f32_16x16x32_bf16 v[140:143], v[72:75], a[20:23], v[140:143]
    v_cvt_pk_bf16_f32 v125, v50, v51
    v_mfma_f32_16x16x32_bf16 v[136:139], v[72:75], a[4:7], v[136:139]
    v_exp_f32 v46, v186
    s_waitcnt vmcnt(5) lgkmcnt(2)
    v_mfma_f32_16x16x32_bf16 v[144:147], v[76:79], a[4:7], v[144:147]
    ds_read_b128 v[60:63], v12 offset:8192
    v_exp_f32 v47, v187
    buffer_load_dwordx4 v27, s[12:15], s41 offen offset:1024 nt lds
    s_add_u32 s81, s81, s82
    v_mfma_f32_16x16x32_bf16 v[148:151], v[76:79], a[20:23], v[148:151]
    ds_read_b128 v[64:67], v12 offset:12288
    v_exp_f32 v48, v188
    v_mfma_f32_16x16x32_bf16 v[156:159], v[80:83], a[20:23], v[156:159]
    v_cvt_pk_bf16_f32 v122, v44, v45
    v_mfma_f32_16x16x32_bf16 v[152:155], v[80:83], a[4:7], v[152:155]
    v_exp_f32 v49, v189
    s_waitcnt vmcnt(6) lgkmcnt(2)
    v_mfma_f32_16x16x32_bf16 v[128:131], v[52:55], a[8:11], v[128:131]
    ds_read_b128 v[68:71], v13 offset:0
    v_cvt_pk_bf16_f32 v123, v46, v47
    buffer_load_dwordx4 v26, s[12:15], s41 offen offset:2048 nt lds
    s_and_b32 s81, s81, 0xffff
    v_mfma_f32_16x16x32_bf16 v[132:135], v[52:55], a[24:27], v[132:135]
    ds_read_b128 v[72:75], v13 offset:4096
    v_exp_f32 v50, v190
    v_mfma_f32_16x16x32_bf16 v[140:143], v[56:59], a[24:27], v[140:143]
    v_exp_f32 v51, v191
    v_mfma_f32_16x16x32_bf16 v[136:139], v[56:59], a[8:11], v[136:139]
    s_nop 0
    s_waitcnt lgkmcnt(2)
    v_mfma_f32_16x16x32_bf16 v[144:147], v[60:63], a[8:11], v[144:147]
    ds_read_b128 v[76:79], v13 offset:8192
    v_cvt_pk_bf16_f32 v126, v48, v49
    v_mfma_f32_16x16x32_bf16 v[148:151], v[60:63], a[24:27], v[148:151]
    ds_read_b128 v[80:83], v13 offset:12288
    v_cvt_pk_bf16_f32 v127, v50, v51
    v_mfma_f32_16x16x32_bf16 v[156:159], v[64:67], a[24:27], v[156:159]
    v_mfma_f32_16x16x32_bf16 v[152:155], v[64:67], a[8:11], v[152:155]
    s_waitcnt vmcnt(5) lgkmcnt(2)
    v_mfma_f32_16x16x32_bf16 v[128:131], v[68:71], a[12:15], v[128:131]
    buffer_load_dwordx4 v27, s[12:15], s41 offen offset:3072 nt lds
    s_add_u32 s41, s41, s82
    v_mfma_f32_16x16x32_bf16 v[88:91], v[84:87], v[120:123], v[88:91]
    v_mfma_f32_16x16x32_bf16 v[132:135], v[68:71], a[28:31], v[132:135]
    v_mfma_f32_16x16x32_bf16 v[92:95], v[84:87], v[124:127], v[92:95]
    v_mfma_f32_16x16x32_bf16 v[140:143], v[72:75], a[28:31], v[140:143]
    s_waitcnt vmcnt(8) lgkmcnt(0)
    s_barrier
    ds_read_b64_tr_b16 v[52:53], v14 offset:49152
    ds_read_b64_tr_b16 v[54:55], v14 offset:53248
    v_mfma_f32_16x16x32_bf16 v[136:139], v[72:75], a[12:15], v[136:139]
    ds_read_b64_tr_b16 v[56:57], v15 offset:49152
    ds_read_b64_tr_b16 v[58:59], v15 offset:53248
    v_mfma_f32_16x16x32_bf16 v[144:147], v[76:79], a[12:15], v[144:147]
    ds_read_b64_tr_b16 v[60:61], v16 offset:49152
    ds_read_b64_tr_b16 v[62:63], v16 offset:53248
    v_mfma_f32_16x16x32_bf16 v[148:151], v[76:79], a[28:31], v[148:151]
    ds_read_b64_tr_b16 v[64:65], v17 offset:49152
    ds_read_b64_tr_b16 v[66:67], v17 offset:53248
    v_mfma_f32_16x16x32_bf16 v[156:159], v[80:83], a[28:31], v[156:159]
    v_max_f32 v32, v88, v92
    v_mfma_f32_16x16x32_bf16 v[152:155], v[80:83], a[12:15], v[152:155]
    v_cmp_lt_f32 vcc, 0x45800000, v32
    s_cbranch_vccnz L_trL2a
L_Lret2a:
    s_waitcnt lgkmcnt(4)
    v_mfma_f32_16x16x32_bf16 v[192:195], v[52:55], v[112:115], v[192:195]
    s_add_u32 s44, s44, 1
    s_cmp_eq_u32 s44, s45
    ds_read_b64_tr_b16 v[68:69], v18 offset:49152
    ds_read_b64_tr_b16 v[70:71], v18 offset:53248
    v_exp_f32 v44, v128
    v_mfma_f32_16x16x32_bf16 v[196:199], v[52:55], v[116:119], v[196:199]
    s_cselect_b32 s10, 0, 524288
    s_cselect_b32 s14, 0, 524288
    s_cselect_b32 s82, 0, 16384
    ds_read_b64_tr_b16 v[72:73], v19 offset:49152
    ds_read_b64_tr_b16 v[74:75], v19 offset:53248
    v_exp_f32 v45, v129
    v_mfma_f32_16x16x32_bf16 v[204:207], v[56:59], v[116:119], v[204:207]
    v_exp_f32 v46, v130
    v_add_f32 v28, v28, v88
    v_mfma_f32_16x16x32_bf16 v[200:203], v[56:59], v[112:115], v[200:203]
    v_exp_f32 v47, v131
    v_add_f32 v29, v29, v92
    s_mov_b32 m0, s80
    s_waitcnt vmcnt(6) lgkmcnt(4)
    v_mfma_f32_16x16x32_bf16 v[208:211], v[60:63], v[112:115], v[208:211]
    ds_read_b64_tr_b16 v[76:77], v20 offset:49152
    ds_read_b64_tr_b16 v[78:79], v20 offset:53248
    v_exp_f32 v48, v132
    buffer_load_dwordx4 v22, s[8:11], s40 offen offset:0 nt lds
    v_mfma_f32_16x16x32_bf16 v[212:215], v[60:63], v[116:119], v[212:215]
    ds_read_b64_tr_b16 v[80:81], v21 offset:49152
    ds_read_b64_tr_b16 v[82:83], v21 offset:53248
    v_cvt_pk_bf16_f32 v96, v44, v45
    v_mfma_f32_16x16x32_bf16 v[220:223], v[64:67], v[116:119], v[220:223]
    v_mfma_f32_16x16x32_bf16 v[216:219], v[64:67], v[112:115], v[216:219]
    v_exp_f32 v49, v133
    s_waitcnt lgkmcnt(4)
    v_mfma_f32_16x16x32_bf16 v[224:227], v[68:71], v[112:115], v[224:227]
    ds_read_b64_tr_b16 v[52:53], v14 offset:57344
    ds_read_b64_tr_b16 v[54:55], v14 offset:61440
    v_cvt_pk_bf16_f32 v97, v46, v47
    v_mfma_f32_16x16x32_bf16 v[228:231], v[68:71], v[116:119], v[228:231]
    ds_read_b64_tr_b16 v[56:57], v15 offset:57344
    ds_read_b64_tr_b16 v[58:59], v15 offset:61440
    v_exp_f32 v50, v134
    v_mfma_f32_16x16x32_bf16 v[236:239], v[72:75], v[116:119], v[236:239]
    v_exp_f32 v51, v135
    v_mfma_f32_16x16x32_bf16 v[232:235], v[72:75], v[112:115], v[232:235]
    v_exp_f32 v44, v136
    s_waitcnt vmcnt(5) lgkmcnt(4)
    v_mfma_f32_16x16x32_bf16 v[240:243], v[76:79], v[112:115], v[240:243]
    ds_read_b64_tr_b16 v[60:61], v16 offset:57344
    ds_read_b64_tr_b16 v[62:63], v16 offset:61440
    buffer_load_dwordx4 v23, s[8:11], s40 offen offset:1024 nt lds
    s_add_u32 s80, s80, s82
    v_mfma_f32_16x16x32_bf16 v[244:247], v[76:79], v[116:119], v[244:247]
    ds_read_b64_tr_b16 v[64:65], v17 offset:57344
    ds_read_b64_tr_b16 v[66:67], v17 offset:61440
    v_cvt_pk_bf16_f32 v100, v48, v49
    v_mfma_f32_16x16x32_bf16 v[252:255], v[80:83], v[116:119], v[252:255]
    v_exp_f32 v45, v137
    v_mfma_f32_16x16x32_bf16 v[248:251], v[80:83], v[112:115], v[248:251]
    v_cvt_pk_bf16_f32 v101, v50, v51
    s_waitcnt lgkmcnt(4)
    v_mfma_f32_16x16x32_bf16 v[192:195], v[52:55], v[120:123], v[192:195]
    ds_read_b64_tr_b16 v[68:69], v18 offset:57344
    ds_read_b64_tr_b16 v[70:71], v18 offset:61440
    v_exp_f32 v46, v138
    v_mfma_f32_16x16x32_bf16 v[196:199], v[52:55], v[124:127], v[196:199]
    ds_read_b64_tr_b16 v[72:73], v19 offset:57344
    ds_read_b64_tr_b16 v[74:75], v19 offset:61440
    v_exp_f32 v47, v139
    v_mfma_f32_16x16x32_bf16 v[204:207], v[56:59], v[124:127], v[204:207]
    v_exp_f32 v48, v140
    v_mfma_f32_16x16x32_bf16 v[200:203], v[56:59], v[120:123], v[200:203]
    s_waitcnt vmcnt(6) lgkmcnt(4)
    v_mfma_f32_16x16x32_bf16 v[208:211], v[60:63], v[120:123], v[208:211]
    ds_read_b64_tr_b16 v[76:77], v20 offset:57344
    ds_read_b64_tr_b16 v[78:79], v20 offset:61440
    v_cvt_pk_bf16_f32 v98, v44, v45
    buffer_load_dwordx4 v24, s[8:11], s40 offen offset:2048 nt lds
    s_and_b32 s80, s80, 0xffff
    v_mfma_f32_16x16x32_bf16 v[212:215], v[60:63], v[124:127], v[212:215]
    ds_read_b64_tr_b16 v[80:81], v21 offset:57344
    ds_read_b64_tr_b16 v[82:83], v21 offset:61440
    v_exp_f32 v49, v141
    v_mfma_f32_16x16x32_bf16 v[220:223], v[64:67], v[124:127], v[220:223]
    v_cvt_pk_bf16_f32 v99, v46, v47
    v_mfma_f32_16x16x32_bf16 v[216:219], v[64:67], v[120:123], v[216:219]
    v_exp_f32 v50, v142
    s_waitcnt lgkmcnt(4)
    v_mfma_f32_16x16x32_bf16 v[224:227], v[68:71], v[120:123], v[224:227]
    ds_read_b128 v[52:55], v10 offset:16384
    v_exp_f32 v51, v143
    v_mfma_f32_16x16x32_bf16 v[228:231], v[68:71], v[124:127], v[228:231]
    ds_read_b128 v[56:59], v10 offset:20480
    v_mfma_f32_16x16x32_bf16 v[236:239], v[72:75], v[124:127], v[236:239]
    v_exp_f32 v44, v144
    v_mfma_f32_16x16x32_bf16 v[232:235], v[72:75], v[120:123], v[232:235]
    v_cvt_pk_bf16_f32 v102, v48, v49
    s_waitcnt vmcnt(5) lgkmcnt(2)
    v_mfma_f32_16x16x32_bf16 v[240:243], v[76:79], v[120:123], v[240:243]
    ds_read_b128 v[60:63], v10 offset:24576
    v_exp_f32 v45, v145
    buffer_load_dwordx4 v25, s[8:11], s40 offen offset:3072 nt lds
    s_add_u32 s40, s40, s82
    v_mfma_f32_16x16x32_bf16 v[244:247], v[76:79], v[124:127], v[244:247]
    ds_read_b128 v[64:67], v10 offset:28672
    v_cvt_pk_bf16_f32 v103, v50, v51
    v_mfma_f32_16x16x32_bf16 v[252:255], v[80:83], v[124:127], v[252:255]
    v_exp_f32 v46, v146
    v_mfma_f32_16x16x32_bf16 v[248:251], v[80:83], v[120:123], v[248:251]
    s_waitcnt lgkmcnt(2)
    v_mfma_f32_16x16x32_bf16 v[160:163], v[52:55], a[0:3], v[36:39]
    ds_read_b128 v[68:71], v11 offset:16384
    v_exp_f32 v47, v147
    v_mfma_f32_16x16x32_bf16 v[164:167], v[52:55], a[16:19], v[40:43]
    ds_read_b128 v[72:75], v11 offset:20480
    v_exp_f32 v48, v148
    v_mfma_f32_16x16x32_bf16 v[172:175], v[56:59], a[16:19], v[40:43]
    v_cvt_pk_bf16_f32 v104, v44, v45
    v_mfma_f32_16x16x32_bf16 v[168:171], v[56:59], a[0:3], v[36:39]
    v_exp_f32 v49, v149
    s_add_u32 m0, s81, 65536
    s_waitcnt vmcnt(6) lgkmcnt(2)
    v_mfma_f32_16x16x32_bf16 v[176:179], v[60:63], a[0:3], v[36:39]
    ds_read_b128 v[76:79], v11 offset:24576
    v_cvt_pk_bf16_f32 v105, v46, v47
    buffer_load_dwordx4 v26, s[12:15], s41 offen offset:0 nt lds
    v_mfma_f32_16x16x32_bf16 v[180:183], v[60:63], a[16:19], v[40:43]
    ds_read_b128 v[80:83], v11 offset:28672
    v_exp_f32 v50, v150
    v_mfma_f32_16x16x32_bf16 v[188:191], v[64:67], a[16:19], v[40:43]
    v_exp_f32 v51, v151
    v_mfma_f32_16x16x32_bf16 v[88:91], v[84:87], v[96:99], 0
    v_mfma_f32_16x16x32_bf16 v[184:187], v[64:67], a[0:3], v[36:39]
    v_exp_f32 v44, v152
    v_mfma_f32_16x16x32_bf16 v[92:95], v[84:87], v[100:103], 0
    s_waitcnt lgkmcnt(2)
    v_mfma_f32_16x16x32_bf16 v[160:163], v[68:71], a[4:7], v[160:163]
    ds_read_b128 v[52:55], v12 offset:16384
    v_cvt_pk_bf16_f32 v108, v48, v49
    v_mfma_f32_16x16x32_bf16 v[164:167], v[68:71], a[20:23], v[164:167]
    ds_read_b128 v[56:59], v12 offset:20480
    v_exp_f32 v45, v153
    v_mfma_f32_16x16x32_bf16 v[172:175], v[72:75], a[20:23], v[172:175]
    v_cvt_pk_bf16_f32 v109, v50, v51
    v_mfma_f32_16x16x32_bf16 v[168:171], v[72:75], a[4:7], v[168:171]
    v_exp_f32 v46, v154
    s_waitcnt vmcnt(5) lgkmcnt(2)
    v_mfma_f32_16x16x32_bf16 v[176:179], v[76:79], a[4:7], v[176:179]
    ds_read_b128 v[60:63], v12 offset:24576
    v_exp_f32 v47, v155
    buffer_load_dwordx4 v27, s[12:15], s41 offen offset:1024 nt lds
    s_add_u32 s81, s81, s82
    v_mfma_f32_16x16x32_bf16 v[180:183], v[76:79], a[20:23], v[180:183]
    ds_read_b128 v[64:67], v12 offset:28672
    v_exp_f32 v48, v156
    v_mfma_f32_16x16x32_bf16 v[188:191], v[80:83], a[20:23], v[188:191]
    v_cvt_pk_bf16_f32 v106, v44, v45
    v_mfma_f32_16x16x32_bf16 v[184:187], v[80:83], a[4:7], v[184:187]
    v_exp_f32 v49, v157
    s_waitcnt vmcnt(6) lgkmcnt(2)
    v_mfma_f32_16x16x32_bf16 v[160:163], v[52:55], a[8:11], v[160:163]
    ds_read_b128 v[68:71], v13 offset:16384
    v_cvt_pk_bf16_f32 v107, v46, v47
    buffer_load_dwordx4 v26, s[12:15], s41 offen offset:2048 nt lds
    s_and_b32 s81, s81, 0xffff
    v_mfma_f32_16x16x32_bf16 v[164:167], v[52:55], a[24:27], v[164:167]
    ds_read_b128 v[72:75], v13 offset:20480
    v_exp_f32 v50, v158
    v_mfma_f32_16x16x32_bf16 v[172:175], v[56:59], a[24:27], v[172:175]
    v_exp_f32 v51, v159
    v_mfma_f32_16x16x32_bf16 v[168:171], v[56:59], a[8:11], v[168:171]
    s_nop 0
    s_waitcnt lgkmcnt(2)
    v_mfma_f32_16x16x32_bf16 v[176:179], v[60:63], a[8:11], v[176:179]
    ds_read_b128 v[76:79], v13 offset:24576
    v_cvt_pk_bf16_f32 v110, v48, v49
    v_mfma_f32_16x16x32_bf16 v[180:183], v[60:63], a[24:27], v[180:183]
    ds_read_b128 v[80:83], v13 offset:28672
    v_cvt_pk_bf16_f32 v111, v50, v51
    v_mfma_f32_16x16x32_bf16 v[188:191], v[64:67], a[24:27], v[188:191]
    v_mfma_f32_16x16x32_bf16 v[184:187], v[64:67], a[8:11], v[184:187]
    s_waitcnt vmcnt(5) lgkmcnt(2)
    v_mfma_f32_16x16x32_bf16 v[160:163], v[68:71], a[12:15], v[160:163]
    buffer_load_dwordx4 v27, s[12:15], s41 offen offset:3072 nt lds
    s_add_u32 s41, s41, s82
    v_mfma_f32_16x16x32_bf16 v[88:91], v[84:87], v[104:107], v[88:91]
    v_mfma_f32_16x16x32_bf16 v[164:167], v[68:71], a[28:31], v[164:167]
    v_mfma_f32_16x16x32_bf16 v[92:95], v[84:87], v[108:111], v[92:95]
    v_mfma_f32_16x16x32_bf16 v[172:175], v[72:75], a[28:31], v[172:175]
    s_waitcnt vmcnt(8) lgkmcnt(0)
    s_barrier
    ds_read_b64_tr_b16 v[52:53], v14 offset:0
    ds_read_b64_tr_b16 v[54:55], v14 offset:4096
    v_mfma_f32_16x16x32_bf16 v[168:171], v[72:75], a[12:15], v[168:171]
    ds_read_b64_tr_b16 v[56:57], v15 offset:0
    ds_read_b64_tr_b16 v[58:59], v15 offset:4096
    v_mfma_f32_16x16x32_bf16 v[176:179], v[76:79], a[12:15], v[176:179]
    ds_read_b64_tr_b16 v[60:61], v16 offset:0
    ds_read_b64_tr_b16 v[62:63], v16 offset:4096
    v_mfma_f32_16x16x32_bf16 v[180:183], v[76:79], a[28:31], v[180:183]
    ds_read_b64_tr_b16 v[64:65], v17 offset:0
    ds_read_b64_tr_b16 v[66:67], v17 offset:4096
    v_mfma_f32_16x16x32_bf16 v[188:191], v[80:83], a[28:31], v[188:191]
    v_max_f32 v32, v88, v92
    v_mfma_f32_16x16x32_bf16 v[184:187], v[80:83], a[12:15], v[184:187]
    v_cmp_lt_f32 vcc, 0x45800000, v32
    s_cbranch_vccnz L_trL3a
L_Lret3a:
    s_cmp_eq_u32 s44, 28
    s_cbranch_scc0 L_L0a
L_E0:
    s_waitcnt lgkmcnt(4)
    v_mfma_f32_16x16x32_bf16 v[192:195], v[52:55], v[96:99], v[192:195]
    ds_read_b64_tr_b16 v[68:69], v18 offset:0
    ds_read_b64_tr_b16 v[70:71], v18 offset:4096
    v_exp_f32 v44, v160
    v_mfma_f32_16x16x32_bf16 v[196:199], v[52:55], v[100:103], v[196:199]
    ds_read_b64_tr_b16 v[72:73], v19 offset:0
    ds_read_b64_tr_b16 v[74:75], v19 offset:4096
    v_exp_f32 v45, v161
    v_mfma_f32_16x16x32_bf16 v[204:207], v[56:59], v[100:103], v[204:207]
    v_exp_f32 v46, v162
    v_add_f32 v28, v28, v88
    v_mfma_f32_16x16x32_bf16 v[200:203], v[56:59], v[96:99], v[200:203]
    v_exp_f32 v47, v163
    v_add_f32 v29, v29, v92
    s_add_u32 m0, s43, 32768
    s_waitcnt vmcnt(6) lgkmcnt(4)
    v_mfma_f32_16x16x32_bf16 v[208:211], v[60:63], v[96:99], v[208:211]
    ds_read_b64_tr_b16 v[76:77], v20 offset:0
    ds_read_b64_tr_b16 v[78:79], v20 offset:4096
    v_exp_f32 v48, v164
    buffer_load_dwordx4 v26, s[12:15], s41 offen offset:0 nt lds
    v_mfma_f32_16x16x32_bf16 v[212:215], v[60:63], v[100:103], v[212:215]
    ds_read_b64_tr_b16 v[80:81], v21 offset:0
    ds_read_b64_tr_b16 v[82:83], v21 offset:4096
    v_cvt_pk_bf16_f32 v112, v44, v45
    v_mfma_f32_16x16x32_bf16 v[220:223], v[64:67], v[100:103], v[220:223]
    v_mfma_f32_16x16x32_bf16 v[216:219], v[64:67], v[96:99], v[216:219]
    v_exp_f32 v49, v165
    s_waitcnt lgkmcnt(4)
    v_mfma_f32_16x16x32_bf16 v[224:227], v[68:71], v[96:99], v[224:227]
    ds_read_b64_tr_b16 v[52:53], v14 offset:8192
    ds_read_b64_tr_b16 v[54:55], v14 offset:12288
    v_cvt_pk_bf16_f32 v113, v46, v47
    v_mfma_f32_16x16x32_bf16 v[228:231], v[68:71], v[100:103], v[228:231]
    ds_read_b64_tr_b16 v[56:57], v15 offset:8192
    ds_read_b64_tr_b16 v[58:59], v15 offset:12288
    v_exp_f32 v50, v166
    v_mfma_f32_16x16x32_bf16 v[236:239], v[72:75], v[100:103], v[236:239]
    v_exp_f32 v51, v167
    v_mfma_f32_16x16x32_bf16 v[232:235], v[72:75], v[96:99], v[232:235]
    v_exp_f32 v44, v168
    s_waitcnt vmcnt(6) lgkmcnt(4)
    v_mfma_f32_16x16x32_bf16 v[240:243], v[76:79], v[96:99], v[240:243]
    ds_read_b64_tr_b16 v[60:61], v16 offset:8192
    ds_read_b64_tr_b16 v[62:63], v16 offset:12288
    buffer_load_dwordx4 v27, s[12:15], s41 offen offset:1024 nt lds
    v_mfma_f32_16x16x32_bf16 v[244:247], v[76:79], v[100:103], v[244:247]
    ds_read_b64_tr_b16 v[64:65], v17 offset:8192
    ds_read_b64_tr_b16 v[66:67], v17 offset:12288
    v_cvt_pk_bf16_f32 v116, v48, v49
    v_mfma_f32_16x16x32_bf16 v[252:255], v[80:83], v[100:103], v[252:255]
    v_exp_f32 v45, v169
    v_mfma_f32_16x16x32_bf16 v[248:251], v[80:83], v[96:99], v[248:251]
    v_cvt_pk_bf16_f32 v117, v50, v51
    s_waitcnt lgkmcnt(4)
    v_mfma_f32_16x16x32_bf16 v[192:195], v[52:55], v[104:107], v[192:195]
    ds_read_b64_tr_b16 v[68:69], v18 offset:8192
    ds_read_b64_tr_b16 v[70:71], v18 offset:12288
    v_exp_f32 v46, v170
    v_mfma_f32_16x16x32_bf16 v[196:199], v[52:55], v[108:111], v[196:199]
    ds_read_b64_tr_b16 v[72:73], v19 offset:8192
    ds_read_b64_tr_b16 v[74:75], v19 offset:12288
    v_exp_f32 v47, v171
    v_mfma_f32_16x16x32_bf16 v[204:207], v[56:59], v[108:111], v[204:207]
    v_exp_f32 v48, v172
    v_mfma_f32_16x16x32_bf16 v[200:203], v[56:59], v[104:107], v[200:203]
    s_waitcnt vmcnt(6) lgkmcnt(4)
    v_mfma_f32_16x16x32_bf16 v[208:211], v[60:63], v[104:107], v[208:211]
    ds_read_b64_tr_b16 v[76:77], v20 offset:8192
    ds_read_b64_tr_b16 v[78:79], v20 offset:12288
    v_cvt_pk_bf16_f32 v114, v44, v45
    buffer_load_dwordx4 v26, s[12:15], s41 offen offset:2048 nt lds
    v_mfma_f32_16x16x32_bf16 v[212:215], v[60:63], v[108:111], v[212:215]
    ds_read_b64_tr_b16 v[80:81], v21 offset:8192
    ds_read_b64_tr_b16 v[82:83], v21 offset:12288
    v_exp_f32 v49, v173
    v_mfma_f32_16x16x32_bf16 v[220:223], v[64:67], v[108:111], v[220:223]
    v_cvt_pk_bf16_f32 v115, v46, v47
    v_mfma_f32_16x16x32_bf16 v[216:219], v[64:67], v[104:107], v[216:219]
    v_exp_f32 v50, v174
    s_waitcnt lgkmcnt(4)
    v_mfma_f32_16x16x32_bf16 v[224:227], v[68:71], v[104:107], v[224:227]
    ds_read_b128 v[52:55], v10 offset:32768
    v_exp_f32 v51, v175
    v_mfma_f32_16x16x32_bf16 v[228:231], v[68:71], v[108:111], v[228:231]
    ds_read_b128 v[56:59], v10 offset:36864
    v_mfma_f32_16x16x32_bf16 v[236:239], v[72:75], v[108:111], v[236:239]
    v_exp_f32 v44, v176
    v_mfma_f32_16x16x32_bf16 v[232:235], v[72:75], v[104:107], v[232:235]
    v_cvt_pk_bf16_f32 v118, v48, v49
    s_waitcnt vmcnt(6) lgkmcnt(2)
    v_mfma_f32_16x16x32_bf16 v[240:243], v[76:79], v[104:107], v[240:243]
    ds_read_b128 v[60:63], v10 offset:40960
    v_exp_f32 v45, v177
    buffer_load_dwordx4 v27, s[12:15], s41 offen offset:3072 nt lds
    s_add_u32 s41, s41, 16384
    v_mfma_f32_16x16x32_bf16 v[244:247], v[76:79], v[108:111], v[244:247]
    ds_read_b128 v[64:67], v10 offset:45056
    v_cvt_pk_bf16_f32 v119, v50, v51
    v_mfma_f32_16x16x32_bf16 v[252:255], v[80:83], v[108:111], v[252:255]
    v_exp_f32 v46, v178
    v_mfma_f32_16x16x32_bf16 v[248:251], v[80:83], v[104:107], v[248:251]
    s_waitcnt lgkmcnt(2)
    v_mfma_f32_16x16x32_bf16 v[128:131], v[52:55], a[0:3], v[36:39]
    ds_read_b128 v[68:71], v11 offset:32768
    v_exp_f32 v47, v179
    v_mfma_f32_16x16x32_bf16 v[132:135], v[52:55], a[16:19], v[40:43]
    ds_read_b128 v[72:75], v11 offset:36864
    v_exp_f32 v48, v180
    v_mfma_f32_16x16x32_bf16 v[140:143], v[56:59], a[16:19], v[40:43]
    v_cvt_pk_bf16_f32 v120, v44, v45
    v_mfma_f32_16x16x32_bf16 v[136:139], v[56:59], a[0:3], v[36:39]
    v_exp_f32 v49, v181
    s_add_u32 m0, s43, 49152
    s_waitcnt vmcnt(6) lgkmcnt(2)
    v_mfma_f32_16x16x32_bf16 v[144:147], v[60:63], a[0:3], v[36:39]
    ds_read_b128 v[76:79], v11 offset:40960
    v_cvt_pk_bf16_f32 v121, v46, v47
    buffer_load_dwordx4 v26, s[12:15], s41 offen offset:0 nt lds
    v_mfma_f32_16x16x32_bf16 v[148:151], v[60:63], a[16:19], v[40:43]
    ds_read_b128 v[80:83], v11 offset:45056
    v_exp_f32 v50, v182
    v_mfma_f32_16x16x32_bf16 v[156:159], v[64:67], a[16:19], v[40:43]
    v_exp_f32 v51, v183
    v_mfma_f32_16x16x32_bf16 v[88:91], v[84:87], v[112:115], 0
    v_mfma_f32_16x16x32_bf16 v[152:155], v[64:67], a[0:3], v[36:39]
    v_exp_f32 v44, v184
    v_mfma_f32_16x16x32_bf16 v[92:95], v[84:87], v[116:119], 0
    s_waitcnt lgkmcnt(2)
    v_mfma_f32_16x16x32_bf16 v[128:131], v[68:71], a[4:7], v[128:131]
    ds_read_b128 v[52:55], v12 offset:32768
    v_cvt_pk_bf16_f32 v124, v48, v49
    v_mfma_f32_16x16x32_bf16 v[132:135], v[68:71], a[20:23], v[132:135]
    ds_read_b128 v[56:59], v12 offset:36864
    v_exp_f32 v45, v185
    v_mfma_f32_16x16x32_bf16 v[140:143], v[72:75], a[20:23], v[140:143]
    v_cvt_pk_bf16_f32 v125, v50, v51
    v_mfma_f32_16x16x32_bf16 v[136:139], v[72:75], a[4:7], v[136:139]
    v_exp_f32 v46, v186
    s_waitcnt vmcnt(6) lgkmcnt(2)
    v_mfma_f32_16x16x32_bf16 v[144:147], v[76:79], a[4:7], v[144:147]
    ds_read_b128 v[60:63], v12 offset:40960
    v_exp_f32 v47, v187
    buffer_load_dwordx4 v27, s[12:15], s41 offen offset:1024 nt lds
    v_mfma_f32_16x16x32_bf16 v[148:151], v[76:79], a[20:23], v[148:151]
    ds_read_b128 v[64:67], v12 offset:45056
    v_exp_f32 v48, v188
    v_mfma_f32_16x16x32_bf16 v[156:159], v[80:83], a[20:23], v[156:159]
    v_cvt_pk_bf16_f32 v122, v44, v45
    v_mfma_f32_16x16x32_bf16 v[152:155], v[80:83], a[4:7], v[152:155]
    v_exp_f32 v49, v189
    s_waitcnt vmcnt(6) lgkmcnt(2)
    v_mfma_f32_16x16x32_bf16 v[128:131], v[52:55], a[8:11], v[128:131]
    ds_read_b128 v[68:71], v13 offset:32768
    v_cvt_pk_bf16_f32 v123, v46, v47
    buffer_load_dwordx4 v26, s[12:15], s41 offen offset:2048 nt lds
    v_mfma_f32_16x16x32_bf16 v[132:135], v[52:55], a[24:27], v[132:135]
    ds_read_b128 v[72:75], v13 offset:36864
    v_exp_f32 v50, v190
    v_mfma_f32_16x16x32_bf16 v[140:143], v[56:59], a[24:27], v[140:143]
    v_exp_f32 v51, v191
    v_mfma_f32_16x16x32_bf16 v[136:139], v[56:59], a[8:11], v[136:139]
    s_nop 0
    s_waitcnt lgkmcnt(2)
    v_mfma_f32_16x16x32_bf16 v[144:147], v[60:63], a[8:11], v[144:147]
    ds_read_b128 v[76:79], v13 offset:40960
    v_cvt_pk_bf16_f32 v126, v48, v49
    v_mfma_f32_16x16x32_bf16 v[148:151], v[60:63], a[24:27], v[148:151]
    ds_read_b128 v[80:83], v13 offset:45056
    v_cvt_pk_bf16_f32 v127, v50, v51
    v_mfma_f32_16x16x32_bf16 v[156:159], v[64:67], a[24:27], v[156:159]
    v_mfma_f32_16x16x32_bf16 v[152:155], v[64:67], a[8:11], v[152:155]
    s_waitcnt vmcnt(6) lgkmcnt(2)
    v_mfma_f32_16x16x32_bf16 v[128:131], v[68:71], a[12:15], v[128:131]
    buffer_load_dwordx4 v27, s[12:15], s41 offen offset:3072 nt lds
    s_add_u32 s41, s41, 16384
    v_mfma_f32_16x16x32_bf16 v[88:91], v[84:87], v[120:123], v[88:91]
    v_mfma_f32_16x16x32_bf16 v[132:135], v[68:71], a[28:31], v[132:135]
    v_mfma_f32_16x16x32_bf16 v[92:95], v[84:87], v[124:127], v[92:95]
    v_mfma_f32_16x16x32_bf16 v[140:143], v[72:75], a[28:31], v[140:143]
    s_waitcnt vmcnt(8) lgkmcnt(0)
    s_barrier
    ds_read_b64_tr_b16 v[52:53], v14 offset:16384
    ds_read_b64_tr_b16 v[54:55], v14 offset:20480
    v_mfma_f32_16x16x32_bf16 v[136:139], v[72:75], a[12:15], v[136:139]
    ds_read_b64_tr_b16 v[56:57], v15 offset:16384
    ds_read_b64_tr_b16 v[58:59], v15 offset:20480
    v_mfma_f32_16x16x32_bf16 v[144:147], v[76:79], a[12:15], v[144:147]
    ds_read_b64_tr_b16 v[60:61], v16 offset:16384
    ds_read_b64_tr_b16 v[62:63], v16 offset:20480
    v_mfma_f32_16x16x32_bf16 v[148:151], v[76:79], a[28:31], v[148:151]
    ds_read_b64_tr_b16 v[64:65], v17 offset:16384
    ds_read_b64_tr_b16 v[66:67], v17 offset:20480
    v_mfma_f32_16x16x32_bf16 v[156:159], v[80:83], a[28:31], v[156:159]
    v_max_f32 v32, v88, v92
    v_mfma_f32_16x16x32_bf16 v[152:155], v[80:83], a[12:15], v[152:155]
    v_cmp_lt_f32 vcc, 0x45800000, v32
    s_cbranch_vccnz L_trE0
L_Eret0:
    s_waitcnt lgkmcnt(4)
    v_mfma_f32_16x16x32_bf16 v[192:195], v[52:55], v[112:115], v[192:195]
    ds_read_b64_tr_b16 v[68:69], v18 offset:16384
    ds_read_b64_tr_b16 v[70:71], v18 offset:20480
    v_exp_f32 v44, v128
    v_mfma_f32_16x16x32_bf16 v[196:199], v[52:55], v[116:119], v[196:199]
    ds_read_b64_tr_b16 v[72:73], v19 offset:16384
    ds_read_b64_tr_b16 v[74:75], v19 offset:20480
    v_exp_f32 v45, v129
    v_mfma_f32_16x16x32_bf16 v[204:207], v[56:59], v[116:119], v[204:207]
    v_exp_f32 v46, v130
    v_add_f32 v28, v28, v88
    v_mfma_f32_16x16x32_bf16 v[200:203], v[56:59], v[112:115], v[200:203]
    v_exp_f32 v47, v131
    v_add_f32 v29, v29, v92
    s_waitcnt lgkmcnt(4)
    v_mfma_f32_16x16x32_bf16 v[208:211], v[60:63], v[112:115], v[208:211]
    ds_read_b64_tr_b16 v[76:77], v20 offset:16384
    ds_read_b64_tr_b16 v[78:79], v20 offset:20480
    v_exp_f32 v48, v132
    v_mfma_f32_16x16x32_bf16 v[212:215], v[60:63], v[116:119], v[212:215]
    ds_read_b64_tr_b16 v[80:81], v21 offset:16384
    ds_read_b64_tr_b16 v[82:83], v21 offset:20480
    v_cvt_pk_bf16_f32 v96, v44, v45
    v_mfma_f32_16x16x32_bf16 v[220:223], v[64:67], v[116:119], v[220:223]
    v_mfma_f32_16x16x32_bf16 v[216:219], v[64:67], v[112:115], v[216:219]
    v_exp_f32 v49, v133
    s_waitcnt lgkmcnt(4)
    v_mfma_f32_16x16x32_bf16 v[224:227], v[68:71], v[112:115], v[224:227]
    ds_read_b64_tr_b16 v[52:53], v14 offset:24576
    ds_read_b64_tr_b16 v[54:55], v14 offset:28672
    v_cvt_pk_bf16_f32 v97, v46, v47
    v_mfma_f32_16x16x32_bf16 v[228:231], v[68:71], v[116:119], v[228:231]
    ds_read_b64_tr_b16 v[56:57], v15 offset:24576
    ds_read_b64_tr_b16 v[58:59], v15 offset:28672
    v_exp_f32 v50, v134
    v_mfma_f32_16x16x32_bf16 v[236:239], v[72:75], v[116:119], v[236:239]
    v_exp_f32 v51, v135
    v_mfma_f32_16x16x32_bf16 v[232:235], v[72:75], v[112:115], v[232:235]
    v_exp_f32 v44, v136
    s_waitcnt lgkmcnt(4)
    v_mfma_f32_16x16x32_bf16 v[240:243], v[76:79], v[112:115], v[240:243]
    ds_read_b64_tr_b16 v[60:61], v16 offset:24576
    ds_read_b64_tr_b16 v[62:63], v16 offset:28672
    v_mfma_f32_16x16x32_bf16 v[244:247], v[76:79], v[116:119], v[244:247]
    ds_read_b64_tr_b16 v[64:65], v17 offset:24576
    ds_read_b64_tr_b16 v[66:67], v17 offset:28672
    v_cvt_pk_bf16_f32 v100, v48, v49
    v_mfma_f32_16x16x32_bf16 v[252:255], v[80:83], v[116:119], v[252:255]
    v_exp_f32 v45, v137
    v_mfma_f32_16x16x32_bf16 v[248:251], v[80:83], v[112:115], v[248:251]
    v_cvt_pk_bf16_f32 v101, v50, v51
    s_waitcnt lgkmcnt(4)
    v_mfma_f32_16x16x32_bf16 v[192:195], v[52:55], v[120:123], v[192:195]
    ds_read_b64_tr_b16 v[68:69], v18 offset:24576
    ds_read_b64_tr_b16 v[70:71], v18 offset:28672
    v_exp_f32 v46, v138
    v_mfma_f32_16x16x32_bf16 v[196:199], v[52:55], v[124:127], v[196:199]
    ds_read_b64_tr_b16 v[72:73], v19 offset:24576
    ds_read_b64_tr_b16 v[74:75], v19 offset:28672
    v_exp_f32 v47, v139
    v_mfma_f32_16x16x32_bf16 v[204:207], v[56:59], v[124:127], v[204:207]
    v_exp_f32 v48, v140
    v_mfma_f32_16x16x32_bf16 v[200:203], v[56:59], v[120:123], v[200:203]
    s_waitcnt lgkmcnt(4)
    v_mfma_f32_16x16x32_bf16 v[208:211], v[60:63], v[120:123], v[208:211]
    ds_read_b64_tr_b16 v[76:77], v20 offset:24576
    ds_read_b64_tr_b16 v[78:79], v20 offset:28672
    v_cvt_pk_bf16_f32 v98, v44, v45
    v_mfma_f32_16x16x32_bf16 v[212:215], v[60:63], v[124:127], v[212:215]
    ds_read_b64_tr_b16 v[80:81], v21 offset:24576
    ds_read_b64_tr_b16 v[82:83], v21 offset:28672
    v_exp_f32 v49, v141
    v_mfma_f32_16x16x32_bf16 v[220:223], v[64:67], v[124:127], v[220:223]
    v_cvt_pk_bf16_f32 v99, v46, v47
    v_mfma_f32_16x16x32_bf16 v[216:219], v[64:67], v[120:123], v[216:219]
    v_exp_f32 v50, v142
    s_waitcnt lgkmcnt(4)
    v_mfma_f32_16x16x32_bf16 v[224:227], v[68:71], v[120:123], v[224:227]
    ds_read_b128 v[52:55], v10 offset:49152
    v_exp_f32 v51, v143
    v_mfma_f32_16x16x32_bf16 v[228:231], v[68:71], v[124:127], v[228:231]
    ds_read_b128 v[56:59], v10 offset:53248
    v_mfma_f32_16x16x32_bf16 v[236:239], v[72:75], v[124:127], v[236:239]
    v_exp_f32 v44, v144
    v_mfma_f32_16x16x32_bf16 v[232:235], v[72:75], v[120:123], v[232:235]
    v_cvt_pk_bf16_f32 v102, v48, v49
    s_waitcnt lgkmcnt(2)
    v_mfma_f32_16x16x32_bf16 v[240:243], v[76:79], v[120:123], v[240:243]
    ds_read_b128 v[60:63], v10 offset:57344
    v_exp_f32 v45, v145
    v_mfma_f32_16x16x32_bf16 v[244:247], v[76:79], v[124:127], v[244:247]
    ds_read_b128 v[64:67], v10 offset:61440
    v_cvt_pk_bf16_f32 v103, v50, v51
    v_mfma_f32_16x16x32_bf16 v[252:255], v[80:83], v[124:127], v[252:255]
    v_exp_f32 v46, v146
    v_mfma_f32_16x16x32_bf16 v[248:251], v[80:83], v[120:123], v[248:251]
    s_waitcnt lgkmcnt(2)
    v_mfma_f32_16x16x32_bf16 v[160:163], v[52:55], a[0:3], v[36:39]
    ds_read_b128 v[68:71], v11 offset:49152
    v_exp_f32 v47, v147
    v_mfma_f32_16x16x32_bf16 v[164:167], v[52:55], a[16:19], v[40:43]
    ds_read_b128 v[72:75], v11 offset:53248
    v_exp_f32 v48, v148
    v_mfma_f32_16x16x32_bf16 v[172:175], v[56:59], a[16:19], v[40:43]
    v_cvt_pk_bf16_f32 v104, v44, v45
    v_mfma_f32_16x16x32_bf16 v[168:171], v[56:59], a[0:3], v[36:39]
    v_exp_f32 v49, v149
    s_waitcnt lgkmcnt(2)
    v_mfma_f32_16x16x32_bf16 v[176:179], v[60:63], a[0:3], v[36:39]
    ds_read_b128 v[76:79], v11 offset:57344
    v_cvt_pk_bf16_f32 v105, v46, v47
    v_mfma_f32_16x16x32_bf16 v[180:183], v[60:63], a[16:19], v[40:43]
    ds_read_b128 v[80:83], v11 offset:61440
    v_exp_f32 v50, v150
    v_mfma_f32_16x16x32_bf16 v[188:191], v[64:67], a[16:19], v[40:43]
    v_exp_f32 v51, v151
    v_mfma_f32_16x16x32_bf16 v[88:91], v[84:87], v[96:99], 0
    v_mfma_f32_16x16x32_bf16 v[184:187], v[64:67], a[0:3], v[36:39]
    v_exp_f32 v44, v152
    v_mfma_f32_16x16x32_bf16 v[92:95], v[84:87], v[100:103], 0
    s_waitcnt lgkmcnt(2)
    v_mfma_f32_16x16x32_bf16 v[160:163], v[68:71], a[4:7], v[160:163]
    ds_read_b128 v[52:55], v12 offset:49152
    v_cvt_pk_bf16_f32 v108, v48, v49
    v_mfma_f32_16x16x32_bf16 v[164:167], v[68:71], a[20:23], v[164:167]
    ds_read_b128 v[56:59], v12 offset:53248
    v_exp_f32 v45, v153
    v_mfma_f32_16x16x32_bf16 v[172:175], v[72:75], a[20:23], v[172:175]
    v_cvt_pk_bf16_f32 v109, v50, v51
    v_mfma_f32_16x16x32_bf16 v[168:171], v[72:75], a[4:7], v[168:171]
    v_exp_f32 v46, v154
    s_waitcnt lgkmcnt(2)
    v_mfma_f32_16x16x32_bf16 v[176:179], v[76:79], a[4:7], v[176:179]
    ds_read_b128 v[60:63], v12 offset:57344
    v_exp_f32 v47, v155
    v_mfma_f32_16x16x32_bf16 v[180:183], v[76:79], a[20:23], v[180:183]
    ds_read_b128 v[64:67], v12 offset:61440
    v_exp_f32 v48, v156
    v_mfma_f32_16x16x32_bf16 v[188:191], v[80:83], a[20:23], v[188:191]
    v_cvt_pk_bf16_f32 v106, v44, v45
    v_mfma_f32_16x16x32_bf16 v[184:187], v[80:83], a[4:7], v[184:187]
    v_exp_f32 v49, v157
    s_waitcnt lgkmcnt(2)
    v_mfma_f32_16x16x32_bf16 v[160:163], v[52:55], a[8:11], v[160:163]
    ds_read_b128 v[68:71], v13 offset:49152
    v_cvt_pk_bf16_f32 v107, v46, v47
    v_mfma_f32_16x16x32_bf16 v[164:167], v[52:55], a[24:27], v[164:167]
    ds_read_b128 v[72:75], v13 offset:53248
    v_exp_f32 v50, v158
    v_mfma_f32_16x16x32_bf16 v[172:175], v[56:59], a[24:27], v[172:175]
    v_exp_f32 v51, v159
    v_mfma_f32_16x16x32_bf16 v[168:171], v[56:59], a[8:11], v[168:171]
    s_nop 0
    s_waitcnt lgkmcnt(2)
    v_mfma_f32_16x16x32_bf16 v[176:179], v[60:63], a[8:11], v[176:179]
    ds_read_b128 v[76:79], v13 offset:57344
    v_cvt_pk_bf16_f32 v110, v48, v49
    v_mfma_f32_16x16x32_bf16 v[180:183], v[60:63], a[24:27], v[180:183]
    ds_read_b128 v[80:83], v13 offset:61440
    v_cvt_pk_bf16_f32 v111, v50, v51
    v_mfma_f32_16x16x32_bf16 v[188:191], v[64:67], a[24:27], v[188:191]
    v_mfma_f32_16x16x32_bf16 v[184:187], v[64:67], a[8:11], v[184:187]
    s_waitcnt lgkmcnt(2)
    v_mfma_f32_16x16x32_bf16 v[160:163], v[68:71], a[12:15], v[160:163]
    v_mfma_f32_16x16x32_bf16 v[88:91], v[84:87], v[104:107], v[88:91]
    v_mfma_f32_16x16x32_bf16 v[164:167], v[68:71], a[28:31], v[164:167]
    v_mfma_f32_16x16x32_bf16 v[92:95], v[84:87], v[108:111], v[92:95]
    v_mfma_f32_16x16x32_bf16 v[172:175], v[72:75], a[28:31], v[172:175]
    s_waitcnt vmcnt(4) lgkmcnt(0)
    s_barrier
    ds_read_b64_tr_b16 v[52:53], v14 offset:32768
    ds_read_b64_tr_b16 v[54:55], v14 offset:36864
    v_mfma_f32_16x16x32_bf16 v[168:171], v[72:75], a[12:15], v[168:171]
    ds_read_b64_tr_b16 v[56:57], v15 offset:32768
    ds_read_b64_tr_b16 v[58:59], v15 offset:36864
    v_mfma_f32_16x16x32_bf16 v[176:179], v[76:79], a[12:15], v[176:179]
    ds_read_b64_tr_b16 v[60:61], v16 offset:32768
    ds_read_b64_tr_b16 v[62:63], v16 offset:36864
    v_mfma_f32_16x16x32_bf16 v[180:183], v[76:79], a[28:31], v[180:183]
    ds_read_b64_tr_b16 v[64:65], v17 offset:32768
    ds_read_b64_tr_b16 v[66:67], v17 offset:36864
    v_mfma_f32_16x16x32_bf16 v[188:191], v[80:83], a[28:31], v[188:191]
    v_max_f32 v32, v88, v92
    v_mfma_f32_16x16x32_bf16 v[184:187], v[80:83], a[12:15], v[184:187]
    v_cmp_lt_f32 vcc, 0x45800000, v32
    s_cbranch_vccnz L_trE1
L_Eret1:
    s_waitcnt lgkmcnt(4)
    v_mfma_f32_16x16x32_bf16 v[192:195], v[52:55], v[96:99], v[192:195]
    ds_read_b64_tr_b16 v[68:69], v18 offset:32768
    ds_read_b64_tr_b16 v[70:71], v18 offset:36864
    v_exp_f32 v44, v160
    v_exp_f32 v45, v161
    v_mfma_f32_16x16x32_bf16 v[196:199], v[52:55], v[100:103], v[196:199]
    ds_read_b64_tr_b16 v[72:73], v19 offset:32768
    ds_read_b64_tr_b16 v[74:75], v19 offset:36864
    v_exp_f32 v46, v162
    v_exp_f32 v47, v163
    v_mfma_f32_16x16x32_bf16 v[204:207], v[56:59], v[100:103], v[204:207]
    v_exp_f32 v48, v164
    v_add_f32 v28, v28, v88
    v_mfma_f32_16x16x32_bf16 v[200:203], v[56:59], v[96:99], v[200:203]
    v_cvt_pk_bf16_f32 v112, v44, v45
    v_exp_f32 v49, v165
    v_add_f32 v29, v29, v92
    s_waitcnt lgkmcnt(4)
    v_mfma_f32_16x16x32_bf16 v[208:211], v[60:63], v[96:99], v[208:211]
    ds_read_b64_tr_b16 v[76:77], v20 offset:32768
    ds_read_b64_tr_b16 v[78:79], v20 offset:36864
    v_cvt_pk_bf16_f32 v113, v46, v47
    v_exp_f32 v50, v166
    v_mfma_f32_16x16x32_bf16 v[212:215], v[60:63], v[100:103], v[212:215]
    ds_read_b64_tr_b16 v[80:81], v21 offset:32768
    ds_read_b64_tr_b16 v[82:83], v21 offset:36864
    v_exp_f32 v51, v167
    v_mfma_f32_16x16x32_bf16 v[220:223], v[64:67], v[100:103], v[220:223]
    v_exp_f32 v44, v168
    v_cvt_pk_bf16_f32 v116, v48, v49
    v_mfma_f32_16x16x32_bf16 v[216:219], v[64:67], v[96:99], v[216:219]
    v_exp_f32 v45, v169
    v_cvt_pk_bf16_f32 v117, v50, v51
    s_waitcnt lgkmcnt(4)
    v_mfma_f32_16x16x32_bf16 v[224:227], v[68:71], v[96:99], v[224:227]
    ds_read_b64_tr_b16 v[52:53], v14 offset:40960
    ds_read_b64_tr_b16 v[54:55], v14 offset:45056
    v_exp_f32 v46, v170
    v_mfma_f32_16x16x32_bf16 v[228:231], v[68:71], v[100:103], v[228:231]
    ds_read_b64_tr_b16 v[56:57], v15 offset:40960
    ds_read_b64_tr_b16 v[58:59], v15 offset:45056
    v_exp_f32 v47, v171
    v_exp_f32 v48, v172
    v_mfma_f32_16x16x32_bf16 v[236:239], v[72:75], v[100:103], v[236:239]
    v_cvt_pk_bf16_f32 v114, v44, v45
    v_mfma_f32_16x16x32_bf16 v[232:235], v[72:75], v[96:99], v[232:235]
    v_exp_f32 v49, v173
    v_cvt_pk_bf16_f32 v115, v46, v47
    s_waitcnt lgkmcnt(4)
    v_mfma_f32_16x16x32_bf16 v[240:243], v[76:79], v[96:99], v[240:243]
    ds_read_b64_tr_b16 v[60:61], v16 offset:40960
    ds_read_b64_tr_b16 v[62:63], v16 offset:45056
    v_exp_f32 v50, v174
    v_exp_f32 v51, v175
    v_mfma_f32_16x16x32_bf16 v[244:247], v[76:79], v[100:103], v[244:247]
    ds_read_b64_tr_b16 v[64:65], v17 offset:40960
    ds_read_b64_tr_b16 v[66:67], v17 offset:45056
    v_exp_f32 v44, v176
    v_mfma_f32_16x16x32_bf16 v[252:255], v[80:83], v[100:103], v[252:255]
    v_cvt_pk_bf16_f32 v118, v48, v49
    v_exp_f32 v45, v177
    v_mfma_f32_16x16x32_bf16 v[248:251], v[80:83], v[96:99], v[248:251]
    v_cvt_pk_bf16_f32 v119, v50, v51
    v_exp_f32 v46, v178
    s_waitcnt lgkmcnt(4)
    v_mfma_f32_16x16x32_bf16 v[192:195], v[52:55], v[104:107], v[192:195]
    ds_read_b64_tr_b16 v[68:69], v18 offset:40960
    ds_read_b64_tr_b16 v[70:71], v18 offset:45056
    v_exp_f32 v47, v179
    v_mfma_f32_16x16x32_bf16 v[196:199], v[52:55], v[108:111], v[196:199]
    ds_read_b64_tr_b16 v[72:73], v19 offset:40960
    ds_read_b64_tr_b16 v[74:75], v19 offset:45056
    v_exp_f32 v48, v180
    v_cvt_pk_bf16_f32 v120, v44, v45
    v_mfma_f32_16x16x32_bf16 v[204:207], v[56:59], v[108:111], v[204:207]
    v_exp_f32 v49, v181
    v_cvt_pk_bf16_f32 v121, v46, v47
    v_mfma_f32_16x16x32_bf16 v[200:203], v[56:59], v[104:107], v[200:203]
    v_exp_f32 v50, v182
    s_waitcnt lgkmcnt(4)
    v_mfma_f32_16x16x32_bf16 v[208:211], v[60:63], v[104:107], v[208:211]
    ds_read_b64_tr_b16 v[76:77], v20 offset:40960
    ds_read_b64_tr_b16 v[78:79], v20 offset:45056
    v_exp_f32 v51, v183
    v_exp_f32 v44, v184
    v_mfma_f32_16x16x32_bf16 v[88:91], v[84:87], v[112:115], 0
    v_mfma_f32_16x16x32_bf16 v[212:215], v[60:63], v[108:111], v[212:215]
    ds_read_b64_tr_b16 v[80:81], v21 offset:40960
    ds_read_b64_tr_b16 v[82:83], v21 offset:45056
    v_cvt_pk_bf16_f32 v124, v48, v49
    v_mfma_f32_16x16x32_bf16 v[92:95], v[84:87], v[116:119], 0
    v_mfma_f32_16x16x32_bf16 v[220:223], v[64:67], v[108:111], v[220:223]
    v_exp_f32 v45, v185
    v_cvt_pk_bf16_f32 v125, v50, v51
    v_mfma_f32_16x16x32_bf16 v[216:219], v[64:67], v[104:107], v[216:219]
    v_exp_f32 v46, v186
    v_exp_f32 v47, v187
    s_waitcnt lgkmcnt(4)
    v_mfma_f32_16x16x32_bf16 v[224:227], v[68:71], v[104:107], v[224:227]
    v_exp_f32 v48, v188
    v_mfma_f32_16x16x32_bf16 v[228:231], v[68:71], v[108:111], v[228:231]
    v_cvt_pk_bf16_f32 v122, v44, v45
    v_exp_f32 v49, v189
    v_mfma_f32_16x16x32_bf16 v[236:239], v[72:75], v[108:111], v[236:239]
    v_cvt_pk_bf16_f32 v123, v46, v47
    v_exp_f32 v50, v190
    v_mfma_f32_16x16x32_bf16 v[232:235], v[72:75], v[104:107], v[232:235]
    v_exp_f32 v51, v191
    s_waitcnt lgkmcnt(0)
    v_mfma_f32_16x16x32_bf16 v[240:243], v[76:79], v[104:107], v[240:243]
    s_nop 0
    v_cvt_pk_bf16_f32 v126, v48, v49
    v_mfma_f32_16x16x32_bf16 v[244:247], v[76:79], v[108:111], v[244:247]
    v_cvt_pk_bf16_f32 v127, v50, v51
    v_mfma_f32_16x16x32_bf16 v[252:255], v[80:83], v[108:111], v[252:255]
    v_mfma_f32_16x16x32_bf16 v[248:251], v[80:83], v[104:107], v[248:251]
    v_mfma_f32_16x16x32_bf16 v[88:91], v[84:87], v[120:123], v[88:91]
    v_mfma_f32_16x16x32_bf16 v[92:95], v[84:87], v[124:127], v[92:95]
    s_waitcnt vmcnt(0) lgkmcnt(0)
    s_barrier
    ds_read_b64_tr_b16 v[52:53], v18 offset:49152
    ds_read_b64_tr_b16 v[54:55], v18 offset:53248
    ds_read_b64_tr_b16 v[56:57], v19 offset:49152
    ds_read_b64_tr_b16 v[58:59], v19 offset:53248
    ds_read_b64_tr_b16 v[60:61], v20 offset:49152
    ds_read_b64_tr_b16 v[62:63], v20 offset:53248
    ds_read_b64_tr_b16 v[64:65], v21 offset:49152
    ds_read_b64_tr_b16 v[66:67], v21 offset:53248
    v_max_f32 v32, v88, v92
    v_cmp_lt_f32 vcc, 0x45800000, v32
    s_cbranch_vccnz L_trE2
L_Eret2:
    s_waitcnt lgkmcnt(4)
    v_mfma_f32_16x16x32_bf16 v[224:227], v[52:55], v[112:115], v[224:227]
    ds_read_b64_tr_b16 v[68:69], v18 offset:57344
    ds_read_b64_tr_b16 v[70:71], v18 offset:61440
    v_mfma_f32_16x16x32_bf16 v[228:231], v[52:55], v[116:119], v[228:231]
    ds_read_b64_tr_b16 v[72:73], v19 offset:57344
    ds_read_b64_tr_b16 v[74:75], v19 offset:61440
    v_mfma_f32_16x16x32_bf16 v[236:239], v[56:59], v[116:119], v[236:239]
    v_add_f32 v28, v28, v88
    v_add_f32 v29, v29, v92
    v_lshlrev_b32 v9, 4, v1
    v_mov_b32 v4, 0
    v_mfma_f32_16x16x32_bf16 v[232:235], v[56:59], v[112:115], v[232:235]
    s_mov_b64 exec, 1
    buffer_atomic_add v4, off, s[16:19], s83 sc0 sc1
    s_mov_b64 exec, -1
    s_waitcnt lgkmcnt(4)
    v_mfma_f32_16x16x32_bf16 v[240:243], v[60:63], v[112:115], v[240:243]
    ds_read_b64_tr_b16 v[76:77], v20 offset:57344
    ds_read_b64_tr_b16 v[78:79], v20 offset:61440
    v_mfma_f32_16x16x32_bf16 v[244:247], v[60:63], v[116:119], v[244:247]
    ds_read_b64_tr_b16 v[80:81], v21 offset:57344
    ds_read_b64_tr_b16 v[82:83], v21 offset:61440
    v_mfma_f32_16x16x32_bf16 v[252:255], v[64:67], v[116:119], v[252:255]
    v_mfma_f32_16x16x32_bf16 v[248:251], v[64:67], v[112:115], v[248:251]
    s_waitcnt lgkmcnt(4)
    v_mfma_f32_16x16x32_bf16 v[224:227], v[68:71], v[120:123], v[224:227]
    ds_read_b64_tr_b16 v[52:53], v14 offset:49152
    ds_read_b64_tr_b16 v[54:55], v14 offset:53248
    v_mfma_f32_16x16x32_bf16 v[228:231], v[68:71], v[124:127], v[228:231]
    ds_read_b64_tr_b16 v[56:57], v15 offset:49152
    ds_read_b64_tr_b16 v[58:59], v15 offset:53248
    s_mov_b32 vcc_lo, 0xffff0000
    s_mov_b32 vcc_hi, 0xffff0000
    v_mfma_f32_16x16x32_bf16 v[236:239], v[72:75], v[124:127], v[236:239]
    v_cndmask_b32 v160, v36, v40, vcc
    v_cndmask_b32 v161, v28, v29, vcc
    v_mfma_f32_16x16x32_bf16 v[232:235], v[72:75], v[120:123], v[232:235]
    v_xad_u32 v162, v160, s46, v161
    s_add_u32 s7, s48, 4096
    v_mov_b32 v5, s46
    s_waitcnt lgkmcnt(4)
    v_mfma_f32_16x16x32_bf16 v[240:243], v[76:79], v[120:123], v[240:243]
    ds_read_b64_tr_b16 v[60:61], v16 offset:49152
    ds_read_b64_tr_b16 v[62:63], v16 offset:53248
    v_mfma_f32_16x16x32_bf16 v[244:247], v[76:79], v[124:127], v[244:247]
    ds_read_b64_tr_b16 v[64:65], v17 offset:49152
    ds_read_b64_tr_b16 v[66:67], v17 offset:53248
    s_mov_b64 exec, 1
    buffer_store_dword v5, off, s[16:19], s59 sc1
    s_mov_b64 exec, -1
    v_mfma_f32_16x16x32_bf16 v[252:255], v[80:83], v[124:127], v[252:255]
    v_mfma_f32_16x16x32_bf16 v[248:251], v[80:83], v[120:123], v[248:251]
    s_waitcnt lgkmcnt(4)
    v_mfma_f32_16x16x32_bf16 v[192:195], v[52:55], v[112:115], v[192:195]
    ds_read_b64_tr_b16 v[68:69], v14 offset:57344
    ds_read_b64_tr_b16 v[70:71], v14 offset:61440
    v_cvt_pk_bf16_f32 v164, v224, v225
    v_cvt_pk_bf16_f32 v165, v226, v227
    v_cvt_pk_bf16_f32 v166, v232, v233
    v_mfma_f32_16x16x32_bf16 v[196:199], v[52:55], v[116:119], v[196:199]
    ds_read_b64_tr_b16 v[72:73], v15 offset:57344
    ds_read_b64_tr_b16 v[74:75], v15 offset:61440
    v_cvt_pk_bf16_f32 v167, v234, v235
    buffer_store_dwordx4 v[164:167], v9, s[16:19], s48 offen offset:1024 sc1
    v_xad_u32 v162, v162, v164, v165
    v_xad_u32 v162, v162, v166, v167
    v_mfma_f32_16x16x32_bf16 v[204:207], v[56:59], v[116:119], v[204:207]
    v_cvt_pk_bf16_f32 v168, v228, v229
    v_cvt_pk_bf16_f32 v169, v230, v231
    v_cvt_pk_bf16_f32 v170, v236, v237
    v_mfma_f32_16x16x32_bf16 v[200:203], v[56:59], v[112:115], v[200:203]
    v_cvt_pk_bf16_f32 v171, v238, v239
    buffer_store_dwordx4 v[168:171], v9, s[16:19], s48 offen offset:2048 sc1
    v_xad_u32 v162, v162, v168, v169
    v_xad_u32 v162, v162, v170, v171
    s_waitcnt lgkmcnt(4)
    v_mfma_f32_16x16x32_bf16 v[208:211], v[60:63], v[112:115], v[208:211]
    ds_read_b64_tr_b16 v[76:77], v16 offset:57344
    ds_read_b64_tr_b16 v[78:79], v16 offset:61440
    v_cvt_pk_bf16_f32 v172, v240, v241
    v_cvt_pk_bf16_f32 v173, v242, v243
    v_cvt_pk_bf16_f32 v174, v248, v249
    v_mfma_f32_16x16x32_bf16 v[212:215], v[60:63], v[116:119], v[212:215]
    ds_read_b64_tr_b16 v[80:81], v17 offset:57344
    ds_read_b64_tr_b16 v[82:83], v17 offset:61440
    v_cvt_pk_bf16_f32 v175, v250, v251
    buffer_store_dwordx4 v[172:175], v9, s[16:19], s48 offen offset:3072 sc1
    v_xad_u32 v162, v162, v172, v173
    v_xad_u32 v162, v162, v174, v175
    v_mfma_f32_16x16x32_bf16 v[220:223], v[64:67], v[116:119], v[220:223]
    v_cvt_pk_bf16_f32 v176, v244, v245
    v_cvt_pk_bf16_f32 v177, v246, v247
    v_cvt_pk_bf16_f32 v178, v252, v253
    v_mfma_f32_16x16x32_bf16 v[216:219], v[64:67], v[112:115], v[216:219]
    v_cvt_pk_bf16_f32 v179, v254, v255
    buffer_store_dwordx4 v[176:179], v9, s[16:19], s7 offen offset:0 sc1
    v_xad_u32 v162, v162, v176, v177
    v_xad_u32 v162, v162, v178, v179
    s_waitcnt lgkmcnt(4)
    v_mfma_f32_16x16x32_bf16 v[192:195], v[68:71], v[120:123], v[192:195]
    v_mfma_f32_16x16x32_bf16 v[196:199], v[68:71], v[124:127], v[196:199]
    buffer_store_dwordx4 v[160:163], v9, s[16:19], s48 offen offset:0 sc1
    v_mfma_f32_16x16x32_bf16 v[204:207], v[72:75], v[124:127], v[204:207]
    v_mfma_f32_16x16x32_bf16 v[200:203], v[72:75], v[120:123], v[200:203]
    s_waitcnt lgkmcnt(0)
    v_mfma_f32_16x16x32_bf16 v[208:211], v[76:79], v[120:123], v[208:211]
    v_mfma_f32_16x16x32_bf16 v[212:215], v[76:79], v[124:127], v[212:215]
    v_mfma_f32_16x16x32_bf16 v[220:223], v[80:83], v[124:127], v[220:223]
    v_mfma_f32_16x16x32_bf16 v[216:219], v[80:83], v[120:123], v[216:219]
L_exit:
    s_mov_b64 exec, 1
    s_mov_b32 s4, 0
    s_waitcnt vmcnt(6)
    v_cmp_ne_u32 vcc, s46, v4
    s_mov_b64 exec, -1
    s_cbranch_vccnz L_xlate
    buffer_load_dwordx4 v[96:99], v9, s[16:19], s49 offen offset:0 sc1
    buffer_load_dwordx4 v[100:103], v9, s[16:19], s49 offen offset:1024 sc1
    buffer_load_dwordx4 v[104:107], v9, s[16:19], s49 offen offset:2048 sc1
    buffer_load_dwordx4 v[108:111], v9, s[16:19], s49 offen offset:3072 sc1
    s_add_u32 s6, s49, 4096
    buffer_load_dwordx4 v[112:115], v9, s[16:19], s6 offen offset:0 sc1
    v_add_u32 v7, s86, v14
    ds_read_b64_tr_b16 v[52:53], v7 offset:4096
    ds_read_b64_tr_b16 v[54:55], v7 offset:0
    v_add_u32 v7, s86, v15
    ds_read_b64_tr_b16 v[56:57], v7 offset:4096
    ds_read_b64_tr_b16 v[58:59], v7 offset:0
    v_add_u32 v7, s86, v16
    ds_read_b64_tr_b16 v[60:61], v7 offset:4096
    ds_read_b64_tr_b16 v[62:63], v7 offset:0
    v_add_u32 v7, s86, v17
    ds_read_b64_tr_b16 v[64:65], v7 offset:4096
    ds_read_b64_tr_b16 v[66:67], v7 offset:0
    v_add_u32 v7, s86, v18
    ds_read_b64_tr_b16 v[68:69], v7 offset:4096
    ds_read_b64_tr_b16 v[70:71], v7 offset:0
    v_add_u32 v7, s86, v19
    ds_read_b64_tr_b16 v[72:73], v7 offset:4096
    ds_read_b64_tr_b16 v[74:75], v7 offset:0
    v_add_u32 v7, s86, v20
    ds_read_b64_tr_b16 v[76:77], v7 offset:4096
    ds_read_b64_tr_b16 v[78:79], v7 offset:0
    v_add_u32 v7, s86, v21
    ds_read_b64_tr_b16 v[80:81], v7 offset:4096
    ds_read_b64_tr_b16 v[82:83], v7 offset:0
    s_branch L_ximp
L_xlate:
    v_add_u32 v7, s86, v14
    ds_read_b64_tr_b16 v[52:53], v7 offset:4096
    ds_read_b64_tr_b16 v[54:55], v7 offset:0
    v_add_u32 v7, s86, v15
    ds_read_b64_tr_b16 v[56:57], v7 offset:4096
    ds_read_b64_tr_b16 v[58:59], v7 offset:0
    v_add_u32 v7, s86, v16
    ds_read_b64_tr_b16 v[60:61], v7 offset:4096
    ds_read_b64_tr_b16 v[62:63], v7 offset:0
    v_add_u32 v7, s86, v17
    ds_read_b64_tr_b16 v[64:65], v7 offset:4096
    ds_read_b64_tr_b16 v[66:67], v7 offset:0
    v_add_u32 v7, s86, v18
    ds_read_b64_tr_b16 v[68:69], v7 offset:4096
    ds_read_b64_tr_b16 v[70:71], v7 offset:0
    v_add_u32 v7, s86, v19
    ds_read_b64_tr_b16 v[72:73], v7 offset:4096
    ds_read_b64_tr_b16 v[74:75], v7 offset:0
    v_add_u32 v7, s86, v20
    ds_read_b64_tr_b16 v[76:77], v7 offset:4096
    ds_read_b64_tr_b16 v[78:79], v7 offset:0
    v_add_u32 v7, s86, v21
    ds_read_b64_tr_b16 v[80:81], v7 offset:4096
    ds_read_b64_tr_b16 v[82:83], v7 offset:0
    s_mov_b64 exec, 1
L_xpoll:
    v_mov_b32 v4, 0
    buffer_atomic_add v4, off, s[16:19], s83 sc0 sc1
    s_add_u32 s4, s4, 1
    s_cmp_lt_u32 s4, 400000
    s_waitcnt vmcnt(0)
    v_cmp_ne_u32 vcc, s46, v4
    s_cbranch_vccz L_xseen
    s_cbranch_scc1 L_xpoll
L_xseen:
    s_mov_b64 exec, -1
L_xagain:
    buffer_load_dwordx4 v[96:99], v9, s[16:19], s49 offen offset:0 sc1
    buffer_load_dwordx4 v[100:103], v9, s[16:19], s49 offen offset:1024 sc1
    buffer_load_dwordx4 v[104:107], v9, s[16:19], s49 offen offset:2048 sc1
    buffer_load_dwordx4 v[108:111], v9, s[16:19], s49 offen offset:3072 sc1
    s_add_u32 s6, s49, 4096
    buffer_load_dwordx4 v[112:115], v9, s[16:19], s6 offen offset:0 sc1
L_ximp:
    v_add_u32 v6, s42, v9
    s_add_u32 s4, s4, 1
    s_cmp_lt_u32 s4, 400000
    s_waitcnt vmcnt(4)
    v_xad_u32 v32, v96, s46, v97
    s_waitcnt vmcnt(3)
    v_xad_u32 v32, v32, v100, v101
    v_xad_u32 v32, v32, v102, v103
    s_waitcnt vmcnt(2)
    v_xad_u32 v32, v32, v104, v105
    v_xad_u32 v32, v32, v106, v107
    s_waitcnt vmcnt(1)
    v_xad_u32 v32, v32, v108, v109
    v_xad_u32 v32, v32, v110, v111
    s_waitcnt vmcnt(0)
    v_xad_u32 v32, v32, v112, v113
    v_xad_u32 v32, v32, v114, v115
    v_cmp_ne_u32 vcc, v32, v98
    v_mov_b32 v98, v97
    v_mov_b32 v99, v97
    v_mov_b32 v97, v96
    s_cbranch_vccz L_xok
    s_cbranch_scc1 L_xagain
L_xok:
    v_permlane16_swap_b32 v98, v99
    v_permlane16_swap_b32 v96, v97
    v_min_f32 v37, v36, v96
    v_sub_f32 v36, v37, v36
    v_sub_f32 v96, v37, v96
    v_min_f32 v41, v40, v97
    v_sub_f32 v40, v41, v40
    v_sub_f32 v97, v41, v97
    v_exp_f32 v36, v36
    v_exp_f32 v96, v96
    v_exp_f32 v40, v40
    v_exp_f32 v97, v97
    s_nop 0
    v_mul_f32 v98, v98, v96
    v_fma_f32 v37, v28, v36, v98
    v_mul_f32 v99, v99, v97
    v_fma_f32 v41, v29, v40, v99
    v_rcp_f32 v37, v37
    v_rcp_f32 v41, v41
    s_nop 0
    v_mul_f32 v46, v36, v37
    v_mul_f32 v47, v96, v37
    v_mul_f32 v48, v40, v41
    v_mul_f32 v49, v97, v41
    v_lshlrev_b32 v32, 16, v100
    v_and_b32 v33, 0xffff0000, v100
    v_pk_mul_f32 v[32:33], v[32:33], v[46:47] op_sel:[0,1] op_sel_hi:[1,1]
    v_pk_fma_f32 v[32:33], v[192:193], v[46:47], v[32:33] op_sel:[0,0,0] op_sel_hi:[1,0,1]
    v_cvt_pk_bf16_f32 v128, v32, v33
    v_lshlrev_b32 v44, 16, v101
    v_and_b32 v45, 0xffff0000, v101
    v_pk_mul_f32 v[44:45], v[44:45], v[46:47] op_sel:[0,1] op_sel_hi:[1,1]
    v_pk_fma_f32 v[44:45], v[194:195], v[46:47], v[44:45] op_sel:[0,0,0] op_sel_hi:[1,0,1]
    v_cvt_pk_bf16_f32 v129, v44, v45
    v_lshlrev_b32 v32, 16, v102
    v_and_b32 v33, 0xffff0000, v102
    v_pk_mul_f32 v[32:33], v[32:33], v[46:47] op_sel:[0,1] op_sel_hi:[1,1]
    v_pk_fma_f32 v[32:33], v[200:201], v[46:47], v[32:33] op_sel:[0,0,0] op_sel_hi:[1,0,1]
    v_cvt_pk_bf16_f32 v130, v32, v33
    v_lshlrev_b32 v44, 16, v103
    v_and_b32 v45, 0xffff0000, v103
    v_pk_mul_f32 v[44:45], v[44:45], v[46:47] op_sel:[0,1] op_sel_hi:[1,1]
    v_pk_fma_f32 v[44:45], v[202:203], v[46:47], v[44:45] op_sel:[0,0,0] op_sel_hi:[1,0,1]
    v_cvt_pk_bf16_f32 v131, v44, v45
    ds_write_b128 v6, v[128:131] offset:0
    v_lshlrev_b32 v32, 16, v104
    v_and_b32 v33, 0xffff0000, v104
    v_pk_mul_f32 v[32:33], v[32:33], v[48:49] op_sel:[0,1] op_sel_hi:[1,1]
    v_pk_fma_f32 v[32:33], v[196:197], v[48:49], v[32:33] op_sel:[0,0,0] op_sel_hi:[1,0,1]
    v_cvt_pk_bf16_f32 v132, v32, v33
    v_lshlrev_b32 v44, 16, v105
    v_and_b32 v45, 0xffff0000, v105
    v_pk_mul_f32 v[44:45], v[44:45], v[48:49] op_sel:[0,1] op_sel_hi:[1,1]
    v_pk_fma_f32 v[44:45], v[198:199], v[48:49], v[44:45] op_sel:[0,0,0] op_sel_hi:[1,0,1]
    v_cvt_pk_bf16_f32 v133, v44, v45
    v_lshlrev_b32 v32, 16, v106
    v_and_b32 v33, 0xffff0000, v106
    v_pk_mul_f32 v[32:33], v[32:33], v[48:49] op_sel:[0,1] op_sel_hi:[1,1]
    v_pk_fma_f32 v[32:33], v[204:205], v[48:49], v[32:33] op_sel:[0,0,0] op_sel_hi:[1,0,1]
    v_cvt_pk_bf16_f32 v134, v32, v33
    v_lshlrev_b32 v44, 16, v107
    v_and_b32 v45, 0xffff0000, v107
    v_pk_mul_f32 v[44:45], v[44:45], v[48:49] op_sel:[0,1] op_sel_hi:[1,1]
    v_pk_fma_f32 v[44:45], v[206:207], v[48:49], v[44:45] op_sel:[0,0,0] op_sel_hi:[1,0,1]
    v_cvt_pk_bf16_f32 v135, v44, v45
    ds_write_b128 v6, v[132:135] offset:1024
    v_lshlrev_b32 v32, 16, v108
    v_and_b32 v33, 0xffff0000, v108
    v_pk_mul_f32 v[32:33], v[32:33], v[46:47] op_sel:[0,1] op_sel_hi:[1,1]
    v_pk_fma_f32 v[32:33], v[208:209], v[46:47], v[32:33] op_sel:[0,0,0] op_sel_hi:[1,0,1]
    v_cvt_pk_bf16_f32 v136, v32, v33
    v_lshlrev_b32 v44, 16, v109
    v_and_b32 v45, 0xffff0000, v109
    v_pk_mul_f32 v[44:45], v[44:45], v[46:47] op_sel:[0,1] op_sel_hi:[1,1]
    v_pk_fma_f32 v[44:45], v[210:211], v[46:47], v[44:45] op_sel:[0,0,0] op_sel_hi:[1,0,1]
    v_cvt_pk_bf16_f32 v137, v44, v45
    v_lshlrev_b32 v32, 16, v110
    v_and_b32 v33, 0xffff0000, v110
    v_pk_mul_f32 v[32:33], v[32:33], v[46:47] op_sel:[0,1] op_sel_hi:[1,1]
    v_pk_fma_f32 v[32:33], v[216:217], v[46:47], v[32:33] op_sel:[0,0,0] op_sel_hi:[1,0,1]
    v_cvt_pk_bf16_f32 v138, v32, v33
    v_lshlrev_b32 v44, 16, v111
    v_and_b32 v45, 0xffff0000, v111
    v_pk_mul_f32 v[44:45], v[44:45], v[46:47] op_sel:[0,1] op_sel_hi:[1,1]
    v_pk_fma_f32 v[44:45], v[218:219], v[46:47], v[44:45] op_sel:[0,0,0] op_sel_hi:[1,0,1]
    v_cvt_pk_bf16_f32 v139, v44, v45
    ds_write_b128 v6, v[136:139] offset:2048
    v_lshlrev_b32 v32, 16, v112
    v_and_b32 v33, 0xffff0000, v112
    v_pk_mul_f32 v[32:33], v[32:33], v[48:49] op_sel:[0,1] op_sel_hi:[1,1]
    v_pk_fma_f32 v[32:33], v[212:213], v[48:49], v[32:33] op_sel:[0,0,0] op_sel_hi:[1,0,1]
    v_cvt_pk_bf16_f32 v140, v32, v33
    v_lshlrev_b32 v44, 16, v113
    v_and_b32 v45, 0xffff0000, v113
    v_pk_mul_f32 v[44:45], v[44:45], v[48:49] op_sel:[0,1] op_sel_hi:[1,1]
    v_pk_fma_f32 v[44:45], v[214:215], v[48:49], v[44:45] op_sel:[0,0,0] op_sel_hi:[1,0,1]
    v_cvt_pk_bf16_f32 v141, v44, v45
    v_lshlrev_b32 v32, 16, v114
    v_and_b32 v33, 0xffff0000, v114
    v_pk_mul_f32 v[32:33], v[32:33], v[48:49] op_sel:[0,1] op_sel_hi:[1,1]
    v_pk_fma_f32 v[32:33], v[220:221], v[48:49], v[32:33] op_sel:[0,0,0] op_sel_hi:[1,0,1]
    v_cvt_pk_bf16_f32 v142, v32, v33
    v_lshlrev_b32 v44, 16, v115
    v_and_b32 v45, 0xffff0000, v115
    v_pk_mul_f32 v[44:45], v[44:45], v[48:49] op_sel:[0,1] op_sel_hi:[1,1]
    v_pk_fma_f32 v[44:45], v[222:223], v[48:49], v[44:45] op_sel:[0,0,0] op_sel_hi:[1,0,1]
    v_cvt_pk_bf16_f32 v143, v44, v45
    ds_write_b128 v6, v[140:143] offset:3072
    s_waitcnt lgkmcnt(0)
    s_barrier
    ds_read_b128 v[128:131], v9 offset:0
    ds_read_b128 v[132:135], v9 offset:1024
    ds_read_b128 v[136:139], v9 offset:2048
    ds_read_b128 v[140:143], v9 offset:3072
    ds_read_b128 v[144:147], v9 offset:4096
    ds_read_b128 v[148:151], v9 offset:5120
    ds_read_b128 v[152:155], v9 offset:6144
    ds_read_b128 v[156:159], v9 offset:7168
    ds_read_b128 v[160:163], v9 offset:8192
    ds_read_b128 v[164:167], v9 offset:9216
    ds_read_b128 v[168:171], v9 offset:10240
    ds_read_b128 v[172:175], v9 offset:11264
    ds_read_b128 v[176:179], v9 offset:12288
    ds_read_b128 v[180:183], v9 offset:13312
    ds_read_b128 v[184:187], v9 offset:14336
    ds_read_b128 v[188:191], v9 offset:15360
    s_waitcnt lgkmcnt(15)
    v_mfma_f32_16x16x32_bf16 v[192:195], a[32:35], v[128:131], 0
    s_waitcnt lgkmcnt(14)
    v_mfma_f32_16x16x32_bf16 v[196:199], a[32:35], v[132:135], 0
    v_mfma_f32_16x16x32_bf16 v[200:203], a[36:39], v[128:131], 0
    v_mfma_f32_16x16x32_bf16 v[204:207], a[36:39], v[132:135], 0
    s_waitcnt lgkmcnt(13)
    v_mfma_f32_16x16x32_bf16 v[192:195], a[64:67], v[136:139], v[192:195]
    s_waitcnt lgkmcnt(12)
    v_mfma_f32_16x16x32_bf16 v[196:199], a[64:67], v[140:143], v[196:199]
    v_mfma_f32_16x16x32_bf16 v[200:203], a[68:71], v[136:139], v[200:203]
    v_mfma_f32_16x16x32_bf16 v[204:207], a[68:71], v[140:143], v[204:207]
    s_waitcnt lgkmcnt(11)
    v_mfma_f32_16x16x32_bf16 v[192:195], a[96:99], v[144:147], v[192:195]
    s_waitcnt lgkmcnt(10)
    v_mfma_f32_16x16x32_bf16 v[196:199], a[96:99], v[148:151], v[196:199]
    v_mfma_f32_16x16x32_bf16 v[200:203], a[100:103], v[144:147], v[200:203]
    v_mfma_f32_16x16x32_bf16 v[204:207], a[100:103], v[148:151], v[204:207]
    s_waitcnt lgkmcnt(9)
    v_mfma_f32_16x16x32_bf16 v[192:195], a[128:131], v[152:155], v[192:195]
    s_waitcnt lgkmcnt(8)
    v_mfma_f32_16x16x32_bf16 v[196:199], a[128:131], v[156:159], v[196:199]
    v_mfma_f32_16x16x32_bf16 v[200:203], a[132:135], v[152:155], v[200:203]
    v_mfma_f32_16x16x32_bf16 v[204:207], a[132:135], v[156:159], v[204:207]
    s_waitcnt lgkmcnt(7)
    v_mfma_f32_16x16x32_bf16 v[192:195], a[160:163], v[160:163], v[192:195]
    s_waitcnt lgkmcnt(6)
    v_mfma_f32_16x16x32_bf16 v[196:199], a[160:163], v[164:167], v[196:199]
    v_mfma_f32_16x16x32_bf16 v[200:203], a[164:167], v[160:163], v[200:203]
    v_mfma_f32_16x16x32_bf16 v[204:207], a[164:167], v[164:167], v[204:207]
    s_waitcnt lgkmcnt(5)
    v_mfma_f32_16x16x32_bf16 v[192:195], a[192:195], v[168:171], v[192:195]
    s_waitcnt lgkmcnt(4)
    v_mfma_f32_16x16x32_bf16 v[196:199], a[192:195], v[172:175], v[196:199]
    v_mfma_f32_16x16x32_bf16 v[200:203], a[196:199], v[168:171], v[200:203]
    v_mfma_f32_16x16x32_bf16 v[204:207], a[196:199], v[172:175], v[204:207]
    s_waitcnt lgkmcnt(3)
    v_mfma_f32_16x16x32_bf16 v[192:195], a[224:227], v[176:179], v[192:195]
    s_waitcnt lgkmcnt(2)
    v_mfma_f32_16x16x32_bf16 v[196:199], a[224:227], v[180:183], v[196:199]
    v_mfma_f32_16x16x32_bf16 v[200:203], a[228:231], v[176:179], v[200:203]
    v_mfma_f32_16x16x32_bf16 v[204:207], a[228:231], v[180:183], v[204:207]
    s_waitcnt lgkmcnt(1)
    v_mfma_f32_16x16x32_bf16 v[192:195], v[52:55], v[184:187], v[192:195]
    s_waitcnt lgkmcnt(0)
    v_mfma_f32_16x16x32_bf16 v[196:199], v[52:55], v[188:191], v[196:199]
    v_mfma_f32_16x16x32_bf16 v[200:203], v[56:59], v[184:187], v[200:203]
    v_mfma_f32_16x16x32_bf16 v[204:207], v[56:59], v[188:191], v[204:207]
    v_mfma_f32_16x16x32_bf16 v[208:211], a[40:43], v[128:131], 0
    v_mfma_f32_16x16x32_bf16 v[212:215], a[40:43], v[132:135], 0
    v_mfma_f32_16x16x32_bf16 v[216:219], a[44:47], v[128:131], 0
    v_mfma_f32_16x16x32_bf16 v[220:223], a[44:47], v[132:135], 0
    v_mfma_f32_16x16x32_bf16 v[208:211], a[72:75], v[136:139], v[208:211]
    v_mfma_f32_16x16x32_bf16 v[212:215], a[72:75], v[140:143], v[212:215]
    v_mfma_f32_16x16x32_bf16 v[216:219], a[76:79], v[136:139], v[216:219]
    v_mfma_f32_16x16x32_bf16 v[220:223], a[76:79], v[140:143], v[220:223]
    v_mfma_f32_16x16x32_bf16 v[208:211], a[104:107], v[144:147], v[208:211]
    v_cvt_pk_bf16_f32 v96, v192, v193
    v_mfma_f32_16x16x32_bf16 v[212:215], a[104:107], v[148:151], v[212:215]
    v_mfma_f32_16x16x32_bf16 v[216:219], a[108:111], v[144:147], v[216:219]
    v_cvt_pk_bf16_f32 v97, v194, v195
    v_mfma_f32_16x16x32_bf16 v[220:223], a[108:111], v[148:151], v[220:223]
    v_mfma_f32_16x16x32_bf16 v[208:211], a[136:139], v[152:155], v[208:211]
    v_cvt_pk_bf16_f32 v98, v200, v201
    v_mfma_f32_16x16x32_bf16 v[212:215], a[136:139], v[156:159], v[212:215]
    v_mfma_f32_16x16x32_bf16 v[216:219], a[140:143], v[152:155], v[216:219]
    v_cvt_pk_bf16_f32 v99, v202, v203
    v_mfma_f32_16x16x32_bf16 v[220:223], a[140:143], v[156:159], v[220:223]
    v_mfma_f32_16x16x32_bf16 v[208:211], a[168:171], v[160:163], v[208:211]
    buffer_store_dwordx4 v[96:99], v9, s[16:19], s52 offen offset:0 sc1
    v_mfma_f32_16x16x32_bf16 v[212:215], a[168:171], v[164:167], v[212:215]
    v_mfma_f32_16x16x32_bf16 v[216:219], a[172:175], v[160:163], v[216:219]
    v_cvt_pk_bf16_f32 v100, v196, v197
    v_mfma_f32_16x16x32_bf16 v[220:223], a[172:175], v[164:167], v[220:223]
    v_mfma_f32_16x16x32_bf16 v[208:211], a[200:203], v[168:171], v[208:211]
    v_cvt_pk_bf16_f32 v101, v198, v199
    v_mfma_f32_16x16x32_bf16 v[212:215], a[200:203], v[172:175], v[212:215]
    v_mfma_f32_16x16x32_bf16 v[216:219], a[204:207], v[168:171], v[216:219]
    v_cvt_pk_bf16_f32 v102, v204, v205
    v_mfma_f32_16x16x32_bf16 v[220:223], a[204:207], v[172:175], v[220:223]
    v_mfma_f32_16x16x32_bf16 v[208:211], a[232:235], v[176:179], v[208:211]
    v_cvt_pk_bf16_f32 v103, v206, v207
    v_mfma_f32_16x16x32_bf16 v[212:215], a[232:235], v[180:183], v[212:215]
    v_mfma_f32_16x16x32_bf16 v[216:219], a[236:239], v[176:179], v[216:219]
    buffer_store_dwordx4 v[100:103], v9, s[16:19], s52 offen offset:1024 sc1
    v_mfma_f32_16x16x32_bf16 v[220:223], a[236:239], v[180:183], v[220:223]
    v_mfma_f32_16x16x32_bf16 v[208:211], v[60:63], v[184:187], v[208:211]
    v_mfma_f32_16x16x32_bf16 v[212:215], v[60:63], v[188:191], v[212:215]
    v_mfma_f32_16x16x32_bf16 v[216:219], v[64:67], v[184:187], v[216:219]
    v_mfma_f32_16x16x32_bf16 v[220:223], v[64:67], v[188:191], v[220:223]
    v_mfma_f32_16x16x32_bf16 v[224:227], a[48:51], v[128:131], 0
    v_mfma_f32_16x16x32_bf16 v[228:231], a[48:51], v[132:135], 0
    v_mfma_f32_16x16x32_bf16 v[232:235], a[52:55], v[128:131], 0
    v_mfma_f32_16x16x32_bf16 v[236:239], a[52:55], v[132:135], 0
    v_mfma_f32_16x16x32_bf16 v[224:227], a[80:83], v[136:139], v[224:227]
    v_mfma_f32_16x16x32_bf16 v[228:231], a[80:83], v[140:143], v[228:231]
    v_mfma_f32_16x16x32_bf16 v[232:235], a[84:87], v[136:139], v[232:235]
    v_mfma_f32_16x16x32_bf16 v[236:239], a[84:87], v[140:143], v[236:239]
    v_mfma_f32_16x16x32_bf16 v[224:227], a[112:115], v[144:147], v[224:227]
    v_cvt_pk_bf16_f32 v104, v208, v209
    v_mfma_f32_16x16x32_bf16 v[228:231], a[112:115], v[148:151], v[228:231]
    v_mfma_f32_16x16x32_bf16 v[232:235], a[116:119], v[144:147], v[232:235]
    v_cvt_pk_bf16_f32 v105, v210, v211
    v_mfma_f32_16x16x32_bf16 v[236:239], a[116:119], v[148:151], v[236:239]
    v_mfma_f32_16x16x32_bf16 v[224:227], a[144:147], v[152:155], v[224:227]
    v_cvt_pk_bf16_f32 v106, v216, v217
    v_mfma_f32_16x16x32_bf16 v[228:231], a[144:147], v[156:159], v[228:231]
    v_mfma_f32_16x16x32_bf16 v[232:235], a[148:151], v[152:155], v[232:235]
    v_cvt_pk_bf16_f32 v107, v218, v219
    v_mfma_f32_16x16x32_bf16 v[236:239], a[148:151], v[156:159], v[236:239]
    v_mfma_f32_16x16x32_bf16 v[224:227], a[176:179], v[160:163], v[224:227]
    buffer_store_dwordx4 v[104:107], v9, s[16:19], s53 offen offset:0 sc1
    v_mfma_f32_16x16x32_bf16 v[228:231], a[176:179], v[164:167], v[228:231]
    v_mfma_f32_16x16x32_bf16 v[232:235], a[180:183], v[160:163], v[232:235]
    v_cvt_pk_bf16_f32 v108, v212, v213
    v_mfma_f32_16x16x32_bf16 v[236:239], a[180:183], v[164:167], v[236:239]
    v_mfma_f32_16x16x32_bf16 v[224:227], a[208:211], v[168:171], v[224:227]
    v_cvt_pk_bf16_f32 v109, v214, v215
    v_mfma_f32_16x16x32_bf16 v[228:231], a[208:211], v[172:175], v[228:231]
    v_mfma_f32_16x16x32_bf16 v[232:235], a[212:215], v[168:171], v[232:235]
    v_cvt_pk_bf16_f32 v110, v220, v221
    v_mfma_f32_16x16x32_bf16 v[236:239], a[212:215], v[172:175], v[236:239]
    v_mfma_f32_16x16x32_bf16 v[224:227], a[240:243], v[176:179], v[224:227]
    v_cvt_pk_bf16_f32 v111, v222, v223
    v_mfma_f32_16x16x32_bf16 v[228:231], a[240:243], v[180:183], v[228:231]
    v_mfma_f32_16x16x32_bf16 v[232:235], a[244:247], v[176:179], v[232:235]
    buffer_store_dwordx4 v[108:111], v9, s[16:19], s53 offen offset:1024 sc1
    v_mfma_f32_16x16x32_bf16 v[236:239], a[244:247], v[180:183], v[236:239]
    v_mfma_f32_16x16x32_bf16 v[224:227], v[68:71], v[184:187], v[224:227]
    v_mfma_f32_16x16x32_bf16 v[228:231], v[68:71], v[188:191], v[228:231]
    v_mfma_f32_16x16x32_bf16 v[232:235], v[72:75], v[184:187], v[232:235]
    v_mfma_f32_16x16x32_bf16 v[236:239], v[72:75], v[188:191], v[236:239]
    v_mfma_f32_16x16x32_bf16 v[240:243], a[56:59], v[128:131], 0
    v_mfma_f32_16x16x32_bf16 v[244:247], a[56:59], v[132:135], 0
    v_mfma_f32_16x16x32_bf16 v[248:251], a[60:63], v[128:131], 0
    v_mfma_f32_16x16x32_bf16 v[252:255], a[60:63], v[132:135], 0
    v_mfma_f32_16x16x32_bf16 v[240:243], a[88:91], v[136:139], v[240:243]
    v_mfma_f32_16x16x32_bf16 v[244:247], a[88:91], v[140:143], v[244:247]
    v_mfma_f32_16x16x32_bf16 v[248:251], a[92:95], v[136:139], v[248:251]
    v_mfma_f32_16x16x32_bf16 v[252:255], a[92:95], v[140:143], v[252:255]
    v_mfma_f32_16x16x32_bf16 v[240:243], a[120:123], v[144:147], v[240:243]
    v_cvt_pk_bf16_f32 v96, v224, v225
    v_mfma_f32_16x16x32_bf16 v[244:247], a[120:123], v[148:151], v[244:247]
    v_mfma_f32_16x16x32_bf16 v[248:251], a[124:127], v[144:147], v[248:251]
    v_cvt_pk_bf16_f32 v97, v226, v227
    v_mfma_f32_16x16x32_bf16 v[252:255], a[124:127], v[148:151], v[252:255]
    v_mfma_f32_16x16x32_bf16 v[240:243], a[152:155], v[152:155], v[240:243]
    v_cvt_pk_bf16_f32 v98, v232, v233
    v_mfma_f32_16x16x32_bf16 v[244:247], a[152:155], v[156:159], v[244:247]
    v_mfma_f32_16x16x32_bf16 v[248:251], a[156:159], v[152:155], v[248:251]
    v_cvt_pk_bf16_f32 v99, v234, v235
    v_mfma_f32_16x16x32_bf16 v[252:255], a[156:159], v[156:159], v[252:255]
    v_mfma_f32_16x16x32_bf16 v[240:243], a[184:187], v[160:163], v[240:243]
    buffer_store_dwordx4 v[96:99], v9, s[16:19], s54 offen offset:0 sc1
    v_mfma_f32_16x16x32_bf16 v[244:247], a[184:187], v[164:167], v[244:247]
    v_mfma_f32_16x16x32_bf16 v[248:251], a[188:191], v[160:163], v[248:251]
    v_cvt_pk_bf16_f32 v100, v228, v229
    v_mfma_f32_16x16x32_bf16 v[252:255], a[188:191], v[164:167], v[252:255]
    v_mfma_f32_16x16x32_bf16 v[240:243], a[216:219], v[168:171], v[240:243]
    v_cvt_pk_bf16_f32 v101, v230, v231
    v_mfma_f32_16x16x32_bf16 v[244:247], a[216:219], v[172:175], v[244:247]
    v_mfma_f32_16x16x32_bf16 v[248:251], a[220:223], v[168:171], v[248:251]
    v_cvt_pk_bf16_f32 v102, v236, v237
    v_mfma_f32_16x16x32_bf16 v[252:255], a[220:223], v[172:175], v[252:255]
    v_mfma_f32_16x16x32_bf16 v[240:243], a[248:251], v[176:179], v[240:243]
    v_cvt_pk_bf16_f32 v103, v238, v239
    v_mfma_f32_16x16x32_bf16 v[244:247], a[248:251], v[180:183], v[244:247]
    v_mfma_f32_16x16x32_bf16 v[248:251], a[252:255], v[176:179], v[248:251]
    buffer_store_dwordx4 v[100:103], v9, s[16:19], s54 offen offset:1024 sc1
    v_mfma_f32_16x16x32_bf16 v[252:255], a[252:255], v[180:183], v[252:255]
    v_mfma_f32_16x16x32_bf16 v[240:243], v[76:79], v[184:187], v[240:243]
    v_mfma_f32_16x16x32_bf16 v[244:247], v[76:79], v[188:191], v[244:247]
    v_mfma_f32_16x16x32_bf16 v[248:251], v[80:83], v[184:187], v[248:251]
    v_mfma_f32_16x16x32_bf16 v[252:255], v[80:83], v[188:191], v[252:255]
    s_nop 7
    v_cvt_pk_bf16_f32 v104, v240, v241
    v_cvt_pk_bf16_f32 v105, v242, v243
    v_cvt_pk_bf16_f32 v106, v248, v249
    v_cvt_pk_bf16_f32 v107, v250, v251
    buffer_store_dwordx4 v[104:107], v9, s[16:19], s55 offen offset:0 sc1
    v_cvt_pk_bf16_f32 v108, v244, v245
    v_cvt_pk_bf16_f32 v109, v246, v247
    v_cvt_pk_bf16_f32 v110, v252, v253
    v_cvt_pk_bf16_f32 v111, v254, v255
    buffer_store_dwordx4 v[108:111], v9, s[16:19], s55 offen offset:1024 sc1
    v_and_b32 v6, 31, v1
    v_lshlrev_b32 v6, 4, v6
    v_lshrrev_b32 v7, 5, v1
    v_lshl_add_u32 v6, v7, 14, v6
    v_lshlrev_b32 v3, 9, v3
    v_mov_b32 v5, s46
    s_mov_b64 exec, 1
    s_waitcnt vmcnt(0)
    buffer_store_dword v5, off, s[16:19], s50 sc1
    s_mov_b64 exec, -1
    s_cmp_eq_u32 s36, 0
    s_cbranch_scc0 L_rwait
    s_mov_b32 s4, 0
    s_mov_b64 exec, 0xffff
L_pollR:
    v_mov_b32 v4, 0
    buffer_atomic_add v4, v3, s[16:19], s51 offen sc0 sc1
    s_waitcnt vmcnt(0)
    v_cmp_ne_u32 vcc, s46, v4
    s_cbranch_vccz L_gotR
    s_mov_b64 exec, vcc
    s_add_u32 s4, s4, 1
    s_cmp_lt_u32 s4, 400000
    s_cbranch_scc1 L_pollR
L_gotR:
    s_mov_b64 exec, -1
L_rwait:
    s_barrier
    buffer_load_dwordx4 v[128:131], v6, s[16:19], s56 offen offset:0 sc1
    buffer_load_dwordx4 v[132:135], v6, s[16:19], s56 offen offset:2048 sc1
    s_add_u32 s56, s56, 4096
    buffer_load_dwordx4 v[136:139], v6, s[16:19], s56 offen offset:0 sc1
    buffer_load_dwordx4 v[140:143], v6, s[16:19], s56 offen offset:2048 sc1
    s_add_u32 s56, s56, 4096
    buffer_load_dwordx4 v[144:147], v6, s[16:19], s56 offen offset:0 sc1
    buffer_load_dwordx4 v[148:151], v6, s[16:19], s56 offen offset:2048 sc1
    s_add_u32 s56, s56, 4096
    buffer_load_dwordx4 v[152:155], v6, s[16:19], s56 offen offset:0 sc1
    buffer_load_dwordx4 v[156:159], v6, s[16:19], s56 offen offset:2048 sc1
    s_add_u32 s56, s56, 4096
    v_lshlrev_b32 v3, 1, v3
    v_lshl_add_u32 v3, v7, 5, v3
    v_and_b32 v2, 1, v2
    v_lshl_add_u32 v3, v2, 3, v3
    s_waitcnt vmcnt(7)
    v_lshlrev_b32 v192, 16, v128
    v_and_b32 v193, 0xffff0000, v128
    v_lshlrev_b32 v194, 16, v129
    v_and_b32 v195, 0xffff0000, v129
    v_lshlrev_b32 v196, 16, v130
    v_and_b32 v197, 0xffff0000, v130
    v_lshlrev_b32 v198, 16, v131
    v_and_b32 v199, 0xffff0000, v131
    s_waitcnt vmcnt(6)
    v_lshlrev_b32 v32, 16, v132
    v_and_b32 v33, 0xffff0000, v132
    v_pk_add_f32 v[192:193], v[192:193], v[32:33]
    v_lshlrev_b32 v44, 16, v133
    v_and_b32 v45, 0xffff0000, v133
    v_pk_add_f32 v[194:195], v[194:195], v[44:45]
    v_lshlrev_b32 v32, 16, v134
    v_and_b32 v33, 0xffff0000, v134
    v_pk_add_f32 v[196:197], v[196:197], v[32:33]
    v_lshlrev_b32 v44, 16, v135
    v_and_b32 v45, 0xffff0000, v135
    v_pk_add_f32 v[198:199], v[198:199], v[44:45]
    s_waitcnt vmcnt(5)
    v_lshlrev_b32 v32, 16, v136
    v_and_b32 v33, 0xffff0000, v136
    v_pk_add_f32 v[192:193], v[192:193], v[32:33]
    v_lshlrev_b32 v44, 16, v137
    v_and_b32 v45, 0xffff0000, v137
    v_pk_add_f32 v[194:195], v[194:195], v[44:45]
    v_lshlrev_b32 v32, 16, v138
    v_and_b32 v33, 0xffff0000, v138
    v_pk_add_f32 v[196:197], v[196:197], v[32:33]
    v_lshlrev_b32 v44, 16, v139
    v_and_b32 v45, 0xffff0000, v139
    v_pk_add_f32 v[198:199], v[198:199], v[44:45]
    s_waitcnt vmcnt(4)
    v_lshlrev_b32 v32, 16, v140
    v_and_b32 v33, 0xffff0000, v140
    v_pk_add_f32 v[192:193], v[192:193], v[32:33]
    v_lshlrev_b32 v44, 16, v141
    v_and_b32 v45, 0xffff0000, v141
    v_pk_add_f32 v[194:195], v[194:195], v[44:45]
    v_lshlrev_b32 v32, 16, v142
    v_and_b32 v33, 0xffff0000, v142
    v_pk_add_f32 v[196:197], v[196:197], v[32:33]
    v_lshlrev_b32 v44, 16, v143
    v_and_b32 v45, 0xffff0000, v143
    v_pk_add_f32 v[198:199], v[198:199], v[44:45]
    s_waitcnt vmcnt(3)
    v_lshlrev_b32 v32, 16, v144
    v_and_b32 v33, 0xffff0000, v144
    v_pk_add_f32 v[192:193], v[192:193], v[32:33]
    v_lshlrev_b32 v44, 16, v145
    v_and_b32 v45, 0xffff0000, v145
    v_pk_add_f32 v[194:195], v[194:195], v[44:45]
    v_lshlrev_b32 v32, 16, v146
    v_and_b32 v33, 0xffff0000, v146
    v_pk_add_f32 v[196:197], v[196:197], v[32:33]
    v_lshlrev_b32 v44, 16, v147
    v_and_b32 v45, 0xffff0000, v147
    v_pk_add_f32 v[198:199], v[198:199], v[44:45]
    s_waitcnt vmcnt(2)
    v_lshlrev_b32 v32, 16, v148
    v_and_b32 v33, 0xffff0000, v148
    v_pk_add_f32 v[192:193], v[192:193], v[32:33]
    v_lshlrev_b32 v44, 16, v149
    v_and_b32 v45, 0xffff0000, v149
    v_pk_add_f32 v[194:195], v[194:195], v[44:45]
    v_lshlrev_b32 v32, 16, v150
    v_and_b32 v33, 0xffff0000, v150
    v_pk_add_f32 v[196:197], v[196:197], v[32:33]
    v_lshlrev_b32 v44, 16, v151
    v_and_b32 v45, 0xffff0000, v151
    v_pk_add_f32 v[198:199], v[198:199], v[44:45]
    s_waitcnt vmcnt(1)
    v_lshlrev_b32 v32, 16, v152
    v_and_b32 v33, 0xffff0000, v152
    v_pk_add_f32 v[192:193], v[192:193], v[32:33]
    v_lshlrev_b32 v44, 16, v153
    v_and_b32 v45, 0xffff0000, v153
    v_pk_add_f32 v[194:195], v[194:195], v[44:45]
    v_lshlrev_b32 v32, 16, v154
    v_and_b32 v33, 0xffff0000, v154
    v_pk_add_f32 v[196:197], v[196:197], v[32:33]
    v_lshlrev_b32 v44, 16, v155
    v_and_b32 v45, 0xffff0000, v155
    v_pk_add_f32 v[198:199], v[198:199], v[44:45]
    s_waitcnt vmcnt(0)
    v_lshlrev_b32 v32, 16, v156
    v_and_b32 v33, 0xffff0000, v156
    v_pk_add_f32 v[192:193], v[192:193], v[32:33]
    v_lshlrev_b32 v44, 16, v157
    v_and_b32 v45, 0xffff0000, v157
    v_pk_add_f32 v[194:195], v[194:195], v[44:45]
    v_lshlrev_b32 v32, 16, v158
    v_and_b32 v33, 0xffff0000, v158
    v_pk_add_f32 v[196:197], v[196:197], v[32:33]
    v_lshlrev_b32 v44, 16, v159
    v_and_b32 v45, 0xffff0000, v159
    v_pk_add_f32 v[198:199], v[198:199], v[44:45]
    s_nop 1
    v_permlane32_swap_b32 v192, v196
    v_permlane32_swap_b32 v193, v197
    v_permlane32_swap_b32 v194, v198
    v_permlane32_swap_b32 v195, v199
    v_add_f32 v192, v192, v196
    v_add_f32 v193, v193, v197
    v_add_f32 v194, v194, v198
    v_add_f32 v195, v195, v199
    v_cvt_pk_bf16_f32 v200, v192, v193
    v_cvt_pk_bf16_f32 v201, v194, v195
    buffer_store_dwordx2 v[200:201], v3, s[32:35], s57 offen nt
    s_and_b32 s4, s2, 15
    s_or_b32 s4, s4, s36
    s_cmp_eq_u32 s4, 0
    s_cbranch_scc0 L_nobump
    v_mov_b32 v8, 0
    v_mov_b32 v5, s46
    s_mov_b64 exec, 1
    buffer_store_dword v5, v8, s[16:19], s58 offen sc1
    s_mov_b64 exec, -1
L_nobump:
L_end:
    s_endpgm
L_qgot0:
    buffer_load_dwordx4 a[0:3], v33, s[16:19], s98 offen offset:0 sc1
    buffer_load_dwordx4 a[4:7], v33, s[16:19], s98 offen offset:1024 sc1
    buffer_load_dwordx4 a[8:11], v33, s[16:19], s98 offen offset:2048 sc1
    buffer_load_dwordx4 a[12:15], v33, s[16:19], s98 offen offset:3072 sc1
    buffer_load_dwordx4 a[16:19], v33, s[16:19], s99 offen offset:0 sc1
    buffer_load_dwordx4 a[20:23], v33, s[16:19], s99 offen offset:1024 sc1
    buffer_load_dwordx4 a[24:27], v33, s[16:19], s99 offen offset:2048 sc1
    buffer_load_dwordx4 a[28:31], v33, s[16:19], s99 offen offset:3072 sc1
    s_add_u32 m0, s43, 0
    s_nop 0
    buffer_load_dwordx4 v26, s[12:15], s41 offen offset:0 nt lds
    buffer_load_dwordx4 v27, s[12:15], s41 offen offset:1024 nt lds
    buffer_load_dwordx4 v26, s[12:15], s41 offen offset:2048 nt lds
    buffer_load_dwordx4 v27, s[12:15], s41 offen offset:3072 nt lds
    s_add_u32 s41, s41, 16384
    s_waitcnt vmcnt(4)
    s_branch L_qdone
L_trJ1a:
    s_call_b64 s[90:91], L_rare1
    s_branch L_H0a
L_trH0a:
    s_call_b64 s[90:91], L_rare0
    s_branch L_Hret0a
L_trH1a:
    s_call_b64 s[90:91], L_rare1
    s_branch L_Hret1a
L_trH2a:
    s_call_b64 s[90:91], L_rare0
    s_branch L_Hret2a
L_trH3a:
    s_call_b64 s[90:91], L_rare1
    s_branch L_Hret3a
L_trJ1b:
    s_call_b64 s[90:91], L_rare1
    s_branch L_H0b
L_trH0b:
    s_call_b64 s[90:91], L_rare0
    s_branch L_Hret0b
L_trH1b:
    s_call_b64 s[90:91], L_rare1
    s_branch L_Hret1b
L_trH2b:
    s_call_b64 s[90:91], L_rare0
    s_branch L_Hret2b
L_trH3b:
    s_call_b64 s[90:91], L_rare1
    s_branch L_Hret3b
L_trL0b:
    s_call_b64 s[90:91], L_rare0
    s_branch L_Lret0b
L_trL1b:
    s_call_b64 s[90:91], L_rare1
    s_branch L_Lret1b
L_trL2b:
    s_call_b64 s[90:91], L_rare0
    s_branch L_Lret2b
L_trL3b:
    s_call_b64 s[90:91], L_rare1
    s_branch L_Lret3b
L_trL0a:
    s_call_b64 s[90:91], L_rare0
    s_branch L_Lret0a
L_trL1a:
    s_call_b64 s[90:91], L_rare1
    s_branch L_Lret1a
L_trL2a:
    s_call_b64 s[90:91], L_rare0
    s_branch L_Lret2a
L_trL3a:
    s_call_b64 s[90:91], L_rare1
    s_branch L_Lret3a
L_trE0:
    s_call_b64 s[90:91], L_rare0
    s_branch L_Eret0
L_trE1:
    s_call_b64 s[90:91], L_rare1
    s_branch L_Eret1
L_trE2:
    s_call_b64 s[90:91], L_rare0
    s_branch L_Eret2
L_rare0:
    s_nop 7
    v_max3_f32 v32, v160, v161, v162
    v_max3_f32 v32, v32, v163, v168
    v_max3_f32 v32, v32, v169, v170
    v_max3_f32 v32, v32, v171, v176
    v_max3_f32 v32, v32, v177, v178
    v_max3_f32 v32, v32, v179, v184
    v_max3_f32 v32, v32, v185, v186
    v_max_f32 v32, v32, v187
    v_mov_b32 v33, v32
    s_nop 1
    v_permlane32_swap_b32 v32, v33
    v_max_f32 v32, v32, v33
    v_mov_b32 v33, v32
    s_nop 1
    v_permlane16_swap_b32 v32, v33
    v_max_f32 v32, v32, v33
    v_max_f32 v32, 0, v32
    v_sub_f32 v33, 0, v32
    v_exp_f32 v33, v33
    v_sub_f32 v36, v36, v32
    v_sub_f32 v37, v37, v32
    v_sub_f32 v38, v38, v32
    v_sub_f32 v39, v39, v32
    v_sub_f32 v160, v160, v32
    v_sub_f32 v161, v161, v32
    v_sub_f32 v162, v162, v32
    v_sub_f32 v163, v163, v32
    v_sub_f32 v168, v168, v32
    v_sub_f32 v169, v169, v32
    v_sub_f32 v170, v170, v32
    v_sub_f32 v171, v171, v32
    v_sub_f32 v176, v176, v32
    v_sub_f32 v177, v177, v32
    v_sub_f32 v178, v178, v32
    v_sub_f32 v179, v179, v32
    v_sub_f32 v184, v184, v32
    v_sub_f32 v185, v185, v32
    v_sub_f32 v186, v186, v32
    v_sub_f32 v187, v187, v32
    v_sub_f32 v128, v128, v32
    v_sub_f32 v129, v129, v32
    v_sub_f32 v130, v130, v32
    v_sub_f32 v131, v131, v32
    v_sub_f32 v136, v136, v32
    v_sub_f32 v137, v137, v32
    v_sub_f32 v138, v138, v32
    v_sub_f32 v139, v139, v32
    v_sub_f32 v144, v144, v32
    v_sub_f32 v145, v145, v32
    v_sub_f32 v146, v146, v32
    v_sub_f32 v147, v147, v32
    v_sub_f32 v152, v152, v32
    v_sub_f32 v153, v153, v32
    v_sub_f32 v154, v154, v32
    v_sub_f32 v155, v155, v32
    v_mul_f32 v28, v28, v33
    v_mul_f32 v192, v192, v33
    v_mul_f32 v193, v193, v33
    v_mul_f32 v194, v194, v33
    v_mul_f32 v195, v195, v33
    v_mul_f32 v200, v200, v33
    v_mul_f32 v201, v201, v33
    v_mul_f32 v202, v202, v33
    v_mul_f32 v203, v203, v33
    v_mul_f32 v208, v208, v33
    v_mul_f32 v209, v209, v33
    v_mul_f32 v210, v210, v33
    v_mul_f32 v211, v211, v33
    v_mul_f32 v216, v216, v33
    v_mul_f32 v217, v217, v33
    v_mul_f32 v218, v218, v33
    v_mul_f32 v219, v219, v33
    v_mul_f32 v224, v224, v33
    v_mul_f32 v225, v225, v33
    v_mul_f32 v226, v226, v33
    v_mul_f32 v227, v227, v33
    v_mul_f32 v232, v232, v33
    v_mul_f32 v233, v233, v33
    v_mul_f32 v234, v234, v33
    v_mul_f32 v235, v235, v33
    v_mul_f32 v240, v240, v33
    v_mul_f32 v241, v241, v33
    v_mul_f32 v242, v242, v33
    v_mul_f32 v243, v243, v33
    v_mul_f32 v248, v248, v33
    v_mul_f32 v249, v249, v33
    v_mul_f32 v250, v250, v33
    v_mul_f32 v251, v251, v33
    v_max3_f32 v32, v164, v165, v166
    v_max3_f32 v32, v32, v167, v172
    v_max3_f32 v32, v32, v173, v174
    v_max3_f32 v32, v32, v175, v180
    v_max3_f32 v32, v32, v181, v182
    v_max3_f32 v32, v32, v183, v188
    v_max3_f32 v32, v32, v189, v190
    v_max_f32 v32, v32, v191
    v_mov_b32 v33, v32
    s_nop 1
    v_permlane32_swap_b32 v32, v33
    v_max_f32 v32, v32, v33
    v_mov_b32 v33, v32
    s_nop 1
    v_permlane16_swap_b32 v32, v33
    v_max_f32 v32, v32, v33
    v_max_f32 v32, 0, v32
    v_sub_f32 v33, 0, v32
    v_exp_f32 v33, v33
    v_sub_f32 v40, v40, v32
    v_sub_f32 v41, v41, v32
    v_sub_f32 v42, v42, v32
    v_sub_f32 v43, v43, v32
    v_sub_f32 v164, v164, v32
    v_sub_f32 v165, v165, v32
    v_sub_f32 v166, v166, v32
    v_sub_f32 v167, v167, v32
    v_sub_f32 v172, v172, v32
    v_sub_f32 v173, v173, v32
    v_sub_f32 v174, v174, v32
    v_sub_f32 v175, v175, v32
    v_sub_f32 v180, v180, v32
    v_sub_f32 v181, v181, v32
    v_sub_f32 v182, v182, v32
    v_sub_f32 v183, v183, v32
    v_sub_f32 v188, v188, v32
    v_sub_f32 v189, v189, v32
    v_sub_f32 v190, v190, v32
    v_sub_f32 v191, v191, v32
    v_sub_f32 v132, v132, v32
    v_sub_f32 v133, v133, v32
    v_sub_f32 v134, v134, v32
    v_sub_f32 v135, v135, v32
    v_sub_f32 v140, v140, v32
    v_sub_f32 v141, v141, v32
    v_sub_f32 v142, v142, v32
    v_sub_f32 v143, v143, v32
    v_sub_f32 v148, v148, v32
    v_sub_f32 v149, v149, v32
    v_sub_f32 v150, v150, v32
    v_sub_f32 v151, v151, v32
    v_sub_f32 v156, v156, v32
    v_sub_f32 v157, v157, v32
    v_sub_f32 v158, v158, v32
    v_sub_f32 v159, v159, v32
    v_mul_f32 v29, v29, v33
    v_mul_f32 v196, v196, v33
    v_mul_f32 v197, v197, v33
    v_mul_f32 v198, v198, v33
    v_mul_f32 v199, v199, v33
    v_mul_f32 v204, v204, v33
    v_mul_f32 v205, v205, v33
    v_mul_f32 v206, v206, v33
    v_mul_f32 v207, v207, v33
    v_mul_f32 v212, v212, v33
    v_mul_f32 v213, v213, v33
    v_mul_f32 v214, v214, v33
    v_mul_f32 v215, v215, v33
    v_mul_f32 v220, v220, v33
    v_mul_f32 v221, v221, v33
    v_mul_f32 v222, v222, v33
    v_mul_f32 v223, v223, v33
    v_mul_f32 v228, v228, v33
    v_mul_f32 v229, v229, v33
    v_mul_f32 v230, v230, v33
    v_mul_f32 v231, v231, v33
    v_mul_f32 v236, v236, v33
    v_mul_f32 v237, v237, v33
    v_mul_f32 v238, v238, v33
    v_mul_f32 v239, v239, v33
    v_mul_f32 v244, v244, v33
    v_mul_f32 v245, v245, v33
    v_mul_f32 v246, v246, v33
    v_mul_f32 v247, v247, v33
    v_mul_f32 v252, v252, v33
    v_mul_f32 v253, v253, v33
    v_mul_f32 v254, v254, v33
    v_mul_f32 v255, v255, v33
    v_exp_f32 v44, v160
    v_exp_f32 v45, v161
    v_exp_f32 v46, v162
    v_exp_f32 v47, v163
    v_exp_f32 v48, v164
    v_cvt_pk_bf16_f32 v112, v44, v45
    v_exp_f32 v49, v165
    v_cvt_pk_bf16_f32 v113, v46, v47
    v_exp_f32 v50, v166
    v_exp_f32 v51, v167
    v_exp_f32 v44, v168
    v_cvt_pk_bf16_f32 v116, v48, v49
    v_exp_f32 v45, v169
    v_cvt_pk_bf16_f32 v117, v50, v51
    v_exp_f32 v46, v170
    v_exp_f32 v47, v171
    v_exp_f32 v48, v172
    v_cvt_pk_bf16_f32 v114, v44, v45
    v_exp_f32 v49, v173
    v_cvt_pk_bf16_f32 v115, v46, v47
    v_exp_f32 v50, v174
    v_exp_f32 v51, v175
    v_exp_f32 v44, v176
    v_cvt_pk_bf16_f32 v118, v48, v49
    v_exp_f32 v45, v177
    v_cvt_pk_bf16_f32 v119, v50, v51
    v_exp_f32 v46, v178
    v_exp_f32 v47, v179
    v_exp_f32 v48, v180
    v_cvt_pk_bf16_f32 v120, v44, v45
    v_exp_f32 v49, v181
    v_cvt_pk_bf16_f32 v121, v46, v47
    v_exp_f32 v50, v182
    v_exp_f32 v51, v183
    v_exp_f32 v44, v184
    v_cvt_pk_bf16_f32 v124, v48, v49
    v_exp_f32 v45, v185
    v_cvt_pk_bf16_f32 v125, v50, v51
    v_exp_f32 v46, v186
    v_exp_f32 v47, v187
    v_exp_f32 v48, v188
    v_cvt_pk_bf16_f32 v122, v44, v45
    v_exp_f32 v49, v189
    v_cvt_pk_bf16_f32 v123, v46, v47
    v_exp_f32 v50, v190
    v_exp_f32 v51, v191
    s_nop 0
    v_cvt_pk_bf16_f32 v126, v48, v49
    v_cvt_pk_bf16_f32 v127, v50, v51
    s_nop 1
    v_mfma_f32_16x16x32_bf16 v[88:91], v[84:87], v[112:115], 0
    v_mfma_f32_16x16x32_bf16 v[92:95], v[84:87], v[116:119], 0
    v_mfma_f32_16x16x32_bf16 v[88:91], v[84:87], v[120:123], v[88:91]
    v_mfma_f32_16x16x32_bf16 v[92:95], v[84:87], v[124:127], v[92:95]
    s_nop 7
    s_setpc_b64 s[90:91]
L_rare1:
    s_nop 7
    v_max3_f32 v32, v128, v129, v130
    v_max3_f32 v32, v32, v131, v136
    v_max3_f32 v32, v32, v137, v138
    v_max3_f32 v32, v32, v139, v144
    v_max3_f32 v32, v32, v145, v146
    v_max3_f32 v32, v32, v147, v152
    v_max3_f32 v32, v32, v153, v154
    v_max_f32 v32, v32, v155
    v_mov_b32 v33, v32
    s_nop 1
    v_permlane32_swap_b32 v32, v33
    v_max_f32 v32, v32, v33
    v_mov_b32 v33, v32
    s_nop 1
    v_permlane16_swap_b32 v32, v33
    v_max_f32 v32, v32, v33
    v_max_f32 v32, 0, v32
    v_sub_f32 v33, 0, v32
    v_exp_f32 v33, v33
    v_sub_f32 v36, v36, v32
    v_sub_f32 v37, v37, v32
    v_sub_f32 v38, v38, v32
    v_sub_f32 v39, v39, v32
    v_sub_f32 v128, v128, v32
    v_sub_f32 v129, v129, v32
    v_sub_f32 v130, v130, v32
    v_sub_f32 v131, v131, v32
    v_sub_f32 v136, v136, v32
    v_sub_f32 v137, v137, v32
    v_sub_f32 v138, v138, v32
    v_sub_f32 v139, v139, v32
    v_sub_f32 v144, v144, v32
    v_sub_f32 v145, v145, v32
    v_sub_f32 v146, v146, v32
    v_sub_f32 v147, v147, v32
    v_sub_f32 v152, v152, v32
    v_sub_f32 v153, v153, v32
    v_sub_f32 v154, v154, v32
    v_sub_f32 v155, v155, v32
    v_sub_f32 v160, v160, v32
    v_sub_f32 v161, v161, v32
    v_sub_f32 v162, v162, v32
    v_sub_f32 v163, v163, v32
    v_sub_f32 v168, v168, v32
    v_sub_f32 v169, v169, v32
    v_sub_f32 v170, v170, v32
    v_sub_f32 v171, v171, v32
    v_sub_f32 v176, v176, v32
    v_sub_f32 v177, v177, v32
    v_sub_f32 v178, v178, v32
    v_sub_f32 v179, v179, v32
    v_sub_f32 v184, v184, v32
    v_sub_f32 v185, v185, v32
    v_sub_f32 v186, v186, v32
    v_sub_f32 v187, v187, v32
    v_mul_f32 v28, v28, v33
    v_mul_f32 v192, v192, v33
    v_mul_f32 v193, v193, v33
    v_mul_f32 v194, v194, v33
    v_mul_f32 v195, v195, v33
    v_mul_f32 v200, v200, v33
    v_mul_f32 v201, v201, v33
    v_mul_f32 v202, v202, v33
    v_mul_f32 v203, v203, v33
    v_mul_f32 v208, v208, v33
    v_mul_f32 v209, v209, v33
    v_mul_f32 v210, v210, v33
    v_mul_f32 v211, v211, v33
    v_mul_f32 v216, v216, v33
    v_mul_f32 v217, v217, v33
    v_mul_f32 v218, v218, v33
    v_mul_f32 v219, v219, v33
    v_mul_f32 v224, v224, v33
    v_mul_f32 v225, v225, v33
    v_mul_f32 v226, v226, v33
    v_mul_f32 v227, v227, v33
    v_mul_f32 v232, v232, v33
    v_mul_f32 v233, v233, v33
    v_mul_f32 v234, v234, v33
    v_mul_f32 v235, v235, v33
    v_mul_f32 v240, v240, v33
    v_mul_f32 v241, v241, v33
    v_mul_f32 v242, v242, v33
    v_mul_f32 v243, v243, v33
    v_mul_f32 v248, v248, v33
    v_mul_f32 v249, v249, v33
    v_mul_f32 v250, v250, v33
    v_mul_f32 v251, v251, v33
    v_max3_f32 v32, v132, v133, v134
    v_max3_f32 v32, v32, v135, v140
    v_max3_f32 v32, v32, v141, v142
    v_max3_f32 v32, v32, v143, v148
    v_max3_f32 v32, v32, v149, v150
    v_max3_f32 v32, v32, v151, v156
    v_max3_f32 v32, v32, v157, v158
    v_max_f32 v32, v32, v159
    v_mov_b32 v33, v32
    s_nop 1
    v_permlane32_swap_b32 v32, v33
    v_max_f32 v32, v32, v33
    v_mov_b32 v33, v32
    s_nop 1
    v_permlane16_swap_b32 v32, v33
    v_max_f32 v32, v32, v33
    v_max_f32 v32, 0, v32
    v_sub_f32 v33, 0, v32
    v_exp_f32 v33, v33
    v_sub_f32 v40, v40, v32
    v_sub_f32 v41, v41, v32
    v_sub_f32 v42, v42, v32
    v_sub_f32 v43, v43, v32
    v_sub_f32 v132, v132, v32
    v_sub_f32 v133, v133, v32
    v_sub_f32 v134, v134, v32
    v_sub_f32 v135, v135, v32
    v_sub_f32 v140, v140, v32
    v_sub_f32 v141, v141, v32
    v_sub_f32 v142, v142, v32
    v_sub_f32 v143, v143, v32
    v_sub_f32 v148, v148, v32
    v_sub_f32 v149, v149, v32
    v_sub_f32 v150, v150, v32
    v_sub_f32 v151, v151, v32
    v_sub_f32 v156, v156, v32
    v_sub_f32 v157, v157, v32
    v_sub_f32 v158, v158, v32
    v_sub_f32 v159, v159, v32
    v_sub_f32 v164, v164, v32
    v_sub_f32 v165, v165, v32
    v_sub_f32 v166, v166, v32
    v_sub_f32 v167, v167, v32
    v_sub_f32 v172, v172, v32
    v_sub_f32 v173, v173, v32
    v_sub_f32 v174, v174, v32
    v_sub_f32 v175, v175, v32
    v_sub_f32 v180, v180, v32
    v_sub_f32 v181, v181, v32
    v_sub_f32 v182, v182, v32
    v_sub_f32 v183, v183, v32
    v_sub_f32 v188, v188, v32
    v_sub_f32 v189, v189, v32
    v_sub_f32 v190, v190, v32
    v_sub_f32 v191, v191, v32
    v_mul_f32 v29, v29, v33
    v_mul_f32 v196, v196, v33
    v_mul_f32 v197, v197, v33
    v_mul_f32 v198, v198, v33
    v_mul_f32 v199, v199, v33
    v_mul_f32 v204, v204, v33
    v_mul_f32 v205, v205, v33
    v_mul_f32 v206, v206, v33
    v_mul_f32 v207, v207, v33
    v_mul_f32 v212, v212, v33
    v_mul_f32 v213, v213, v33
    v_mul_f32 v214, v214, v33
    v_mul_f32 v215, v215, v33
    v_mul_f32 v220, v220, v33
    v_mul_f32 v221, v221, v33
    v_mul_f32 v222, v222, v33
    v_mul_f32 v223, v223, v33
    v_mul_f32 v228, v228, v33
    v_mul_f32 v229, v229, v33
    v_mul_f32 v230, v230, v33
    v_mul_f32 v231, v231, v33
    v_mul_f32 v236, v236, v33
    v_mul_f32 v237, v237, v33
    v_mul_f32 v238, v238, v33
    v_mul_f32 v239, v239, v33
    v_mul_f32 v244, v244, v33
    v_mul_f32 v245, v245, v33
    v_mul_f32 v246, v246, v33
    v_mul_f32 v247, v247, v33
    v_mul_f32 v252, v252, v33
    v_mul_f32 v253, v253, v33
    v_mul_f32 v254, v254, v33
    v_mul_f32 v255, v255, v33
    v_exp_f32 v44, v128
    v_exp_f32 v45, v129
    v_exp_f32 v46, v130
    v_exp_f32 v47, v131
    v_exp_f32 v48, v132
    v_cvt_pk_bf16_f32 v96, v44, v45
    v_exp_f32 v49, v133
    v_cvt_pk_bf16_f32 v97, v46, v47
    v_exp_f32 v50, v134
    v_exp_f32 v51, v135
    v_exp_f32 v44, v136
    v_cvt_pk_bf16_f32 v100, v48, v49
    v_exp_f32 v45, v137
    v_cvt_pk_bf16_f32 v101, v50, v51
    v_exp_f32 v46, v138
    v_exp_f32 v47, v139
    v_exp_f32 v48, v140
    v_cvt_pk_bf16_f32 v98, v44, v45
    v_exp_f32 v49, v141
    v_cvt_pk_bf16_f32 v99, v46, v47
    v_exp_f32 v50, v142
    v_exp_f32 v51, v143
    v_exp_f32 v44, v144
    v_cvt_pk_bf16_f32 v102, v48, v49
    v_exp_f32 v45, v145
    v_cvt_pk_bf16_f32 v103, v50, v51
    v_exp_f32 v46, v146
    v_exp_f32 v47, v147
    v_exp_f32 v48, v148
    v_cvt_pk_bf16_f32 v104, v44, v45
    v_exp_f32 v49, v149
    v_cvt_pk_bf16_f32 v105, v46, v47
    v_exp_f32 v50, v150
    v_exp_f32 v51, v151
    v_exp_f32 v44, v152
    v_cvt_pk_bf16_f32 v108, v48, v49
    v_exp_f32 v45, v153
    v_cvt_pk_bf16_f32 v109, v50, v51
    v_exp_f32 v46, v154
    v_exp_f32 v47, v155
    v_exp_f32 v48, v156
    v_cvt_pk_bf16_f32 v106, v44, v45
    v_exp_f32 v49, v157
    v_cvt_pk_bf16_f32 v107, v46, v47
    v_exp_f32 v50, v158
    v_exp_f32 v51, v159
    s_nop 0
    v_cvt_pk_bf16_f32 v110, v48, v49
    v_cvt_pk_bf16_f32 v111, v50, v51
    s_nop 1
    v_mfma_f32_16x16x32_bf16 v[88:91], v[84:87], v[96:99], 0
    v_mfma_f32_16x16x32_bf16 v[92:95], v[84:87], v[100:103], 0
    v_mfma_f32_16x16x32_bf16 v[88:91], v[84:87], v[104:107], v[88:91]
    v_mfma_f32_16x16x32_bf16 v[92:95], v[84:87], v[108:111], v[92:95]
    s_nop 7
    s_setpc_b64 s[90:91]
.p2align 12
L_snip0:
    v_add_u32 v44, s86, v14
    v_add_u32 v45, s86, v15
    v_add_u32 v46, s86, v16
    v_add_u32 v47, s86, v17
    v_add_u32 v48, s86, v18
    v_add_u32 v49, s86, v19
    v_add_u32 v50, s86, v20
    v_add_u32 v51, s86, v21
    ds_read_b64_tr_b16 v[34:35], v44 offset:0
    ds_read_b64_tr_b16 v[34:35], v45 offset:0
    ds_read_b64_tr_b16 v[34:35], v46 offset:0
    ds_read_b64_tr_b16 v[34:35], v47 offset:0
    ds_read_b64_tr_b16 v[34:35], v48 offset:0
    ds_read_b64_tr_b16 v[34:35], v49 offset:0
    ds_read_b64_tr_b16 v[34:35], v50 offset:0
    ds_read_b64_tr_b16 v[34:35], v51 offset:0
    s_add_u32 s94, s94, 0
    s_add_u32 s95, s94, 6144
    s_add_u32 s88, s88, 128
    s_setpc_b64 s[90:91]
.p2align 7
    v_add_u32 v44, s86, v14
    v_add_u32 v45, s86, v15
    v_add_u32 v46, s86, v16
    v_add_u32 v47, s86, v17
    v_add_u32 v48, s86, v18
    v_add_u32 v49, s86, v19
    v_add_u32 v50, s86, v20
    v_add_u32 v51, s86, v21
    ds_read_b64_tr_b16 v[34:35], v44 offset:0
    ds_read_b64_tr_b16 v[34:35], v45 offset:0
    ds_read_b64_tr_b16 v[34:35], v46 offset:0
    ds_read_b64_tr_b16 v[34:35], v47 offset:0
    ds_read_b64_tr_b16 v[34:35], v48 offset:0
    ds_read_b64_tr_b16 v[34:35], v49 offset:0
    ds_read_b64_tr_b16 v[34:35], v50 offset:0
    ds_read_b64_tr_b16 v[34:35], v51 offset:0
    s_add_u32 s94, s94, 16384
    s_add_u32 s95, s94, 6144
    s_add_u32 s88, s88, 128
    s_setpc_b64 s[90:91]
.p2align 7
    v_add_u32 v44, s86, v14
    v_add_u32 v45, s86, v15
    v_add_u32 v46, s86, v16
    v_add_u32 v47, s86, v17
    v_add_u32 v48, s86, v18
    v_add_u32 v49, s86, v19
    v_add_u32 v50, s86, v20
    v_add_u32 v51, s86, v21
    ds_read_b64_tr_b16 a[32:33], v44 offset:4096
    ds_read_b64_tr_b16 a[36:37], v45 offset:4096
    ds_read_b64_tr_b16 a[40:41], v46 offset:4096
    ds_read_b64_tr_b16 a[44:45], v47 offset:4096
    ds_read_b64_tr_b16 a[48:49], v48 offset:4096
    ds_read_b64_tr_b16 a[52:53], v49 offset:4096
    ds_read_b64_tr_b16 a[56:57], v50 offset:4096
    ds_read_b64_tr_b16 a[60:61], v51 offset:4096
    s_add_u32 s94, s94, 16384
    s_add_u32 s95, s94, 6144
    s_add_u32 s88, s88, 128
    s_setpc_b64 s[90:91]
.p2align 7
    v_add_u32 v44, s86, v14
    v_add_u32 v45, s86, v15
    v_add_u32 v46, s86, v16
    v_add_u32 v47, s86, v17
    v_add_u32 v48, s86, v18
    v_add_u32 v49, s86, v19
    v_add_u32 v50, s86, v20
    v_add_u32 v51, s86, v21
    ds_read_b64_tr_b16 a[34:35], v44 offset:0
    ds_read_b64_tr_b16 a[38:39], v45 offset:0
    ds_read_b64_tr_b16 a[42:43], v46 offset:0
    ds_read_b64_tr_b16 a[46:47], v47 offset:0
    ds_read_b64_tr_b16 a[50:51], v48 offset:0
    ds_read_b64_tr_b16 a[54:55], v49 offset:0
    ds_read_b64_tr_b16 a[58:59], v50 offset:0
    ds_read_b64_tr_b16 a[62:63], v51 offset:0
    s_add_u32 s94, s94, 16384
    s_add_u32 s95, s94, 6144
    s_add_u32 s88, s88, 128
    s_setpc_b64 s[90:91]
.p2align 7
    v_add_u32 v44, s86, v14
    v_add_u32 v45, s86, v15
    v_add_u32 v46, s86, v16
    v_add_u32 v47, s86, v17
    v_add_u32 v48, s86, v18
    v_add_u32 v49, s86, v19
    v_add_u32 v50, s86, v20
    v_add_u32 v51, s86, v21
    ds_read_b64_tr_b16 a[64:65], v44 offset:4096
    ds_read_b64_tr_b16 a[68:69], v45 offset:4096
    ds_read_b64_tr_b16 a[72:73], v46 offset:4096
    ds_read_b64_tr_b16 a[76:77], v47 offset:4096
    ds_read_b64_tr_b16 a[80:81], v48 offset:4096
    ds_read_b64_tr_b16 a[84:85], v49 offset:4096
    ds_read_b64_tr_b16 a[88:89], v50 offset:4096
    ds_read_b64_tr_b16 a[92:93], v51 offset:4096
    s_add_u32 s94, s94, 81920
    s_add_u32 s95, s94, 6144
    s_add_u32 s88, s88, 128
    s_setpc_b64 s[90:91]
.p2align 7
    v_add_u32 v44, s86, v14
    v_add_u32 v45, s86, v15
    v_add_u32 v46, s86, v16
    v_add_u32 v47, s86, v17
    v_add_u32 v48, s86, v18
    v_add_u32 v49, s86, v19
    v_add_u32 v50, s86, v20
    v_add_u32 v51, s86, v21
    ds_read_b64_tr_b16 a[66:67], v44 offset:0
    ds_read_b64_tr_b16 a[70:71], v45 offset:0
    ds_read_b64_tr_b16 a[74:75], v46 offset:0
    ds_read_b64_tr_b16 a[78:79], v47 offset:0
    ds_read_b64_tr_b16 a[82:83], v48 offset:0
    ds_read_b64_tr_b16 a[86:87], v49 offset:0
    ds_read_b64_tr_b16 a[90:91], v50 offset:0
    ds_read_b64_tr_b16 a[94:95], v51 offset:0
    s_add_u32 s94, s94, 16384
    s_add_u32 s95, s94, 6144
    s_add_u32 s88, s88, 128
    s_setpc_b64 s[90:91]
.p2align 7
    v_add_u32 v44, s86, v14
    v_add_u32 v45, s86, v15
    v_add_u32 v46, s86, v16
    v_add_u32 v47, s86, v17
    v_add_u32 v48, s86, v18
    v_add_u32 v49, s86, v19
    v_add_u32 v50, s86, v20
    v_add_u32 v51, s86, v21
    ds_read_b64_tr_b16 a[96:97], v44 offset:4096
    ds_read_b64_tr_b16 a[100:101], v45 offset:4096
    ds_read_b64_tr_b16 a[104:105], v46 offset:4096
    ds_read_b64_tr_b16 a[108:109], v47 offset:4096
    ds_read_b64_tr_b16 a[112:113], v48 offset:4096
    ds_read_b64_tr_b16 a[116:117], v49 offset:4096
    ds_read_b64_tr_b16 a[120:121], v50 offset:4096
    ds_read_b64_tr_b16 a[124:125], v51 offset:4096
    s_add_u32 s94, s94, 16384
    s_add_u32 s95, s94, 6144
    s_add_u32 s88, s88, 128
    s_setpc_b64 s[90:91]
.p2align 7
    v_add_u32 v44, s86, v14
    v_add_u32 v45, s86, v15
    v_add_u32 v46, s86, v16
    v_add_u32 v47, s86, v17
    v_add_u32 v48, s86, v18
    v_add_u32 v49, s86, v19
    v_add_u32 v50, s86, v20
    v_add_u32 v51, s86, v21
    ds_read_b64_tr_b16 a[98:99], v44 offset:0
    ds_read_b64_tr_b16 a[102:103], v45 offset:0
    ds_read_b64_tr_b16 a[106:107], v46 offset:0
    ds_read_b64_tr_b16 a[110:111], v47 offset:0
    ds_read_b64_tr_b16 a[114:115], v48 offset:0
    ds_read_b64_tr_b16 a[118:119], v49 offset:0
    ds_read_b64_tr_b16 a[122:123], v50 offset:0
    ds_read_b64_tr_b16 a[126:127], v51 offset:0
    s_add_u32 s94, s94, 16384
    s_add_u32 s95, s94, 6144
    s_add_u32 s88, s88, 128
    s_setpc_b64 s[90:91]
.p2align 7
    v_add_u32 v44, s86, v14
    v_add_u32 v45, s86, v15
    v_add_u32 v46, s86, v16
    v_add_u32 v47, s86, v17
    v_add_u32 v48, s86, v18
    v_add_u32 v49, s86, v19
    v_add_u32 v50, s86, v20
    v_add_u32 v51, s86, v21
    ds_read_b64_tr_b16 a[128:129], v44 offset:4096
    ds_read_b64_tr_b16 a[132:133], v45 offset:4096
    ds_read_b64_tr_b16 a[136:137], v46 offset:4096
    ds_read_b64_tr_b16 a[140:141], v47 offset:4096
    ds_read_b64_tr_b16 a[144:145], v48 offset:4096
    ds_read_b64_tr_b16 a[148:149], v49 offset:4096
    ds_read_b64_tr_b16 a[152:153], v50 offset:4096
    ds_read_b64_tr_b16 a[156:157], v51 offset:4096
    s_add_u32 s94, s94, 81920
    s_add_u32 s95, s94, 6144
    s_add_u32 s88, s88, 128
    s_setpc_b64 s[90:91]
.p2align 7
    v_add_u32 v44, s86, v14
    v_add_u32 v45, s86, v15
    v_add_u32 v46, s86, v16
    v_add_u32 v47, s86, v17
    v_add_u32 v48, s86, v18
    v_add_u32 v49, s86, v19
    v_add_u32 v50, s86, v20
    v_add_u32 v51, s86, v21
    ds_read_b64_tr_b16 a[130:131], v44 offset:0
    ds_read_b64_tr_b16 a[134:135], v45 offset:0
    ds_read_b64_tr_b16 a[138:139], v46 offset:0
    ds_read_b64_tr_b16 a[142:143], v47 offset:0
    ds_read_b64_tr_b16 a[146:147], v48 offset:0
    ds_read_b64_tr_b16 a[150:151], v49 offset:0
    ds_read_b64_tr_b16 a[154:155], v50 offset:0
    ds_read_b64_tr_b16 a[158:159], v51 offset:0
    s_add_u32 s94, s94, 16384
    s_add_u32 s95, s94, 6144
    s_add_u32 s88, s88, 128
    s_setpc_b64 s[90:91]
.p2align 7
    v_add_u32 v44, s86, v14
    v_add_u32 v45, s86, v15
    v_add_u32 v46, s86, v16
    v_add_u32 v47, s86, v17
    v_add_u32 v48, s86, v18
    v_add_u32 v49, s86, v19
    v_add_u32 v50, s86, v20
    v_add_u32 v51, s86, v21
    ds_read_b64_tr_b16 a[160:161], v44 offset:4096
    ds_read_b64_tr_b16 a[164:165], v45 offset:4096
    ds_read_b64_tr_b16 a[168:169], v46 offset:4096
    ds_read_b64_tr_b16 a[172:173], v47 offset:4096
    ds_read_b64_tr_b16 a[176:177], v48 offset:4096
    ds_read_b64_tr_b16 a[180:181], v49 offset:4096
    ds_read_b64_tr_b16 a[184:185], v50 offset:4096
    ds_read_b64_tr_b16 a[188:189], v51 offset:4096
    s_add_u32 s94, s94, 16384
    s_add_u32 s95, s94, 6144
    s_add_u32 s88, s88, 128
    s_setpc_b64 s[90:91]
.p2align 7
    v_add_u32 v44, s86, v14
    v_add_u32 v45, s86, v15
    v_add_u32 v46, s86, v16
    v_add_u32 v47, s86, v17
    v_add_u32 v48, s86, v18
    v_add_u32 v49, s86, v19
    v_add_u32 v50, s86, v20
    v_add_u32 v51, s86, v21
    ds_read_b64_tr_b16 a[162:163], v44 offset:0
    ds_read_b64_tr_b16 a[166:167], v45 offset:0
    ds_read_b64_tr_b16 a[170:171], v46 offset:0
    ds_read_b64_tr_b16 a[174:175], v47 offset:0
    ds_read_b64_tr_b16 a[178:179], v48 offset:0
    ds_read_b64_tr_b16 a[182:183], v49 offset:0
    ds_read_b64_tr_b16 a[186:187], v50 offset:0
    ds_read_b64_tr_b16 a[190:191], v51 offset:0
    s_add_u32 s94, s94, 16384
    s_add_u32 s95, s94, 6144
    s_add_u32 s88, s88, 128
    s_setpc_b64 s[90:91]
.p2align 7
    v_add_u32 v44, s86, v14
    v_add_u32 v45, s86, v15
    v_add_u32 v46, s86, v16
    v_add_u32 v47, s86, v17
    v_add_u32 v48, s86, v18
    v_add_u32 v49, s86, v19
    v_add_u32 v50, s86, v20
    v_add_u32 v51, s86, v21
    ds_read_b64_tr_b16 a[192:193], v44 offset:4096
    ds_read_b64_tr_b16 a[196:197], v45 offset:4096
    ds_read_b64_tr_b16 a[200:201], v46 offset:4096
    ds_read_b64_tr_b16 a[204:205], v47 offset:4096
    ds_read_b64_tr_b16 a[208:209], v48 offset:4096
    ds_read_b64_tr_b16 a[212:213], v49 offset:4096
    ds_read_b64_tr_b16 a[216:217], v50 offset:4096
    ds_read_b64_tr_b16 a[220:221], v51 offset:4096
    s_add_u32 s94, s94, 81920
    s_add_u32 s95, s94, 6144
    s_add_u32 s88, s88, 128
    s_setpc_b64 s[90:91]
.p2align 7
    v_add_u32 v44, s86, v14
    v_add_u32 v45, s86, v15
    v_add_u32 v46, s86, v16
    v_add_u32 v47, s86, v17
    v_add_u32 v48, s86, v18
    v_add_u32 v49, s86, v19
    v_add_u32 v50, s86, v20
    v_add_u32 v51, s86, v21
    ds_read_b64_tr_b16 a[194:195], v44 offset:0
    ds_read_b64_tr_b16 a[198:199], v45 offset:0
    ds_read_b64_tr_b16 a[202:203], v46 offset:0
    ds_read_b64_tr_b16 a[206:207], v47 offset:0
    ds_read_b64_tr_b16 a[210:211], v48 offset:0
    ds_read_b64_tr_b16 a[214:215], v49 offset:0
    ds_read_b64_tr_b16 a[218:219], v50 offset:0
    ds_read_b64_tr_b16 a[222:223], v51 offset:0
    s_add_u32 s94, s94, 16384
    s_add_u32 s95, s94, 6144
    s_add_u32 s88, s88, 128
    s_setpc_b64 s[90:91]
.p2align 7
    v_add_u32 v44, s86, v14
    v_add_u32 v45, s86, v15
    v_add_u32 v46, s86, v16
    v_add_u32 v47, s86, v17
    v_add_u32 v48, s86, v18
    v_add_u32 v49, s86, v19
    v_add_u32 v50, s86, v20
    v_add_u32 v51, s86, v21
    ds_read_b64_tr_b16 a[224:225], v44 offset:4096
    ds_read_b64_tr_b16 a[228:229], v45 offset:4096
    ds_read_b64_tr_b16 a[232:233], v46 offset:4096
    ds_read_b64_tr_b16 a[236:237], v47 offset:4096
    ds_read_b64_tr_b16 a[240:241], v48 offset:4096
    ds_read_b64_tr_b16 a[244:245], v49 offset:4096
    ds_read_b64_tr_b16 a[248:249], v50 offset:4096
    ds_read_b64_tr_b16 a[252:253], v51 offset:4096
    s_add_u32 s94, s94, 16384
    s_add_u32 s95, s94, 6144
    s_add_u32 s88, s88, 128
    s_setpc_b64 s[90:91]
.p2align 7
    v_add_u32 v44, s86, v14
    v_add_u32 v45, s86, v15
    v_add_u32 v46, s86, v16
    v_add_u32 v47, s86, v17
    v_add_u32 v48, s86, v18
    v_add_u32 v49, s86, v19
    v_add_u32 v50, s86, v20
    v_add_u32 v51, s86, v21
    ds_read_b64_tr_b16 a[226:227], v44 offset:0
    ds_read_b64_tr_b16 a[230:231], v45 offset:0
    ds_read_b64_tr_b16 a[234:235], v46 offset:0
    ds_read_b64_tr_b16 a[238:239], v47 offset:0
    ds_read_b64_tr_b16 a[242:243], v48 offset:0
    ds_read_b64_tr_b16 a[246:247], v49 offset:0
    ds_read_b64_tr_b16 a[250:251], v50 offset:0
    ds_read_b64_tr_b16 a[254:255], v51 offset:0
    s_add_u32 s94, s94, 16384
    s_add_u32 s95, s94, 6144
    s_add_u32 s88, s88, 128
    s_setpc_b64 s[90:91]
.p2align 7
    v_add_u32 v44, s86, v14
    v_add_u32 v45, s86, v15
    v_add_u32 v46, s86, v16
    v_add_u32 v47, s86, v17
    v_add_u32 v48, s86, v18
    v_add_u32 v49, s86, v19
    v_add_u32 v50, s86, v20
    v_add_u32 v51, s86, v21
    ds_read_b64_tr_b16 v[34:35], v44 offset:0
    ds_read_b64_tr_b16 v[34:35], v45 offset:0
    ds_read_b64_tr_b16 v[34:35], v46 offset:0
    ds_read_b64_tr_b16 v[34:35], v47 offset:0
    ds_read_b64_tr_b16 v[34:35], v48 offset:0
    ds_read_b64_tr_b16 v[34:35], v49 offset:0
    ds_read_b64_tr_b16 v[34:35], v50 offset:0
    ds_read_b64_tr_b16 v[34:35], v51 offset:0
    s_add_u32 s94, s94, 81920
    s_add_u32 s95, s94, 6144
    s_add_u32 s88, s88, 128
    s_setpc_b64 s[90:91]
.p2align 7
L_stwk:
L_stwv:
L_codeend:
.section .rodata,"a"
.p2align 6
.amdhsa_kernel standalone__gqa_block_cached__sampling_kernel
  .amdhsa_next_free_vgpr 512
  .amdhsa_next_free_sgpr 102
  .amdhsa_accum_offset 256
  .amdhsa_group_segment_fixed_size 0
  .amdhsa_kernarg_size 64
  .amdhsa_user_sgpr_count 2
  .amdhsa_user_sgpr_kernarg_segment_ptr 1
  .amdhsa_system_sgpr_workgroup_id_x 1
.end_amdhsa_kernel
```
